```python
import torch

def _softmax(x, axis=-1):
    return torch.softmax(x, dim=axis)
def _gelu(x):
    return torch.nn.functional.gelu(x, approximate="tanh")
def _silu(x):
    return torch.nn.functional.silu(x)
def _sigmoid(x):
    return torch.sigmoid(x)
def _layernorm(x, axis=-1, eps=1e-5):
    m = x.mean(dim=axis, keepdim=True)
    v = x.var(dim=axis, keepdim=True, unbiased=False)
    return (x - m) / torch.sqrt(v + eps)
def _scatter_add(tgt, idx, src, axis=0):
    return tgt.clone().index_add_(axis, idx, src)
def _segment_sum(src, seg, n):
    out = torch.zeros((n,) + src.shape[1:], dtype=src.dtype)
    return out.index_add_(0, seg, src)
def _pad(x, pw):
    flat = tuple(v for pair in reversed(pw) for v in pair)
    return torch.nn.functional.pad(x, flat)

kernel_name = 'sequential_preLN__grouped_kv_mqa__glu_gated_glu__prompt'

def setup_inputs():

    _w = (lambda a: (lambda t: t.to(torch.bfloat16) if t.is_floating_point() else t)(torch.as_tensor(a)))
    def _A_setup():
        B, S, D, H = 1, 2048, 512, 32
        Dh = D // H
        return {
            "x": _w((lambda *s: torch.randn(*s, dtype=torch.bfloat16) * 0.05)(B, S, D)),
            "wq": _w((lambda *s: torch.randn(*s, dtype=torch.bfloat16) * 0.05)(D, H * Dh)),
            "wk": _w((lambda *s: torch.randn(*s, dtype=torch.bfloat16) * 0.05)(D, Dh)),
            "wv": _w((lambda *s: torch.randn(*s, dtype=torch.bfloat16) * 0.05)(D, Dh)),
            "wo": _w((lambda *s: torch.randn(*s, dtype=torch.bfloat16) * 0.05)(H * Dh, D)),
        }
    _A_in = _A_setup()

    def _B_setup():
        B, S, D, F = 1, 2048, 512, 1792
        return {
            "x": _w((lambda *s: torch.randn(*s, dtype=torch.bfloat16) * 0.05)(B, S, D)),
            "w_gate": _w((lambda *s: torch.randn(*s, dtype=torch.bfloat16) * 0.05)(D, F)),
            "w_up": _w((lambda *s: torch.randn(*s, dtype=torch.bfloat16) * 0.05)(D, F)),
            "w_down": _w((lambda *s: torch.randn(*s, dtype=torch.bfloat16) * 0.05)(F, D)),
        }
    _B_in = _B_setup()

    return {
        "A_x": _A_in["x"],
        "A_wq": _A_in["wq"],
        "A_wk": _A_in["wk"],
        "A_wv": _A_in["wv"],
        "A_wo": _A_in["wo"],
        "B_x": _B_in["x"],
        "B_w_gate": _B_in["w_gate"],
        "B_w_up": _B_in["w_up"],
        "B_w_down": _B_in["w_down"],
    }

def reference(A_x, A_wq, A_wk, A_wv, A_wo, B_x, B_w_gate, B_w_up, B_w_down):
    def _A_ref(x, wq, wk, wv, wo):
        B, S, D = x.shape
        H = 32
        Dh = D // H
        q = (lambda x, *d: x.permute(*d))((x @ wq).reshape(B, S, H, Dh), 0, 2, 1, 3)
        k = x @ wk
        v = x @ wv
        scores = torch.einsum("bhqd,bkd->bhqk", q, k) * (Dh ** -0.5)
        p = _softmax(scores, axis=-1)
        o = torch.einsum("bhqk,bkd->bhqd", p, v)
        return (lambda x, *d: x.permute(*d))(o, 0, 2, 1, 3).reshape(B, S, H * Dh) @ wo

    def _B_ref(x, w_gate, w_up, w_down):
        g = torch.einsum("bsd,df->bsf", x, w_gate)
        u = torch.einsum("bsd,df->bsf", x, w_up)
        h = _sigmoid(g) * u
        return torch.einsum("bsf,fd->bsd", h, w_down)

    x = A_x
    h = x + _A_ref(_layernorm(x, axis=-1), A_wq, A_wk, A_wv, A_wo)
    h2 = h + _B_ref(_layernorm(h, axis=-1), B_w_gate, B_w_up, B_w_down)
    return h2
```

```asm
; @launch kernel=qkv_kernel grid=(256,1,1) block=(768,1,1) lds=150528
; @launch kernel=sequential_preLN__grouped_kv_mqa__glu_gated_glu__prompt_kernel grid=(256,1,1) block=(512,1,1) lds=163840
.amdgcn_target "amdgcn-amd-amdhsa--gfx950"
.text
.p2align 12
.globl qkv_kernel
.p2align 8
.type qkv_kernel,@function
qkv_kernel:
    s_cmp_ge_u32 s2, 256
    s_cbranch_scc1 ka_exit
    s_load_dwordx8 s[4:11], s[0:1], 0
    s_load_dwordx2 s[12:13], s[0:1], 88
    s_load_dwordx2 s[14:15], s[0:1], 32
    v_lshrrev_b32 v6, 6, v0
    v_and_b32 v1, 63, v0
    s_lshr_b32 s36, s2, 3
    v_readfirstlane_b32 s35, v6
    s_and_b32 s33, s36, 7
    s_lshr_b32 s36, s36, 3
    s_add_u32 s34, s36, s33
    s_and_b32 s34, s34, 3
    s_and_b32 s32, s2, 7
    s_lshl_b32 s32, s32, 2
    s_add_u32 s32, s32, s36
    s_lshl_b32 s40, s32, 16
    v_lshlrev_b32 v5, 4, v1
    s_mov_b32 s58, s35
    s_cmp_ge_u32 s35, 4
    s_cbranch_scc1 ka_comp
    s_cmp_ge_u32 s35, 2
    s_cbranch_scc1 ka_nt
    s_getpc_b64 s[48:49]
ct_a:
    v_lshlrev_b32 v24, 7, v0
    v_mov_b32 v25, s49
    v_min_u32 v24, ka_exit-ct_a, v24
    v_add_co_u32 v24, vcc, s48, v24
    s_nop 1
    v_addc_co_u32 v25, vcc, 0, v25, vcc
    global_load_dword v26, v[24:25], off
ka_nt:
    v_lshrrev_b32 v7, 4, v1
    v_lshl_add_u32 v6, v6, 3, v7
    v_xor_b32 v2, v1, v6
    v_and_b32 v2, 15, v2
    v_lshlrev_b32 v2, 4, v2
    v_lshl_add_u32 v2, v6, 10, v2
    v_xor_b32 v3, 64, v2
    v_add_u32 v3, 0xc00, v3
    v_and_b32 v7, 1, v7
    v_lshlrev_b32 v7, 2, v7
    v_xor_b32 v7, v7, v1
    v_and_b32 v7, 7, v7
    v_lshlrev_b32 v7, 4, v7
    v_lshrrev_b32 v4, 3, v1
    v_lshl_add_u32 v4, v4, 10, v7
    v_xor_b32 v30, 32, v4
    v_add_u32 v30, 0x1c00, v30
    v_and_b32 v31, 16, v1
    v_lshlrev_b32 v31, 3, v31
    v_xor_b32 v31, v31, v5
    s_lshl_b32 s39, s35, 10
    s_lshl_b32 s43, s35, 11
    s_lshl_b32 s41, s35, 14
    s_lshl_b32 s36, s33, 7
    s_add_u32 s41, s41, s36
    s_mov_b32 s18, 2097152
    s_mov_b32 s19, 0x00020000
    s_mov_b32 s22, 524288
    s_mov_b32 s23, 0x00020000
    s_mov_b32 s26, 0x4000
    s_mov_b32 s27, 0x00020000
    s_bitcmp1_b32 s33, 0
    s_waitcnt lgkmcnt(0)
    s_mov_b64 s[16:17], s[4:5]
    s_mov_b64 s[20:21], s[6:7]
    s_cselect_b64 s[24:25], s[10:11], s[8:9]
    s_add_u32 s42, s34, 0
    s_and_b32 s42, s42, 3
    s_lshl_b32 s46, s42, 8
    s_add_u32 s46, s46, s40
    s_lshl_b32 s47, s42, 17
    s_add_u32 m0, s43, 0
    s_add_u32 s47, s47, s41
    buffer_load_dwordx4 v2, s[16:19], s46 offen lds
    buffer_load_dwordx4 v3, s[16:19], s46 offen offset:1024 lds
    s_add_u32 m0, s43, 65536
    s_add_u32 s46, s46, 0x8000
    buffer_load_dwordx4 v4, s[20:23], s47 offen lds
    buffer_load_dwordx4 v30, s[20:23], s47 offen offset:1024 lds
    s_add_u32 m0, s43, 8192
    s_add_u32 s47, s47, 0x10000
    buffer_load_dwordx4 v2, s[16:19], s46 offen lds
    buffer_load_dwordx4 v3, s[16:19], s46 offen offset:1024 lds
    s_add_u32 m0, s43, 73728
    s_lshl_b32 s46, s42, 12
    buffer_load_dwordx4 v4, s[20:23], s47 offen lds
    buffer_load_dwordx4 v30, s[20:23], s47 offen offset:1024 lds
    s_add_u32 m0, s39, 131072
    s_add_u32 s46, s46, s39
    buffer_load_dwordx4 v31, s[24:27], s46 offen lds
    s_add_u32 s42, s34, 1
    s_and_b32 s42, s42, 3
    s_lshl_b32 s46, s42, 8
    s_add_u32 s46, s46, s40
    s_lshl_b32 s47, s42, 17
    s_add_u32 m0, s43, 16384
    s_add_u32 s47, s47, s41
    buffer_load_dwordx4 v2, s[16:19], s46 offen lds
    buffer_load_dwordx4 v3, s[16:19], s46 offen offset:1024 lds
    s_add_u32 m0, s43, 81920
    s_add_u32 s46, s46, 0x8000
    buffer_load_dwordx4 v4, s[20:23], s47 offen lds
    buffer_load_dwordx4 v30, s[20:23], s47 offen offset:1024 lds
    s_add_u32 m0, s43, 24576
    s_add_u32 s47, s47, 0x10000
    buffer_load_dwordx4 v2, s[16:19], s46 offen lds
    buffer_load_dwordx4 v3, s[16:19], s46 offen offset:1024 lds
    s_add_u32 m0, s43, 90112
    s_lshl_b32 s46, s42, 12
    buffer_load_dwordx4 v4, s[20:23], s47 offen lds
    buffer_load_dwordx4 v30, s[20:23], s47 offen offset:1024 lds
    s_add_u32 m0, s39, 135168
    s_add_u32 s46, s46, s39
    buffer_load_dwordx4 v31, s[24:27], s46 offen lds
    s_mov_b32 s28, s12
    s_mov_b32 s29, s13
    s_mov_b32 s30, 0x1500000
    s_mov_b32 s31, 0x00020000
    s_mov_b32 s52, s14
    s_mov_b32 s53, s15
    s_mov_b32 s54, 0x80000
    s_mov_b32 s55, 0x00020000
    v_lshrrev_b32 v6, 3, v1
    v_lshlrev_b32 v28, 10, v6
    v_and_b32 v6, 7, v1
    v_lshl_add_u32 v28, v6, 4, v28
    s_lshr_b32 s56, s2, 3
    s_lshl_b32 s57, s56, 14
    s_and_b32 s49, s2, 7
    s_lshl_b32 s48, s49, 7
    s_add_u32 s57, s57, s48
    s_lshl_b32 s56, s56, 10
    s_lshl_b32 s49, s49, 16
    s_add_u32 s56, s56, s49
    s_add_u32 s56, s56, 2621440
    v_bfe_u32 v29, v1, 2, 2
    v_lshrrev_b32 v6, 5, v1
    v_lshl_add_u32 v29, v6, 2, v29
    v_lshlrev_b32 v29, 7, v29
    v_and_b32 v6, 1, v1
    v_lshl_add_u32 v29, v6, 5, v29
    v_and_b32 v6, 16, v1
    v_add_u32 v29, v6, v29
    v_and_b32 v6, 2, v1
    v_lshl_add_u32 v29, v6, 2, v29
    v_add_u32 v29, 148480, v29
    s_lshl_b32 s48, s33, 6
    v_add_u32 v27, s48, v1
    s_waitcnt vmcnt(9)
    s_barrier
    s_add_u32 s42, s34, 2
    s_and_b32 s42, s42, 3
    s_lshl_b32 s46, s42, 8
    s_add_u32 s46, s46, s40
    s_lshl_b32 s47, s42, 17
    s_add_u32 m0, s43, 32768
    s_add_u32 s47, s47, s41
    buffer_load_dwordx4 v2, s[16:19], s46 offen lds
    buffer_load_dwordx4 v3, s[16:19], s46 offen offset:1024 lds
    s_add_u32 m0, s43, 98304
    s_add_u32 s46, s46, 0x8000
    buffer_load_dwordx4 v4, s[20:23], s47 offen lds
    buffer_load_dwordx4 v30, s[20:23], s47 offen offset:1024 lds
    s_add_u32 m0, s43, 40960
    s_add_u32 s47, s47, 0x10000
    buffer_load_dwordx4 v2, s[16:19], s46 offen lds
    buffer_load_dwordx4 v3, s[16:19], s46 offen offset:1024 lds
    s_add_u32 m0, s43, 106496
    s_lshl_b32 s46, s42, 12
    buffer_load_dwordx4 v4, s[20:23], s47 offen lds
    buffer_load_dwordx4 v30, s[20:23], s47 offen offset:1024 lds
    s_add_u32 m0, s39, 139264
    s_add_u32 s46, s46, s39
    buffer_load_dwordx4 v31, s[24:27], s46 offen lds
    s_waitcnt vmcnt(9)
    s_barrier
    s_add_u32 s42, s34, 3
    s_and_b32 s42, s42, 3
    s_lshl_b32 s46, s42, 8
    s_add_u32 s46, s46, s40
    s_lshl_b32 s47, s42, 17
    s_add_u32 m0, s43, 49152
    s_add_u32 s47, s47, s41
    buffer_load_dwordx4 v2, s[16:19], s46 offen lds
    buffer_load_dwordx4 v3, s[16:19], s46 offen offset:1024 lds
    s_add_u32 m0, s43, 114688
    s_add_u32 s46, s46, 0x8000
    buffer_load_dwordx4 v4, s[20:23], s47 offen lds
    buffer_load_dwordx4 v30, s[20:23], s47 offen offset:1024 lds
    s_add_u32 m0, s43, 57344
    s_add_u32 s47, s47, 0x10000
    buffer_load_dwordx4 v2, s[16:19], s46 offen lds
    buffer_load_dwordx4 v3, s[16:19], s46 offen offset:1024 lds
    s_add_u32 m0, s43, 122880
    s_lshl_b32 s46, s42, 12
    buffer_load_dwordx4 v4, s[20:23], s47 offen lds
    buffer_load_dwordx4 v30, s[20:23], s47 offen offset:1024 lds
    s_add_u32 m0, s39, 143360
    s_add_u32 s46, s46, s39
    buffer_load_dwordx4 v31, s[24:27], s46 offen lds
    s_cmp_lg_u32 s35, 0
    s_cbranch_scc1 ka_l0
    s_mov_b32 m0, 148480
    s_add_u32 s49, s57, 7168
    buffer_load_dwordx4 v28, s[52:55], s57 offen lds
    buffer_load_dwordx4 v28, s[52:55], s49 offen offset:1024 lds
    s_waitcnt vmcnt(11)
    s_barrier
    s_waitcnt vmcnt(2)
    s_barrier
    s_add_u32 s57, s56, 0x8000
    s_waitcnt vmcnt(0)
    ds_read_b64_tr_b16 v[64:65], v29 offset:0
    ds_read_b64_tr_b16 v[66:67], v29 offset:1024
    ds_read_b64_tr_b16 v[68:69], v29 offset:64
    ds_read_b64_tr_b16 v[70:71], v29 offset:1088
    s_waitcnt lgkmcnt(2)
    buffer_store_dwordx4 v[64:67], v5, s[28:31], s56 offen sc1
    s_waitcnt lgkmcnt(0)
    buffer_store_dwordx4 v[68:71], v5, s[28:31], s57 offen sc1
    s_branch ka_l3
ka_l0:
    s_cmp_lg_u32 s35, 3
    s_cbranch_scc1 ka_l1
    s_lshl_b32 s49, s2, 11
    buffer_load_dwordx4 v[64:67], v5, s[52:55], s49 offen
    buffer_load_dwordx4 v[68:71], v5, s[52:55], s49 offen offset:1024
    s_waitcnt vmcnt(11)
    s_barrier
    s_waitcnt vmcnt(2)
    s_barrier
    s_setprio 3
    s_lshl_b32 s49, s2, 3
    s_add_u32 s49, s49, 2260992
    v_lshrrev_b32 v6, 3, v1
    s_waitcnt vmcnt(0)
    v_lshlrev_b32 v72, 16, v64
    v_and_b32 v64, 0xffff0000, v64
    v_lshlrev_b32 v73, 16, v65
    v_and_b32 v65, 0xffff0000, v65
    v_lshlrev_b32 v74, 16, v66
    v_and_b32 v66, 0xffff0000, v66
    v_lshlrev_b32 v75, 16, v67
    v_and_b32 v67, 0xffff0000, v67
    v_lshlrev_b32 v76, 16, v68
    v_and_b32 v68, 0xffff0000, v68
    v_lshlrev_b32 v77, 16, v69
    v_and_b32 v69, 0xffff0000, v69
    v_lshlrev_b32 v78, 16, v70
    v_and_b32 v70, 0xffff0000, v70
    v_lshlrev_b32 v79, 16, v71
    v_and_b32 v71, 0xffff0000, v71
    v_add_f32 v64, v64, v72
    v_add_f32 v65, v65, v73
    v_add_f32 v66, v66, v74
    v_add_f32 v67, v67, v75
    v_add_f32 v68, v68, v76
    v_add_f32 v69, v69, v77
    v_add_f32 v70, v70, v78
    v_add_f32 v71, v71, v79
    v_add_f32 v64, v64, v65
    v_add_f32 v66, v66, v67
    v_add_f32 v68, v68, v69
    v_add_f32 v70, v70, v71
    v_add_f32 v64, v64, v66
    v_add_f32 v68, v68, v70
    s_nop 1
    v_permlane32_swap_b32 v64, v68
    v_add_f32 v64, v64, v68
    s_nop 1
    v_add_f32_dpp v64, v64, v64 row_ror:8 row_mask:0xf bank_mask:0xf
    s_nop 1
    v_add_f32_dpp v64, v64, v64 row_ror:4 row_mask:0xf bank_mask:0xf
    s_nop 1
    v_add_f32_dpp v64, v64, v64 row_ror:2 row_mask:0xf bank_mask:0xf
    s_nop 1
    v_add_f32_dpp v64, v64, v64 row_ror:1 row_mask:0xf bank_mask:0xf
    v_mov_b32 v65, v64
    s_nop 1
    v_permlane16_swap_b32 v64, v65
    v_add_f32 v64, v64, v65
    v_mul_f32 v64, 0x3b000000, v64
    s_mov_b32 exec_lo, 1
    s_mov_b32 exec_hi, 1
    buffer_store_dword v64, v6, s[28:31], s49 offen sc1
    s_mov_b64 exec, -1
    s_branch ka_l3
ka_l1:
    s_cmp_lg_u32 s35, 1
    s_cbranch_scc1 ka_l2
    s_waitcnt vmcnt(9)
    s_barrier
    s_waitcnt vmcnt(0)
    s_barrier
    s_getpc_b64 s[48:49]
ct_b:
    s_add_u32 s48, s48, sequential_preLN__grouped_kv_mqa__glu_gated_glu__prompt_kernel-ct_b
    s_addc_u32 s49, s49, 0
    v_lshlrev_b32 v24, 7, v27
    v_mov_b32 v25, s49
    v_min_u32 v24, kb_exit-sequential_preLN__grouped_kv_mqa__glu_gated_glu__prompt_kernel, v24
    v_add_co_u32 v24, vcc, s48, v24
    s_nop 1
    v_addc_co_u32 v25, vcc, 0, v25, vcc
    global_load_dword v26, v[24:25], off
    s_branch ka_l3
ka_l2:
    s_waitcnt vmcnt(9)
    s_barrier
    s_waitcnt vmcnt(0)
    s_barrier
    s_lshl_b32 s36, s2, 8
    s_add_u32 s36, s36, 2359296
    v_lshlrev_b32 v6, 2, v1
    v_mov_b32 v7, 0
    buffer_store_dword v7, v6, s[28:31], s36 offen sc1
ka_l3:
    s_barrier
    s_endpgm
.p2align 12
ka_comp:
    s_sub_u32 s35, s35, 4
    s_waitcnt lgkmcnt(0)
    s_mov_b32 s28, s12
    s_mov_b32 s29, s13
    s_mov_b32 s30, 0x1500000
    s_mov_b32 s31, 0x00020000
    v_and_b32 v8, 31, v1
    v_lshrrev_b32 v9, 5, v1
    s_cmp_ge_u32 s35, 4
    s_cbranch_scc1 ka_help
    s_and_b32 s36, s35, 1
    s_lshl_b32 s36, s36, 13
    v_xor_b32 v6, v9, v8
    v_and_b32 v6, 15, v6
    v_lshlrev_b32 v6, 4, v6
    v_lshl_add_u32 v6, v8, 8, v6
    v_add_u32 v10, s36, v6
    v_xor_b32 v11, 32, v10
    v_xor_b32 v12, 64, v10
    v_xor_b32 v13, 96, v10
    v_xor_b32 v14, 128, v10
    v_xor_b32 v15, 160, v10
    v_xor_b32 v16, 192, v10
    v_xor_b32 v17, 224, v10
    s_lshr_b32 s37, s35, 1
    s_lshl_b32 s37, s37, 6
    v_bfe_u32 v6, v1, 2, 2
    v_lshl_add_u32 v6, v9, 3, v6
    v_lshlrev_b32 v18, 7, v6
    v_bfe_u32 v6, v1, 3, 1
    v_lshlrev_b32 v6, 6, v6
    v_xor_b32 v6, s37, v6
    v_add_u32 v18, v18, v6
    v_bfe_u32 v6, v1, 4, 1
    v_xor_b32 v6, v6, v9
    v_lshl_add_u32 v18, v6, 5, v18
    v_and_b32 v6, 1, v1
    v_lshl_add_u32 v18, v6, 4, v18
    v_bfe_u32 v6, v1, 1, 1
    v_lshl_add_u32 v18, v6, 3, v18
    v_add_u32 v18, 65536, v18
    s_and_b32 s36, s35, 1
    s_lshl_b32 s36, s36, 5
    v_add_u32 v6, s36, v8
    v_lshlrev_b32 v21, 2, v6
    v_add_u32 v21, 147456, v21
    s_lshl_b32 s38, s36, 10
    s_lshl_b32 s36, s37, 1
    s_add_u32 s36, s36, 147968
    v_lshl_add_u32 v20, v9, 4, s36
    s_lshl_b32 s37, s37, 5
    s_lshl_b32 s36, s33, 12
    s_add_u32 s37, s37, s36
    s_add_u32 s38, s38, s37
    s_add_u32 s38, s38, s40
    s_barrier
    ds_read_b128 v[64:67], v10 offset:0
    ds_read_b64_tr_b16 v[68:69], v18 offset:0
    ds_read_b64_tr_b16 v[70:71], v18 offset:512
    ds_read_b128 v[72:75], v11 offset:0
    ds_read_b64_tr_b16 v[76:77], v18 offset:2048
    ds_read_b64_tr_b16 v[78:79], v18 offset:2560
    ds_read_b128 v[80:83], v12 offset:0
    ds_read_b64_tr_b16 v[84:85], v18 offset:4096
    ds_read_b64_tr_b16 v[86:87], v18 offset:4608
    ds_read_b128 v[88:91], v13 offset:0
    ds_read_b64_tr_b16 v[92:93], v18 offset:6144
    ds_read_b64_tr_b16 v[94:95], v18 offset:6656
    s_waitcnt lgkmcnt(9)
    v_mfma_f32_32x32x16_bf16 v[32:47], v[68:71], v[64:67], 0
    ds_read_b128 v[96:99], v14 offset:0
    ds_read_b64_tr_b16 v[100:101], v18 offset:8192
    ds_read_b64_tr_b16 v[102:103], v18 offset:8704
    s_waitcnt lgkmcnt(9)
    v_mfma_f32_32x32x16_bf16 v[32:47], v[76:79], v[72:75], v[32:47]
    ds_read_b128 v[104:107], v15 offset:0
    ds_read_b64_tr_b16 v[108:109], v18 offset:10240
    ds_read_b64_tr_b16 v[110:111], v18 offset:10752
    s_waitcnt lgkmcnt(9)
    v_mfma_f32_32x32x16_bf16 v[32:47], v[84:87], v[80:83], v[32:47]
    ds_read_b128 v[112:115], v16 offset:0
    ds_read_b64_tr_b16 v[116:117], v18 offset:12288
    ds_read_b64_tr_b16 v[118:119], v18 offset:12800
    s_waitcnt lgkmcnt(9)
    v_mfma_f32_32x32x16_bf16 v[32:47], v[92:95], v[88:91], v[32:47]
    ds_read_b128 v[120:123], v17 offset:0
    ds_read_b64_tr_b16 v[124:125], v18 offset:14336
    ds_read_b64_tr_b16 v[126:127], v18 offset:14848
    s_waitcnt lgkmcnt(9)
    v_mfma_f32_32x32x16_bf16 v[32:47], v[100:103], v[96:99], v[32:47]
    s_barrier
    ds_read_b128 v[64:67], v10 offset:16384
    ds_read_b64_tr_b16 v[68:69], v18 offset:16384
    ds_read_b64_tr_b16 v[70:71], v18 offset:16896
    s_waitcnt lgkmcnt(9)
    v_mfma_f32_32x32x16_bf16 v[32:47], v[108:111], v[104:107], v[32:47]
    ds_read_b128 v[72:75], v11 offset:16384
    ds_read_b64_tr_b16 v[76:77], v18 offset:18432
    ds_read_b64_tr_b16 v[78:79], v18 offset:18944
    s_waitcnt lgkmcnt(9)
    v_mfma_f32_32x32x16_bf16 v[32:47], v[116:119], v[112:115], v[32:47]
    ds_read_b128 v[80:83], v12 offset:16384
    ds_read_b64_tr_b16 v[84:85], v18 offset:20480
    ds_read_b64_tr_b16 v[86:87], v18 offset:20992
    s_waitcnt lgkmcnt(9)
    v_mfma_f32_32x32x16_bf16 v[32:47], v[124:127], v[120:123], v[32:47]
    ds_read_b128 v[88:91], v13 offset:16384
    ds_read_b64_tr_b16 v[92:93], v18 offset:22528
    ds_read_b64_tr_b16 v[94:95], v18 offset:23040
    s_waitcnt lgkmcnt(9)
    v_mfma_f32_32x32x16_bf16 v[32:47], v[68:71], v[64:67], v[32:47]
    ds_read_b128 v[96:99], v14 offset:16384
    ds_read_b64_tr_b16 v[100:101], v18 offset:24576
    ds_read_b64_tr_b16 v[102:103], v18 offset:25088
    s_waitcnt lgkmcnt(9)
    v_mfma_f32_32x32x16_bf16 v[32:47], v[76:79], v[72:75], v[32:47]
    ds_read_b128 v[104:107], v15 offset:16384
    ds_read_b64_tr_b16 v[108:109], v18 offset:26624
    ds_read_b64_tr_b16 v[110:111], v18 offset:27136
    s_waitcnt lgkmcnt(9)
    v_mfma_f32_32x32x16_bf16 v[32:47], v[84:87], v[80:83], v[32:47]
    ds_read_b128 v[112:115], v16 offset:16384
    ds_read_b64_tr_b16 v[116:117], v18 offset:28672
    ds_read_b64_tr_b16 v[118:119], v18 offset:29184
    s_waitcnt lgkmcnt(9)
    v_mfma_f32_32x32x16_bf16 v[32:47], v[92:95], v[88:91], v[32:47]
    ds_read_b128 v[120:123], v17 offset:16384
    ds_read_b64_tr_b16 v[124:125], v18 offset:30720
    ds_read_b64_tr_b16 v[126:127], v18 offset:31232
    s_waitcnt lgkmcnt(9)
    v_mfma_f32_32x32x16_bf16 v[32:47], v[100:103], v[96:99], v[32:47]
    s_barrier
    ds_read_b128 v[64:67], v10 offset:32768
    ds_read_b64_tr_b16 v[68:69], v18 offset:32768
    ds_read_b64_tr_b16 v[70:71], v18 offset:33280
    s_waitcnt lgkmcnt(9)
    v_mfma_f32_32x32x16_bf16 v[32:47], v[108:111], v[104:107], v[32:47]
    ds_read_b128 v[72:75], v11 offset:32768
    ds_read_b64_tr_b16 v[76:77], v18 offset:34816
    ds_read_b64_tr_b16 v[78:79], v18 offset:35328
    s_waitcnt lgkmcnt(9)
    v_mfma_f32_32x32x16_bf16 v[32:47], v[116:119], v[112:115], v[32:47]
    ds_read_b128 v[80:83], v12 offset:32768
    ds_read_b64_tr_b16 v[84:85], v18 offset:36864
    ds_read_b64_tr_b16 v[86:87], v18 offset:37376
    s_waitcnt lgkmcnt(9)
    v_mfma_f32_32x32x16_bf16 v[32:47], v[124:127], v[120:123], v[32:47]
    ds_read_b128 v[88:91], v13 offset:32768
    ds_read_b64_tr_b16 v[92:93], v18 offset:38912
    ds_read_b64_tr_b16 v[94:95], v18 offset:39424
    s_waitcnt lgkmcnt(9)
    v_mfma_f32_32x32x16_bf16 v[32:47], v[68:71], v[64:67], v[32:47]
    ds_read_b128 v[96:99], v14 offset:32768
    ds_read_b64_tr_b16 v[100:101], v18 offset:40960
    ds_read_b64_tr_b16 v[102:103], v18 offset:41472
    s_waitcnt lgkmcnt(9)
    v_mfma_f32_32x32x16_bf16 v[32:47], v[76:79], v[72:75], v[32:47]
    ds_read_b128 v[104:107], v15 offset:32768
    ds_read_b64_tr_b16 v[108:109], v18 offset:43008
    ds_read_b64_tr_b16 v[110:111], v18 offset:43520
    s_waitcnt lgkmcnt(9)
    v_mfma_f32_32x32x16_bf16 v[32:47], v[84:87], v[80:83], v[32:47]
    ds_read_b128 v[112:115], v16 offset:32768
    ds_read_b64_tr_b16 v[116:117], v18 offset:45056
    ds_read_b64_tr_b16 v[118:119], v18 offset:45568
    s_waitcnt lgkmcnt(9)
    v_mfma_f32_32x32x16_bf16 v[32:47], v[92:95], v[88:91], v[32:47]
    ds_read_b128 v[120:123], v17 offset:32768
    ds_read_b64_tr_b16 v[124:125], v18 offset:47104
    ds_read_b64_tr_b16 v[126:127], v18 offset:47616
    s_waitcnt lgkmcnt(9)
    v_mfma_f32_32x32x16_bf16 v[32:47], v[100:103], v[96:99], v[32:47]
    s_barrier
    ds_read_b128 v[64:67], v10 offset:49152
    ds_read_b64_tr_b16 v[68:69], v18 offset:49152
    ds_read_b64_tr_b16 v[70:71], v18 offset:49664
    s_waitcnt lgkmcnt(9)
    v_mfma_f32_32x32x16_bf16 v[32:47], v[108:111], v[104:107], v[32:47]
    ds_read_b128 v[72:75], v11 offset:49152
    ds_read_b64_tr_b16 v[76:77], v18 offset:51200
    ds_read_b64_tr_b16 v[78:79], v18 offset:51712
    s_waitcnt lgkmcnt(9)
    v_mfma_f32_32x32x16_bf16 v[32:47], v[116:119], v[112:115], v[32:47]
    ds_read_b128 v[80:83], v12 offset:49152
    ds_read_b64_tr_b16 v[84:85], v18 offset:53248
    ds_read_b64_tr_b16 v[86:87], v18 offset:53760
    s_waitcnt lgkmcnt(9)
    v_mfma_f32_32x32x16_bf16 v[32:47], v[124:127], v[120:123], v[32:47]
    ds_read_b128 v[88:91], v13 offset:49152
    ds_read_b64_tr_b16 v[92:93], v18 offset:55296
    ds_read_b64_tr_b16 v[94:95], v18 offset:55808
    s_waitcnt lgkmcnt(9)
    v_mfma_f32_32x32x16_bf16 v[32:47], v[68:71], v[64:67], v[32:47]
    ds_read_b128 v[96:99], v14 offset:49152
    ds_read_b64_tr_b16 v[100:101], v18 offset:57344
    ds_read_b64_tr_b16 v[102:103], v18 offset:57856
    s_waitcnt lgkmcnt(9)
    v_mfma_f32_32x32x16_bf16 v[32:47], v[76:79], v[72:75], v[32:47]
    ds_read_b128 v[104:107], v15 offset:49152
    ds_read_b64_tr_b16 v[108:109], v18 offset:59392
    ds_read_b64_tr_b16 v[110:111], v18 offset:59904
    s_waitcnt lgkmcnt(9)
    v_mfma_f32_32x32x16_bf16 v[32:47], v[84:87], v[80:83], v[32:47]
    ds_read_b128 v[112:115], v16 offset:49152
    ds_read_b64_tr_b16 v[116:117], v18 offset:61440
    ds_read_b64_tr_b16 v[118:119], v18 offset:61952
    s_waitcnt lgkmcnt(9)
    v_mfma_f32_32x32x16_bf16 v[32:47], v[92:95], v[88:91], v[32:47]
    ds_read_b128 v[120:123], v17 offset:49152
    ds_read_b64_tr_b16 v[124:125], v18 offset:63488
    ds_read_b64_tr_b16 v[126:127], v18 offset:64000
    s_waitcnt lgkmcnt(9)
    v_mfma_f32_32x32x16_bf16 v[32:47], v[100:103], v[96:99], v[32:47]
    s_waitcnt lgkmcnt(6)
    v_mfma_f32_32x32x16_bf16 v[32:47], v[108:111], v[104:107], v[32:47]
    s_waitcnt lgkmcnt(3)
    v_mfma_f32_32x32x16_bf16 v[32:47], v[116:119], v[112:115], v[32:47]
    s_waitcnt lgkmcnt(0)
    v_mfma_f32_32x32x16_bf16 v[32:47], v[124:127], v[120:123], v[32:47]
    s_barrier
    ds_read_b32 v22, v21
    ds_read_b32 v23, v21 offset:256
    ds_read_b128 v[48:51], v20 offset:0
    ds_read_b128 v[52:55], v20 offset:32
    ds_read_b128 v[56:59], v20 offset:64
    ds_read_b128 v[60:63], v20 offset:96
    s_waitcnt lgkmcnt(4)
    v_mul_f32 v23, 0x3eb8aa3b, v23
    v_mul_f32 v22, v22, v23
    s_waitcnt lgkmcnt(0)
    v_mul_f32 v48, v48, v22
    v_mul_f32 v49, v49, v22
    v_mul_f32 v50, v50, v22
    v_mul_f32 v51, v51, v22
    v_mul_f32 v52, v52, v22
    v_mul_f32 v53, v53, v22
    v_mul_f32 v54, v54, v22
    v_mul_f32 v55, v55, v22
    v_mul_f32 v56, v56, v22
    v_mul_f32 v57, v57, v22
    v_mul_f32 v58, v58, v22
    v_mul_f32 v59, v59, v22
    v_mul_f32 v60, v60, v22
    v_mul_f32 v61, v61, v22
    v_mul_f32 v62, v62, v22
    v_mul_f32 v63, v63, v22
    v_fma_f32 v32, v32, v23, -v48
    v_fma_f32 v33, v33, v23, -v49
    v_fma_f32 v34, v34, v23, -v50
    v_fma_f32 v35, v35, v23, -v51
    v_fma_f32 v36, v36, v23, -v52
    v_fma_f32 v37, v37, v23, -v53
    v_fma_f32 v38, v38, v23, -v54
    v_fma_f32 v39, v39, v23, -v55
    v_fma_f32 v40, v40, v23, -v56
    v_fma_f32 v41, v41, v23, -v57
    v_fma_f32 v42, v42, v23, -v58
    v_fma_f32 v43, v43, v23, -v59
    v_fma_f32 v44, v44, v23, -v60
    v_fma_f32 v45, v45, v23, -v61
    v_fma_f32 v46, v46, v23, -v62
    v_fma_f32 v47, v47, v23, -v63
    v_cvt_pk_bf16_f32 v64, v32, v33
    v_cvt_pk_bf16_f32 v65, v34, v35
    v_cvt_pk_bf16_f32 v66, v36, v37
    v_cvt_pk_bf16_f32 v67, v38, v39
    v_cvt_pk_bf16_f32 v68, v40, v41
    v_cvt_pk_bf16_f32 v69, v42, v43
    v_cvt_pk_bf16_f32 v70, v44, v45
    v_cvt_pk_bf16_f32 v71, v46, v47
    buffer_store_dwordx4 v[64:67], v5, s[28:31], s38 offen sc1
    buffer_store_dwordx4 v[68:71], v5, s[28:31], s38 offen offset:1024 sc1
    s_endpgm
ka_help:
    s_lshr_b32 s44, s33, 1
    s_and_b32 s45, s35, 3
    v_and_b32 v8, 15, v1
    v_lshrrev_b32 v9, 4, v1
    s_lshl_b32 s36, s45, 12
    v_xor_b32 v6, v9, v8
    v_lshlrev_b32 v6, 4, v6
    v_lshl_add_u32 v6, v8, 8, v6
    v_add_u32 v10, s36, v6
    v_xor_b32 v11, 64, v10
    v_xor_b32 v12, 0x80, v10
    v_xor_b32 v13, 0xc0, v10
    v_bfe_u32 v6, v1, 2, 2
    v_lshl_add_u32 v6, v9, 3, v6
    v_lshlrev_b32 v14, 5, v6
    v_lshlrev_b32 v17, 7, v6
    v_and_b32 v6, 3, v1
    v_lshl_add_u32 v14, v6, 3, v14
    v_add_u32 v14, 131072, v14
    s_lshl_b32 s36, s45, 5
    v_bfe_u32 v6, v1, 3, 1
    v_lshlrev_b32 v6, 6, v6
    v_xor_b32 v6, s36, v6
    v_add_u32 v17, v17, v6
    v_and_b32 v6, 1, v1
    v_lshl_add_u32 v17, v6, 4, v17
    v_bfe_u32 v6, v1, 1, 1
    v_lshl_add_u32 v17, v6, 3, v17
    v_add_u32 v17, 65536, v17
    v_and_b32 v6, 16, v1
    v_lshlrev_b32 v6, 1, v6
    v_xor_b32 v17, v17, v6
    v_lshlrev_b32 v6, 2, v6
    v_xor_b32 v14, v14, v6
    v_xor_b32 v31, 0x80, v14
    s_lshl_b32 s36, s32, 1
    s_lshr_b32 s37, s44, 1
    s_add_u32 s36, s36, s37
    s_mul_i32 s38, s36, 2112
    s_add_u32 s38, s38, 2097152
    s_lshl_b32 s36, s45, 6
    s_add_u32 s36, s36, 147456
    v_lshl_add_u32 v18, v8, 2, s36
    s_and_b32 s37, s44, 1
    v_mov_b32 v20, 0x3f803f80
    v_mov_b32 v21, 0x3f803f80
    v_mov_b32 v22, 0x3f803f80
    v_mov_b32 v23, 0x3f803f80
    s_lshl_b32 s50, s32, 8
    s_add_u32 s50, s50, 2121728
    s_cmp_eq_u32 s33, 0
    s_cselect_b32 s50, s50, 0x40000000
    s_setprio 1
    s_xor_b32 s48, s44, 1
    s_cmp_eq_u32 s45, s48
    s_cbranch_scc1 ka_h3
    s_cmp_lg_u32 s45, s44
    s_cbranch_scc1 ka_h0
    s_bitcmp1_b32 s33, 0
    s_cbranch_scc1 ka_h2
ka_h1:
    s_lshl_b32 s37, s37, 8
    s_add_u32 s38, s38, s37
    v_lshrrev_b32 v6, 1, v9
    v_lshlrev_b32 v16, 9, v6
    v_lshl_add_u32 v16, v8, 4, v16
    v_and_b32 v6, 1, v9
    v_lshl_add_u32 v16, v6, 3, v16
    v_lshlrev_b32 v19, 4, v9
    v_add_u32 v19, 148224, v19
    s_barrier
    ds_read_b128 v[64:67], v10 offset:0
    ds_read_b64_tr_b16 v[68:69], v17 offset:0
    ds_read_b64_tr_b16 v[70:71], v17 offset:512
    ds_read_b64_tr_b16 v[72:73], v14 offset:0
    ds_read_b64_tr_b16 v[74:75], v31 offset:0
    ds_read_b128 v[76:79], v11 offset:0
    ds_read_b64_tr_b16 v[80:81], v17 offset:4096
    ds_read_b64_tr_b16 v[82:83], v17 offset:4608
    ds_read_b64_tr_b16 v[84:85], v14 offset:1024
    ds_read_b64_tr_b16 v[86:87], v31 offset:1024
    s_waitcnt lgkmcnt(5)
    v_mfma_f32_16x16x32_bf16 v[44:47], v[64:67], v[64:67], 0
    ds_read_b128 v[88:91], v12 offset:0
    ds_read_b64_tr_b16 v[92:93], v17 offset:8192
    ds_read_b64_tr_b16 v[94:95], v17 offset:8704
    ds_read_b64_tr_b16 v[96:97], v14 offset:2048
    ds_read_b64_tr_b16 v[98:99], v31 offset:2048
    v_mfma_f32_16x16x32_bf16 v[40:43], v[20:23], v[64:67], 0
    v_mfma_f32_16x16x32_bf16 v[48:51], v[20:23], v[68:71], 0
    v_mfma_f32_16x16x32_bf16 v[32:35], v[72:75], v[64:67], 0
    s_waitcnt lgkmcnt(5)
    v_mfma_f32_16x16x32_bf16 v[44:47], v[76:79], v[76:79], v[44:47]
    ds_read_b128 v[100:103], v13 offset:0
    ds_read_b64_tr_b16 v[104:105], v17 offset:12288
    ds_read_b64_tr_b16 v[106:107], v17 offset:12800
    ds_read_b64_tr_b16 v[108:109], v14 offset:3072
    ds_read_b64_tr_b16 v[110:111], v31 offset:3072
    v_mfma_f32_16x16x32_bf16 v[40:43], v[20:23], v[76:79], v[40:43]
    v_mfma_f32_16x16x32_bf16 v[48:51], v[20:23], v[80:83], v[48:51]
    v_mfma_f32_16x16x32_bf16 v[32:35], v[84:87], v[76:79], v[32:35]
    s_waitcnt lgkmcnt(5)
    v_mfma_f32_16x16x32_bf16 v[44:47], v[88:91], v[88:91], v[44:47]
    s_barrier
    ds_read_b128 v[64:67], v10 offset:16384
    ds_read_b64_tr_b16 v[68:69], v17 offset:16384
    ds_read_b64_tr_b16 v[70:71], v17 offset:16896
    ds_read_b64_tr_b16 v[72:73], v14 offset:4096
    ds_read_b64_tr_b16 v[74:75], v31 offset:4096
    v_mfma_f32_16x16x32_bf16 v[40:43], v[20:23], v[88:91], v[40:43]
    v_mfma_f32_16x16x32_bf16 v[48:51], v[20:23], v[92:95], v[48:51]
    v_mfma_f32_16x16x32_bf16 v[32:35], v[96:99], v[88:91], v[32:35]
    s_waitcnt lgkmcnt(5)
    v_mfma_f32_16x16x32_bf16 v[44:47], v[100:103], v[100:103], v[44:47]
    ds_read_b128 v[76:79], v11 offset:16384
    ds_read_b64_tr_b16 v[80:81], v17 offset:20480
    ds_read_b64_tr_b16 v[82:83], v17 offset:20992
    ds_read_b64_tr_b16 v[84:85], v14 offset:5120
    ds_read_b64_tr_b16 v[86:87], v31 offset:5120
    v_mfma_f32_16x16x32_bf16 v[40:43], v[20:23], v[100:103], v[40:43]
    v_mfma_f32_16x16x32_bf16 v[48:51], v[20:23], v[104:107], v[48:51]
    v_mfma_f32_16x16x32_bf16 v[32:35], v[108:111], v[100:103], v[32:35]
    s_waitcnt lgkmcnt(5)
    v_mfma_f32_16x16x32_bf16 v[44:47], v[64:67], v[64:67], v[44:47]
    ds_read_b128 v[88:91], v12 offset:16384
    ds_read_b64_tr_b16 v[92:93], v17 offset:24576
    ds_read_b64_tr_b16 v[94:95], v17 offset:25088
    ds_read_b64_tr_b16 v[96:97], v14 offset:6144
    ds_read_b64_tr_b16 v[98:99], v31 offset:6144
    v_mfma_f32_16x16x32_bf16 v[40:43], v[20:23], v[64:67], v[40:43]
    v_mfma_f32_16x16x32_bf16 v[48:51], v[20:23], v[68:71], v[48:51]
    v_mfma_f32_16x16x32_bf16 v[32:35], v[72:75], v[64:67], v[32:35]
    s_waitcnt lgkmcnt(5)
    v_mfma_f32_16x16x32_bf16 v[44:47], v[76:79], v[76:79], v[44:47]
    ds_read_b128 v[100:103], v13 offset:16384
    ds_read_b64_tr_b16 v[104:105], v17 offset:28672
    ds_read_b64_tr_b16 v[106:107], v17 offset:29184
    ds_read_b64_tr_b16 v[108:109], v14 offset:7168
    ds_read_b64_tr_b16 v[110:111], v31 offset:7168
    v_mfma_f32_16x16x32_bf16 v[40:43], v[20:23], v[76:79], v[40:43]
    v_mfma_f32_16x16x32_bf16 v[48:51], v[20:23], v[80:83], v[48:51]
    v_mfma_f32_16x16x32_bf16 v[32:35], v[84:87], v[76:79], v[32:35]
    s_waitcnt lgkmcnt(5)
    v_mfma_f32_16x16x32_bf16 v[44:47], v[88:91], v[88:91], v[44:47]
    s_barrier
    ds_read_b128 v[64:67], v10 offset:32768
    ds_read_b64_tr_b16 v[68:69], v17 offset:32768
    ds_read_b64_tr_b16 v[70:71], v17 offset:33280
    ds_read_b64_tr_b16 v[72:73], v14 offset:8192
    ds_read_b64_tr_b16 v[74:75], v31 offset:8192
    v_mfma_f32_16x16x32_bf16 v[40:43], v[20:23], v[88:91], v[40:43]
    v_mfma_f32_16x16x32_bf16 v[48:51], v[20:23], v[92:95], v[48:51]
    v_mfma_f32_16x16x32_bf16 v[32:35], v[96:99], v[88:91], v[32:35]
    s_waitcnt lgkmcnt(5)
    v_mfma_f32_16x16x32_bf16 v[44:47], v[100:103], v[100:103], v[44:47]
    ds_read_b128 v[76:79], v11 offset:32768
    ds_read_b64_tr_b16 v[80:81], v17 offset:36864
    ds_read_b64_tr_b16 v[82:83], v17 offset:37376
    ds_read_b64_tr_b16 v[84:85], v14 offset:9216
    ds_read_b64_tr_b16 v[86:87], v31 offset:9216
    v_mfma_f32_16x16x32_bf16 v[40:43], v[20:23], v[100:103], v[40:43]
    v_mfma_f32_16x16x32_bf16 v[48:51], v[20:23], v[104:107], v[48:51]
    v_mfma_f32_16x16x32_bf16 v[32:35], v[108:111], v[100:103], v[32:35]
    s_waitcnt lgkmcnt(5)
    v_mfma_f32_16x16x32_bf16 v[44:47], v[64:67], v[64:67], v[44:47]
    ds_read_b128 v[88:91], v12 offset:32768
    ds_read_b64_tr_b16 v[92:93], v17 offset:40960
    ds_read_b64_tr_b16 v[94:95], v17 offset:41472
    ds_read_b64_tr_b16 v[96:97], v14 offset:10240
    ds_read_b64_tr_b16 v[98:99], v31 offset:10240
    v_mfma_f32_16x16x32_bf16 v[40:43], v[20:23], v[64:67], v[40:43]
    v_mfma_f32_16x16x32_bf16 v[48:51], v[20:23], v[68:71], v[48:51]
    v_mfma_f32_16x16x32_bf16 v[32:35], v[72:75], v[64:67], v[32:35]
    s_waitcnt lgkmcnt(5)
    v_mfma_f32_16x16x32_bf16 v[44:47], v[76:79], v[76:79], v[44:47]
    ds_read_b128 v[100:103], v13 offset:32768
    ds_read_b64_tr_b16 v[104:105], v17 offset:45056
    ds_read_b64_tr_b16 v[106:107], v17 offset:45568
    ds_read_b64_tr_b16 v[108:109], v14 offset:11264
    ds_read_b64_tr_b16 v[110:111], v31 offset:11264
    v_mfma_f32_16x16x32_bf16 v[40:43], v[20:23], v[76:79], v[40:43]
    v_mfma_f32_16x16x32_bf16 v[48:51], v[20:23], v[80:83], v[48:51]
    v_mfma_f32_16x16x32_bf16 v[32:35], v[84:87], v[76:79], v[32:35]
    s_waitcnt lgkmcnt(5)
    v_mfma_f32_16x16x32_bf16 v[44:47], v[88:91], v[88:91], v[44:47]
    s_barrier
    ds_read_b128 v[64:67], v10 offset:49152
    ds_read_b64_tr_b16 v[68:69], v17 offset:49152
    ds_read_b64_tr_b16 v[70:71], v17 offset:49664
    ds_read_b64_tr_b16 v[72:73], v14 offset:12288
    ds_read_b64_tr_b16 v[74:75], v31 offset:12288
    v_mfma_f32_16x16x32_bf16 v[40:43], v[20:23], v[88:91], v[40:43]
    v_mfma_f32_16x16x32_bf16 v[48:51], v[20:23], v[92:95], v[48:51]
    v_mfma_f32_16x16x32_bf16 v[32:35], v[96:99], v[88:91], v[32:35]
    s_waitcnt lgkmcnt(5)
    v_mfma_f32_16x16x32_bf16 v[44:47], v[100:103], v[100:103], v[44:47]
    ds_read_b128 v[76:79], v11 offset:49152
    ds_read_b64_tr_b16 v[80:81], v17 offset:53248
    ds_read_b64_tr_b16 v[82:83], v17 offset:53760
    ds_read_b64_tr_b16 v[84:85], v14 offset:13312
    ds_read_b64_tr_b16 v[86:87], v31 offset:13312
    v_mfma_f32_16x16x32_bf16 v[40:43], v[20:23], v[100:103], v[40:43]
    v_mfma_f32_16x16x32_bf16 v[48:51], v[20:23], v[104:107], v[48:51]
    v_mfma_f32_16x16x32_bf16 v[32:35], v[108:111], v[100:103], v[32:35]
    s_waitcnt lgkmcnt(5)
    v_mfma_f32_16x16x32_bf16 v[44:47], v[64:67], v[64:67], v[44:47]
    ds_read_b128 v[88:91], v12 offset:49152
    ds_read_b64_tr_b16 v[92:93], v17 offset:57344
    ds_read_b64_tr_b16 v[94:95], v17 offset:57856
    ds_read_b64_tr_b16 v[96:97], v14 offset:14336
    ds_read_b64_tr_b16 v[98:99], v31 offset:14336
    v_mfma_f32_16x16x32_bf16 v[40:43], v[20:23], v[64:67], v[40:43]
    v_mfma_f32_16x16x32_bf16 v[48:51], v[20:23], v[68:71], v[48:51]
    v_mfma_f32_16x16x32_bf16 v[32:35], v[72:75], v[64:67], v[32:35]
    s_waitcnt lgkmcnt(5)
    v_mfma_f32_16x16x32_bf16 v[44:47], v[76:79], v[76:79], v[44:47]
    ds_read_b128 v[100:103], v13 offset:49152
    ds_read_b64_tr_b16 v[104:105], v17 offset:61440
    ds_read_b64_tr_b16 v[106:107], v17 offset:61952
    ds_read_b64_tr_b16 v[108:109], v14 offset:15360
    ds_read_b64_tr_b16 v[110:111], v31 offset:15360
    v_mfma_f32_16x16x32_bf16 v[40:43], v[20:23], v[76:79], v[40:43]
    v_mfma_f32_16x16x32_bf16 v[48:51], v[20:23], v[80:83], v[48:51]
    v_mfma_f32_16x16x32_bf16 v[32:35], v[84:87], v[76:79], v[32:35]
    s_waitcnt lgkmcnt(5)
    v_mfma_f32_16x16x32_bf16 v[44:47], v[88:91], v[88:91], v[44:47]
    v_mfma_f32_16x16x32_bf16 v[40:43], v[20:23], v[88:91], v[40:43]
    v_mfma_f32_16x16x32_bf16 v[48:51], v[20:23], v[92:95], v[48:51]
    v_mfma_f32_16x16x32_bf16 v[32:35], v[96:99], v[88:91], v[32:35]
    s_waitcnt lgkmcnt(0)
    v_mfma_f32_16x16x32_bf16 v[44:47], v[100:103], v[100:103], v[44:47]
    v_mfma_f32_16x16x32_bf16 v[40:43], v[20:23], v[100:103], v[40:43]
    v_mfma_f32_16x16x32_bf16 v[48:51], v[20:23], v[104:107], v[48:51]
    v_mfma_f32_16x16x32_bf16 v[32:35], v[108:111], v[100:103], v[32:35]
    s_nop 2
    s_mov_b32 exec_lo, 0x200002
    s_mov_b32 exec_hi, 0x20000200
    v_mov_b32 v44, v45
    s_mov_b32 exec_lo, 0x400004
    s_mov_b32 exec_hi, 0x40000400
    v_mov_b32 v44, v46
    s_mov_b32 exec_lo, 0x800008
    s_mov_b32 exec_hi, 0x80000800
    v_mov_b32 v44, v47
    s_mov_b32 exec_lo, 0x00f0000f
    s_mov_b32 exec_hi, 0xf0000f00
    v_mul_f32 v40, 0x3b000000, v40
    v_mul_f32 v44, 0x3b000000, v44
    v_fma_f32 v44, -v40, v40, v44
    v_max_f32 v44, 0, v44
    v_add_f32 v44, 0x3727c5ac, v44
    v_rsq_f32 v44, v44
    ds_write_b32 v18, v40
    ds_write_b32 v18, v48 offset:512
    ds_write_b32 v18, v44 offset:256
    buffer_store_dword v40, v18, s[28:31], s50 offen sc1
    s_mov_b64 exec, -1
    s_waitcnt lgkmcnt(0)
    s_barrier
    ds_read_b32 v40, v18
    ds_read_b32 v44, v18 offset:256
    ds_read_b128 v[36:39], v19
    s_waitcnt lgkmcnt(0)
    v_fma_f32 v32, -v36, v40, v32
    v_fma_f32 v33, -v37, v40, v33
    v_fma_f32 v34, -v38, v40, v34
    v_fma_f32 v35, -v39, v40, v35
    v_mul_f32 v32, v32, v44
    v_mul_f32 v33, v33, v44
    v_mul_f32 v34, v34, v44
    v_mul_f32 v35, v35, v44
    v_cvt_pk_bf16_f32 v48, v32, v33
    v_cvt_pk_bf16_f32 v50, v32, v33
    v_cvt_pk_bf16_f32 v49, v34, v35
    v_cvt_pk_bf16_f32 v51, v34, v35
    v_permlane16_swap_b32 v48, v50
    s_nop 0
    v_permlane16_swap_b32 v49, v51
    s_mov_b32 exec_lo, 0xffff
    s_mov_b32 exec_hi, 0xffff
    buffer_store_dwordx4 v[48:51], v16, s[28:31], s38 offen offset:0 sc1
    s_mov_b64 exec, -1
    s_endpgm
.p2align 12
ka_h2:
    v_lshl_add_u32 v15, v9, 4, s36
    s_mul_i32 s37, s37, 544
    s_add_u32 s38, s38, s37
    v_lshrrev_b32 v6, 1, v9
    v_lshlrev_b32 v16, 8, v6
    v_lshl_add_u32 v16, v8, 4, v16
    v_and_b32 v6, 1, v9
    v_lshl_add_u32 v16, v6, 3, v16
    v_lshlrev_b32 v19, 2, v8
    v_add_u32 v19, 148224, v19
    s_barrier
    ds_read_b128 v[64:67], v10 offset:0
    ds_read_b64_tr_b16 v[68:69], v17 offset:0
    ds_read_b64_tr_b16 v[70:71], v17 offset:512
    ds_read_b64_tr_b16 v[72:73], v14 offset:0
    ds_read_b64_tr_b16 v[74:75], v31 offset:0
    ds_read_b128 v[76:79], v11 offset:0
    ds_read_b64_tr_b16 v[80:81], v17 offset:4096
    ds_read_b64_tr_b16 v[82:83], v17 offset:4608
    ds_read_b64_tr_b16 v[84:85], v14 offset:1024
    ds_read_b64_tr_b16 v[86:87], v31 offset:1024
    s_waitcnt lgkmcnt(5)
    v_mfma_f32_16x16x32_bf16 v[44:47], v[64:67], v[64:67], 0
    ds_read_b128 v[88:91], v12 offset:0
    ds_read_b64_tr_b16 v[92:93], v17 offset:8192
    ds_read_b64_tr_b16 v[94:95], v17 offset:8704
    ds_read_b64_tr_b16 v[96:97], v14 offset:2048
    ds_read_b64_tr_b16 v[98:99], v31 offset:2048
    v_mfma_f32_16x16x32_bf16 v[40:43], v[20:23], v[64:67], 0
    v_mfma_f32_16x16x32_bf16 v[48:51], v[20:23], v[68:71], 0
    v_mfma_f32_16x16x32_bf16 v[32:35], v[64:67], v[72:75], 0
    s_waitcnt lgkmcnt(5)
    v_mfma_f32_16x16x32_bf16 v[44:47], v[76:79], v[76:79], v[44:47]
    ds_read_b128 v[100:103], v13 offset:0
    ds_read_b64_tr_b16 v[104:105], v17 offset:12288
    ds_read_b64_tr_b16 v[106:107], v17 offset:12800
    ds_read_b64_tr_b16 v[108:109], v14 offset:3072
    ds_read_b64_tr_b16 v[110:111], v31 offset:3072
    v_mfma_f32_16x16x32_bf16 v[40:43], v[20:23], v[76:79], v[40:43]
    v_mfma_f32_16x16x32_bf16 v[48:51], v[20:23], v[80:83], v[48:51]
    v_mfma_f32_16x16x32_bf16 v[32:35], v[76:79], v[84:87], v[32:35]
    s_waitcnt lgkmcnt(5)
    v_mfma_f32_16x16x32_bf16 v[44:47], v[88:91], v[88:91], v[44:47]
    s_barrier
    ds_read_b128 v[64:67], v10 offset:16384
    ds_read_b64_tr_b16 v[68:69], v17 offset:16384
    ds_read_b64_tr_b16 v[70:71], v17 offset:16896
    ds_read_b64_tr_b16 v[72:73], v14 offset:4096
    ds_read_b64_tr_b16 v[74:75], v31 offset:4096
    v_mfma_f32_16x16x32_bf16 v[40:43], v[20:23], v[88:91], v[40:43]
    v_mfma_f32_16x16x32_bf16 v[48:51], v[20:23], v[92:95], v[48:51]
    v_mfma_f32_16x16x32_bf16 v[32:35], v[88:91], v[96:99], v[32:35]
    s_waitcnt lgkmcnt(5)
    v_mfma_f32_16x16x32_bf16 v[44:47], v[100:103], v[100:103], v[44:47]
    ds_read_b128 v[76:79], v11 offset:16384
    ds_read_b64_tr_b16 v[80:81], v17 offset:20480
    ds_read_b64_tr_b16 v[82:83], v17 offset:20992
    ds_read_b64_tr_b16 v[84:85], v14 offset:5120
    ds_read_b64_tr_b16 v[86:87], v31 offset:5120
    v_mfma_f32_16x16x32_bf16 v[40:43], v[20:23], v[100:103], v[40:43]
    v_mfma_f32_16x16x32_bf16 v[48:51], v[20:23], v[104:107], v[48:51]
    v_mfma_f32_16x16x32_bf16 v[32:35], v[100:103], v[108:111], v[32:35]
    s_waitcnt lgkmcnt(5)
    v_mfma_f32_16x16x32_bf16 v[44:47], v[64:67], v[64:67], v[44:47]
    ds_read_b128 v[88:91], v12 offset:16384
    ds_read_b64_tr_b16 v[92:93], v17 offset:24576
    ds_read_b64_tr_b16 v[94:95], v17 offset:25088
    ds_read_b64_tr_b16 v[96:97], v14 offset:6144
    ds_read_b64_tr_b16 v[98:99], v31 offset:6144
    v_mfma_f32_16x16x32_bf16 v[40:43], v[20:23], v[64:67], v[40:43]
    v_mfma_f32_16x16x32_bf16 v[48:51], v[20:23], v[68:71], v[48:51]
    v_mfma_f32_16x16x32_bf16 v[32:35], v[64:67], v[72:75], v[32:35]
    s_waitcnt lgkmcnt(5)
    v_mfma_f32_16x16x32_bf16 v[44:47], v[76:79], v[76:79], v[44:47]
    ds_read_b128 v[100:103], v13 offset:16384
    ds_read_b64_tr_b16 v[104:105], v17 offset:28672
    ds_read_b64_tr_b16 v[106:107], v17 offset:29184
    ds_read_b64_tr_b16 v[108:109], v14 offset:7168
    ds_read_b64_tr_b16 v[110:111], v31 offset:7168
    v_mfma_f32_16x16x32_bf16 v[40:43], v[20:23], v[76:79], v[40:43]
    v_mfma_f32_16x16x32_bf16 v[48:51], v[20:23], v[80:83], v[48:51]
    v_mfma_f32_16x16x32_bf16 v[32:35], v[76:79], v[84:87], v[32:35]
    s_waitcnt lgkmcnt(5)
    v_mfma_f32_16x16x32_bf16 v[44:47], v[88:91], v[88:91], v[44:47]
    s_barrier
    ds_read_b128 v[64:67], v10 offset:32768
    ds_read_b64_tr_b16 v[68:69], v17 offset:32768
    ds_read_b64_tr_b16 v[70:71], v17 offset:33280
    ds_read_b64_tr_b16 v[72:73], v14 offset:8192
    ds_read_b64_tr_b16 v[74:75], v31 offset:8192
    v_mfma_f32_16x16x32_bf16 v[40:43], v[20:23], v[88:91], v[40:43]
    v_mfma_f32_16x16x32_bf16 v[48:51], v[20:23], v[92:95], v[48:51]
    v_mfma_f32_16x16x32_bf16 v[32:35], v[88:91], v[96:99], v[32:35]
    s_waitcnt lgkmcnt(5)
    v_mfma_f32_16x16x32_bf16 v[44:47], v[100:103], v[100:103], v[44:47]
    ds_read_b128 v[76:79], v11 offset:32768
    ds_read_b64_tr_b16 v[80:81], v17 offset:36864
    ds_read_b64_tr_b16 v[82:83], v17 offset:37376
    ds_read_b64_tr_b16 v[84:85], v14 offset:9216
    ds_read_b64_tr_b16 v[86:87], v31 offset:9216
    v_mfma_f32_16x16x32_bf16 v[40:43], v[20:23], v[100:103], v[40:43]
    v_mfma_f32_16x16x32_bf16 v[48:51], v[20:23], v[104:107], v[48:51]
    v_mfma_f32_16x16x32_bf16 v[32:35], v[100:103], v[108:111], v[32:35]
    s_waitcnt lgkmcnt(5)
    v_mfma_f32_16x16x32_bf16 v[44:47], v[64:67], v[64:67], v[44:47]
    ds_read_b128 v[88:91], v12 offset:32768
    ds_read_b64_tr_b16 v[92:93], v17 offset:40960
    ds_read_b64_tr_b16 v[94:95], v17 offset:41472
    ds_read_b64_tr_b16 v[96:97], v14 offset:10240
    ds_read_b64_tr_b16 v[98:99], v31 offset:10240
    v_mfma_f32_16x16x32_bf16 v[40:43], v[20:23], v[64:67], v[40:43]
    v_mfma_f32_16x16x32_bf16 v[48:51], v[20:23], v[68:71], v[48:51]
    v_mfma_f32_16x16x32_bf16 v[32:35], v[64:67], v[72:75], v[32:35]
    s_waitcnt lgkmcnt(5)
    v_mfma_f32_16x16x32_bf16 v[44:47], v[76:79], v[76:79], v[44:47]
    ds_read_b128 v[100:103], v13 offset:32768
    ds_read_b64_tr_b16 v[104:105], v17 offset:45056
    ds_read_b64_tr_b16 v[106:107], v17 offset:45568
    ds_read_b64_tr_b16 v[108:109], v14 offset:11264
    ds_read_b64_tr_b16 v[110:111], v31 offset:11264
    v_mfma_f32_16x16x32_bf16 v[40:43], v[20:23], v[76:79], v[40:43]
    v_mfma_f32_16x16x32_bf16 v[48:51], v[20:23], v[80:83], v[48:51]
    v_mfma_f32_16x16x32_bf16 v[32:35], v[76:79], v[84:87], v[32:35]
    s_waitcnt lgkmcnt(5)
    v_mfma_f32_16x16x32_bf16 v[44:47], v[88:91], v[88:91], v[44:47]
    s_barrier
    ds_read_b128 v[64:67], v10 offset:49152
    ds_read_b64_tr_b16 v[68:69], v17 offset:49152
    ds_read_b64_tr_b16 v[70:71], v17 offset:49664
    ds_read_b64_tr_b16 v[72:73], v14 offset:12288
    ds_read_b64_tr_b16 v[74:75], v31 offset:12288
    v_mfma_f32_16x16x32_bf16 v[40:43], v[20:23], v[88:91], v[40:43]
    v_mfma_f32_16x16x32_bf16 v[48:51], v[20:23], v[92:95], v[48:51]
    v_mfma_f32_16x16x32_bf16 v[32:35], v[88:91], v[96:99], v[32:35]
    s_waitcnt lgkmcnt(5)
    v_mfma_f32_16x16x32_bf16 v[44:47], v[100:103], v[100:103], v[44:47]
    ds_read_b128 v[76:79], v11 offset:49152
    ds_read_b64_tr_b16 v[80:81], v17 offset:53248
    ds_read_b64_tr_b16 v[82:83], v17 offset:53760
    ds_read_b64_tr_b16 v[84:85], v14 offset:13312
    ds_read_b64_tr_b16 v[86:87], v31 offset:13312
    v_mfma_f32_16x16x32_bf16 v[40:43], v[20:23], v[100:103], v[40:43]
    v_mfma_f32_16x16x32_bf16 v[48:51], v[20:23], v[104:107], v[48:51]
    v_mfma_f32_16x16x32_bf16 v[32:35], v[100:103], v[108:111], v[32:35]
    s_waitcnt lgkmcnt(5)
    v_mfma_f32_16x16x32_bf16 v[44:47], v[64:67], v[64:67], v[44:47]
    ds_read_b128 v[88:91], v12 offset:49152
    ds_read_b64_tr_b16 v[92:93], v17 offset:57344
    ds_read_b64_tr_b16 v[94:95], v17 offset:57856
    ds_read_b64_tr_b16 v[96:97], v14 offset:14336
    ds_read_b64_tr_b16 v[98:99], v31 offset:14336
    v_mfma_f32_16x16x32_bf16 v[40:43], v[20:23], v[64:67], v[40:43]
    v_mfma_f32_16x16x32_bf16 v[48:51], v[20:23], v[68:71], v[48:51]
    v_mfma_f32_16x16x32_bf16 v[32:35], v[64:67], v[72:75], v[32:35]
    s_waitcnt lgkmcnt(5)
    v_mfma_f32_16x16x32_bf16 v[44:47], v[76:79], v[76:79], v[44:47]
    ds_read_b128 v[100:103], v13 offset:49152
    ds_read_b64_tr_b16 v[104:105], v17 offset:61440
    ds_read_b64_tr_b16 v[106:107], v17 offset:61952
    ds_read_b64_tr_b16 v[108:109], v14 offset:15360
    ds_read_b64_tr_b16 v[110:111], v31 offset:15360
    v_mfma_f32_16x16x32_bf16 v[40:43], v[20:23], v[76:79], v[40:43]
    v_mfma_f32_16x16x32_bf16 v[48:51], v[20:23], v[80:83], v[48:51]
    v_mfma_f32_16x16x32_bf16 v[32:35], v[76:79], v[84:87], v[32:35]
    s_waitcnt lgkmcnt(5)
    v_mfma_f32_16x16x32_bf16 v[44:47], v[88:91], v[88:91], v[44:47]
    v_mfma_f32_16x16x32_bf16 v[40:43], v[20:23], v[88:91], v[40:43]
    v_mfma_f32_16x16x32_bf16 v[48:51], v[20:23], v[92:95], v[48:51]
    v_mfma_f32_16x16x32_bf16 v[32:35], v[88:91], v[96:99], v[32:35]
    s_waitcnt lgkmcnt(0)
    v_mfma_f32_16x16x32_bf16 v[44:47], v[100:103], v[100:103], v[44:47]
    v_mfma_f32_16x16x32_bf16 v[40:43], v[20:23], v[100:103], v[40:43]
    v_mfma_f32_16x16x32_bf16 v[48:51], v[20:23], v[104:107], v[48:51]
    v_mfma_f32_16x16x32_bf16 v[32:35], v[100:103], v[108:111], v[32:35]
    s_nop 2
    s_mov_b32 exec_lo, 0x200002
    s_mov_b32 exec_hi, 0x20000200
    v_mov_b32 v44, v45
    s_mov_b32 exec_lo, 0x400004
    s_mov_b32 exec_hi, 0x40000400
    v_mov_b32 v44, v46
    s_mov_b32 exec_lo, 0x800008
    s_mov_b32 exec_hi, 0x80000800
    v_mov_b32 v44, v47
    s_mov_b32 exec_lo, 0x00f0000f
    s_mov_b32 exec_hi, 0xf0000f00
    v_mul_f32 v40, 0x3b000000, v40
    v_mul_f32 v44, 0x3b000000, v44
    v_fma_f32 v44, -v40, v40, v44
    v_max_f32 v44, 0, v44
    v_add_f32 v44, 0x3727c5ac, v44
    v_rsq_f32 v44, v44
    ds_write_b32 v18, v40
    ds_write_b32 v18, v48 offset:512
    ds_write_b32 v18, v44 offset:256
    buffer_store_dword v40, v18, s[28:31], s50 offen sc1
    s_mov_b64 exec, -1
    s_waitcnt lgkmcnt(0)
    s_barrier
    ds_read_b128 v[40:43], v15
    ds_read_b128 v[44:47], v15 offset:256
    ds_read_b32 v36, v19
    s_waitcnt lgkmcnt(0)
    v_fma_f32 v32, -v36, v40, v32
    v_fma_f32 v33, -v36, v41, v33
    v_fma_f32 v34, -v36, v42, v34
    v_fma_f32 v35, -v36, v43, v35
    v_mul_f32 v32, v32, v44
    v_mul_f32 v33, v33, v45
    v_mul_f32 v34, v34, v46
    v_mul_f32 v35, v35, v47
    v_cvt_pk_bf16_f32 v48, v32, v33
    v_cvt_pk_bf16_f32 v50, v32, v33
    v_cvt_pk_bf16_f32 v49, v34, v35
    v_cvt_pk_bf16_f32 v51, v34, v35
    v_permlane16_swap_b32 v48, v50
    s_nop 0
    v_permlane16_swap_b32 v49, v51
    s_mov_b32 exec_lo, 0xffff
    s_mov_b32 exec_hi, 0xffff
    buffer_store_dwordx4 v[48:51], v16, s[28:31], s38 offen offset:1024 sc1
    s_mov_b64 exec, -1
    s_mov_b64 exec, 2
    v_mov_b32 v20, 0
    v_mov_b32 v21, 0
    v_mov_b32 v22, 0
    v_mov_b32 v23, 0
    s_mov_b64 exec, 3
    buffer_store_dwordx4 v[20:23], v16, s[28:31], s38 offen offset:1536 sc1
    s_mov_b64 exec, -1
    s_endpgm
ka_h3:
    v_lshlrev_b32 v19, 2, v8
    v_add_u32 v19, 148224, v19
    s_barrier
    ds_read_b128 v[64:67], v10 offset:0
    ds_read_b64_tr_b16 v[68:69], v17 offset:0
    ds_read_b64_tr_b16 v[70:71], v17 offset:512
    ds_read_b64_tr_b16 v[72:73], v14 offset:0
    ds_read_b64_tr_b16 v[74:75], v31 offset:0
    ds_read_b128 v[76:79], v11 offset:0
    ds_read_b64_tr_b16 v[80:81], v17 offset:4096
    ds_read_b64_tr_b16 v[82:83], v17 offset:4608
    ds_read_b64_tr_b16 v[84:85], v14 offset:1024
    ds_read_b64_tr_b16 v[86:87], v31 offset:1024
    s_waitcnt lgkmcnt(5)
    v_mfma_f32_16x16x32_bf16 v[44:47], v[64:67], v[64:67], 0
    ds_read_b128 v[88:91], v12 offset:0
    ds_read_b64_tr_b16 v[92:93], v17 offset:8192
    ds_read_b64_tr_b16 v[94:95], v17 offset:8704
    ds_read_b64_tr_b16 v[96:97], v14 offset:2048
    ds_read_b64_tr_b16 v[98:99], v31 offset:2048
    v_mfma_f32_16x16x32_bf16 v[40:43], v[20:23], v[64:67], 0
    v_mfma_f32_16x16x32_bf16 v[48:51], v[20:23], v[68:71], 0
    v_mfma_f32_16x16x32_bf16 v[32:35], v[20:23], v[72:75], 0
    s_waitcnt lgkmcnt(5)
    v_mfma_f32_16x16x32_bf16 v[44:47], v[76:79], v[76:79], v[44:47]
    ds_read_b128 v[100:103], v13 offset:0
    ds_read_b64_tr_b16 v[104:105], v17 offset:12288
    ds_read_b64_tr_b16 v[106:107], v17 offset:12800
    ds_read_b64_tr_b16 v[108:109], v14 offset:3072
    ds_read_b64_tr_b16 v[110:111], v31 offset:3072
    v_mfma_f32_16x16x32_bf16 v[40:43], v[20:23], v[76:79], v[40:43]
    v_mfma_f32_16x16x32_bf16 v[48:51], v[20:23], v[80:83], v[48:51]
    v_mfma_f32_16x16x32_bf16 v[32:35], v[20:23], v[84:87], v[32:35]
    s_waitcnt lgkmcnt(5)
    v_mfma_f32_16x16x32_bf16 v[44:47], v[88:91], v[88:91], v[44:47]
    s_barrier
    ds_read_b128 v[64:67], v10 offset:16384
    ds_read_b64_tr_b16 v[68:69], v17 offset:16384
    ds_read_b64_tr_b16 v[70:71], v17 offset:16896
    ds_read_b64_tr_b16 v[72:73], v14 offset:4096
    ds_read_b64_tr_b16 v[74:75], v31 offset:4096
    v_mfma_f32_16x16x32_bf16 v[40:43], v[20:23], v[88:91], v[40:43]
    v_mfma_f32_16x16x32_bf16 v[48:51], v[20:23], v[92:95], v[48:51]
    v_mfma_f32_16x16x32_bf16 v[32:35], v[20:23], v[96:99], v[32:35]
    s_waitcnt lgkmcnt(5)
    v_mfma_f32_16x16x32_bf16 v[44:47], v[100:103], v[100:103], v[44:47]
    ds_read_b128 v[76:79], v11 offset:16384
    ds_read_b64_tr_b16 v[80:81], v17 offset:20480
    ds_read_b64_tr_b16 v[82:83], v17 offset:20992
    ds_read_b64_tr_b16 v[84:85], v14 offset:5120
    ds_read_b64_tr_b16 v[86:87], v31 offset:5120
    v_mfma_f32_16x16x32_bf16 v[40:43], v[20:23], v[100:103], v[40:43]
    v_mfma_f32_16x16x32_bf16 v[48:51], v[20:23], v[104:107], v[48:51]
    v_mfma_f32_16x16x32_bf16 v[32:35], v[20:23], v[108:111], v[32:35]
    s_waitcnt lgkmcnt(5)
    v_mfma_f32_16x16x32_bf16 v[44:47], v[64:67], v[64:67], v[44:47]
    ds_read_b128 v[88:91], v12 offset:16384
    ds_read_b64_tr_b16 v[92:93], v17 offset:24576
    ds_read_b64_tr_b16 v[94:95], v17 offset:25088
    ds_read_b64_tr_b16 v[96:97], v14 offset:6144
    ds_read_b64_tr_b16 v[98:99], v31 offset:6144
    v_mfma_f32_16x16x32_bf16 v[40:43], v[20:23], v[64:67], v[40:43]
    v_mfma_f32_16x16x32_bf16 v[48:51], v[20:23], v[68:71], v[48:51]
    v_mfma_f32_16x16x32_bf16 v[32:35], v[20:23], v[72:75], v[32:35]
    s_waitcnt lgkmcnt(5)
    v_mfma_f32_16x16x32_bf16 v[44:47], v[76:79], v[76:79], v[44:47]
    ds_read_b128 v[100:103], v13 offset:16384
    ds_read_b64_tr_b16 v[104:105], v17 offset:28672
    ds_read_b64_tr_b16 v[106:107], v17 offset:29184
    ds_read_b64_tr_b16 v[108:109], v14 offset:7168
    ds_read_b64_tr_b16 v[110:111], v31 offset:7168
    v_mfma_f32_16x16x32_bf16 v[40:43], v[20:23], v[76:79], v[40:43]
    v_mfma_f32_16x16x32_bf16 v[48:51], v[20:23], v[80:83], v[48:51]
    v_mfma_f32_16x16x32_bf16 v[32:35], v[20:23], v[84:87], v[32:35]
    s_waitcnt lgkmcnt(5)
    v_mfma_f32_16x16x32_bf16 v[44:47], v[88:91], v[88:91], v[44:47]
    s_barrier
    ds_read_b128 v[64:67], v10 offset:32768
    ds_read_b64_tr_b16 v[68:69], v17 offset:32768
    ds_read_b64_tr_b16 v[70:71], v17 offset:33280
    ds_read_b64_tr_b16 v[72:73], v14 offset:8192
    ds_read_b64_tr_b16 v[74:75], v31 offset:8192
    v_mfma_f32_16x16x32_bf16 v[40:43], v[20:23], v[88:91], v[40:43]
    v_mfma_f32_16x16x32_bf16 v[48:51], v[20:23], v[92:95], v[48:51]
    v_mfma_f32_16x16x32_bf16 v[32:35], v[20:23], v[96:99], v[32:35]
    s_waitcnt lgkmcnt(5)
    v_mfma_f32_16x16x32_bf16 v[44:47], v[100:103], v[100:103], v[44:47]
    ds_read_b128 v[76:79], v11 offset:32768
    ds_read_b64_tr_b16 v[80:81], v17 offset:36864
    ds_read_b64_tr_b16 v[82:83], v17 offset:37376
    ds_read_b64_tr_b16 v[84:85], v14 offset:9216
    ds_read_b64_tr_b16 v[86:87], v31 offset:9216
    v_mfma_f32_16x16x32_bf16 v[40:43], v[20:23], v[100:103], v[40:43]
    v_mfma_f32_16x16x32_bf16 v[48:51], v[20:23], v[104:107], v[48:51]
    v_mfma_f32_16x16x32_bf16 v[32:35], v[20:23], v[108:111], v[32:35]
    s_waitcnt lgkmcnt(5)
    v_mfma_f32_16x16x32_bf16 v[44:47], v[64:67], v[64:67], v[44:47]
    ds_read_b128 v[88:91], v12 offset:32768
    ds_read_b64_tr_b16 v[92:93], v17 offset:40960
    ds_read_b64_tr_b16 v[94:95], v17 offset:41472
    ds_read_b64_tr_b16 v[96:97], v14 offset:10240
    ds_read_b64_tr_b16 v[98:99], v31 offset:10240
    v_mfma_f32_16x16x32_bf16 v[40:43], v[20:23], v[64:67], v[40:43]
    v_mfma_f32_16x16x32_bf16 v[48:51], v[20:23], v[68:71], v[48:51]
    v_mfma_f32_16x16x32_bf16 v[32:35], v[20:23], v[72:75], v[32:35]
    s_waitcnt lgkmcnt(5)
    v_mfma_f32_16x16x32_bf16 v[44:47], v[76:79], v[76:79], v[44:47]
    ds_read_b128 v[100:103], v13 offset:32768
    ds_read_b64_tr_b16 v[104:105], v17 offset:45056
    ds_read_b64_tr_b16 v[106:107], v17 offset:45568
    ds_read_b64_tr_b16 v[108:109], v14 offset:11264
    ds_read_b64_tr_b16 v[110:111], v31 offset:11264
    v_mfma_f32_16x16x32_bf16 v[40:43], v[20:23], v[76:79], v[40:43]
    v_mfma_f32_16x16x32_bf16 v[48:51], v[20:23], v[80:83], v[48:51]
    v_mfma_f32_16x16x32_bf16 v[32:35], v[20:23], v[84:87], v[32:35]
    s_waitcnt lgkmcnt(5)
    v_mfma_f32_16x16x32_bf16 v[44:47], v[88:91], v[88:91], v[44:47]
    s_barrier
    ds_read_b128 v[64:67], v10 offset:49152
    ds_read_b64_tr_b16 v[68:69], v17 offset:49152
    ds_read_b64_tr_b16 v[70:71], v17 offset:49664
    ds_read_b64_tr_b16 v[72:73], v14 offset:12288
    ds_read_b64_tr_b16 v[74:75], v31 offset:12288
    v_mfma_f32_16x16x32_bf16 v[40:43], v[20:23], v[88:91], v[40:43]
    v_mfma_f32_16x16x32_bf16 v[48:51], v[20:23], v[92:95], v[48:51]
    v_mfma_f32_16x16x32_bf16 v[32:35], v[20:23], v[96:99], v[32:35]
    s_waitcnt lgkmcnt(5)
    v_mfma_f32_16x16x32_bf16 v[44:47], v[100:103], v[100:103], v[44:47]
    ds_read_b128 v[76:79], v11 offset:49152
    ds_read_b64_tr_b16 v[80:81], v17 offset:53248
    ds_read_b64_tr_b16 v[82:83], v17 offset:53760
    ds_read_b64_tr_b16 v[84:85], v14 offset:13312
    ds_read_b64_tr_b16 v[86:87], v31 offset:13312
    v_mfma_f32_16x16x32_bf16 v[40:43], v[20:23], v[100:103], v[40:43]
    v_mfma_f32_16x16x32_bf16 v[48:51], v[20:23], v[104:107], v[48:51]
    v_mfma_f32_16x16x32_bf16 v[32:35], v[20:23], v[108:111], v[32:35]
    s_waitcnt lgkmcnt(5)
    v_mfma_f32_16x16x32_bf16 v[44:47], v[64:67], v[64:67], v[44:47]
    ds_read_b128 v[88:91], v12 offset:49152
    ds_read_b64_tr_b16 v[92:93], v17 offset:57344
    ds_read_b64_tr_b16 v[94:95], v17 offset:57856
    ds_read_b64_tr_b16 v[96:97], v14 offset:14336
    ds_read_b64_tr_b16 v[98:99], v31 offset:14336
    v_mfma_f32_16x16x32_bf16 v[40:43], v[20:23], v[64:67], v[40:43]
    v_mfma_f32_16x16x32_bf16 v[48:51], v[20:23], v[68:71], v[48:51]
    v_mfma_f32_16x16x32_bf16 v[32:35], v[20:23], v[72:75], v[32:35]
    s_waitcnt lgkmcnt(5)
    v_mfma_f32_16x16x32_bf16 v[44:47], v[76:79], v[76:79], v[44:47]
    ds_read_b128 v[100:103], v13 offset:49152
    ds_read_b64_tr_b16 v[104:105], v17 offset:61440
    ds_read_b64_tr_b16 v[106:107], v17 offset:61952
    ds_read_b64_tr_b16 v[108:109], v14 offset:15360
    ds_read_b64_tr_b16 v[110:111], v31 offset:15360
    v_mfma_f32_16x16x32_bf16 v[40:43], v[20:23], v[76:79], v[40:43]
    v_mfma_f32_16x16x32_bf16 v[48:51], v[20:23], v[80:83], v[48:51]
    v_mfma_f32_16x16x32_bf16 v[32:35], v[20:23], v[84:87], v[32:35]
    s_waitcnt lgkmcnt(5)
    v_mfma_f32_16x16x32_bf16 v[44:47], v[88:91], v[88:91], v[44:47]
    v_mfma_f32_16x16x32_bf16 v[40:43], v[20:23], v[88:91], v[40:43]
    v_mfma_f32_16x16x32_bf16 v[48:51], v[20:23], v[92:95], v[48:51]
    v_mfma_f32_16x16x32_bf16 v[32:35], v[20:23], v[96:99], v[32:35]
    s_waitcnt lgkmcnt(0)
    v_mfma_f32_16x16x32_bf16 v[44:47], v[100:103], v[100:103], v[44:47]
    v_mfma_f32_16x16x32_bf16 v[40:43], v[20:23], v[100:103], v[40:43]
    v_mfma_f32_16x16x32_bf16 v[48:51], v[20:23], v[104:107], v[48:51]
    v_mfma_f32_16x16x32_bf16 v[32:35], v[20:23], v[108:111], v[32:35]
    s_nop 2
    s_mov_b32 exec_lo, 0x200002
    s_mov_b32 exec_hi, 0x20000200
    v_mov_b32 v44, v45
    s_mov_b32 exec_lo, 0x400004
    s_mov_b32 exec_hi, 0x40000400
    v_mov_b32 v44, v46
    s_mov_b32 exec_lo, 0x800008
    s_mov_b32 exec_hi, 0x80000800
    v_mov_b32 v44, v47
    s_mov_b32 exec_lo, 0x00f0000f
    s_mov_b32 exec_hi, 0xf0000f00
    v_mul_f32 v40, 0x3b000000, v40
    v_mul_f32 v44, 0x3b000000, v44
    v_fma_f32 v44, -v40, v40, v44
    v_max_f32 v44, 0, v44
    v_add_f32 v44, 0x3727c5ac, v44
    v_rsq_f32 v44, v44
    ds_write_b32 v18, v40
    ds_write_b32 v18, v48 offset:512
    ds_write_b32 v19, v32
    ds_write_b32 v18, v44 offset:256
    buffer_store_dword v40, v18, s[28:31], s50 offen sc1
    s_mov_b64 exec, -1
    s_waitcnt lgkmcnt(0)
    s_barrier
    s_endpgm
ka_h0:
    s_barrier
    ds_read_b128 v[64:67], v10 offset:0
    ds_read_b64_tr_b16 v[68:69], v17 offset:0
    ds_read_b64_tr_b16 v[70:71], v17 offset:512
    ds_read_b128 v[76:79], v11 offset:0
    ds_read_b64_tr_b16 v[80:81], v17 offset:4096
    ds_read_b64_tr_b16 v[82:83], v17 offset:4608
    s_waitcnt lgkmcnt(3)
    v_mfma_f32_16x16x32_bf16 v[44:47], v[64:67], v[64:67], 0
    ds_read_b128 v[88:91], v12 offset:0
    ds_read_b64_tr_b16 v[92:93], v17 offset:8192
    ds_read_b64_tr_b16 v[94:95], v17 offset:8704
    v_mfma_f32_16x16x32_bf16 v[40:43], v[20:23], v[64:67], 0
    v_mfma_f32_16x16x32_bf16 v[48:51], v[20:23], v[68:71], 0
    s_waitcnt lgkmcnt(3)
    v_mfma_f32_16x16x32_bf16 v[44:47], v[76:79], v[76:79], v[44:47]
    ds_read_b128 v[100:103], v13 offset:0
    ds_read_b64_tr_b16 v[104:105], v17 offset:12288
    ds_read_b64_tr_b16 v[106:107], v17 offset:12800
    v_mfma_f32_16x16x32_bf16 v[40:43], v[20:23], v[76:79], v[40:43]
    v_mfma_f32_16x16x32_bf16 v[48:51], v[20:23], v[80:83], v[48:51]
    s_waitcnt lgkmcnt(3)
    v_mfma_f32_16x16x32_bf16 v[44:47], v[88:91], v[88:91], v[44:47]
    s_barrier
    ds_read_b128 v[64:67], v10 offset:16384
    ds_read_b64_tr_b16 v[68:69], v17 offset:16384
    ds_read_b64_tr_b16 v[70:71], v17 offset:16896
    v_mfma_f32_16x16x32_bf16 v[40:43], v[20:23], v[88:91], v[40:43]
    v_mfma_f32_16x16x32_bf16 v[48:51], v[20:23], v[92:95], v[48:51]
    s_waitcnt lgkmcnt(3)
    v_mfma_f32_16x16x32_bf16 v[44:47], v[100:103], v[100:103], v[44:47]
    ds_read_b128 v[76:79], v11 offset:16384
    ds_read_b64_tr_b16 v[80:81], v17 offset:20480
    ds_read_b64_tr_b16 v[82:83], v17 offset:20992
    v_mfma_f32_16x16x32_bf16 v[40:43], v[20:23], v[100:103], v[40:43]
    v_mfma_f32_16x16x32_bf16 v[48:51], v[20:23], v[104:107], v[48:51]
    s_waitcnt lgkmcnt(3)
    v_mfma_f32_16x16x32_bf16 v[44:47], v[64:67], v[64:67], v[44:47]
    ds_read_b128 v[88:91], v12 offset:16384
    ds_read_b64_tr_b16 v[92:93], v17 offset:24576
    ds_read_b64_tr_b16 v[94:95], v17 offset:25088
    v_mfma_f32_16x16x32_bf16 v[40:43], v[20:23], v[64:67], v[40:43]
    v_mfma_f32_16x16x32_bf16 v[48:51], v[20:23], v[68:71], v[48:51]
    s_waitcnt lgkmcnt(3)
    v_mfma_f32_16x16x32_bf16 v[44:47], v[76:79], v[76:79], v[44:47]
    ds_read_b128 v[100:103], v13 offset:16384
    ds_read_b64_tr_b16 v[104:105], v17 offset:28672
    ds_read_b64_tr_b16 v[106:107], v17 offset:29184
    v_mfma_f32_16x16x32_bf16 v[40:43], v[20:23], v[76:79], v[40:43]
    v_mfma_f32_16x16x32_bf16 v[48:51], v[20:23], v[80:83], v[48:51]
    s_waitcnt lgkmcnt(3)
    v_mfma_f32_16x16x32_bf16 v[44:47], v[88:91], v[88:91], v[44:47]
    s_barrier
    ds_read_b128 v[64:67], v10 offset:32768
    ds_read_b64_tr_b16 v[68:69], v17 offset:32768
    ds_read_b64_tr_b16 v[70:71], v17 offset:33280
    v_mfma_f32_16x16x32_bf16 v[40:43], v[20:23], v[88:91], v[40:43]
    v_mfma_f32_16x16x32_bf16 v[48:51], v[20:23], v[92:95], v[48:51]
    s_waitcnt lgkmcnt(3)
    v_mfma_f32_16x16x32_bf16 v[44:47], v[100:103], v[100:103], v[44:47]
    ds_read_b128 v[76:79], v11 offset:32768
    ds_read_b64_tr_b16 v[80:81], v17 offset:36864
    ds_read_b64_tr_b16 v[82:83], v17 offset:37376
    v_mfma_f32_16x16x32_bf16 v[40:43], v[20:23], v[100:103], v[40:43]
    v_mfma_f32_16x16x32_bf16 v[48:51], v[20:23], v[104:107], v[48:51]
    s_waitcnt lgkmcnt(3)
    v_mfma_f32_16x16x32_bf16 v[44:47], v[64:67], v[64:67], v[44:47]
    ds_read_b128 v[88:91], v12 offset:32768
    ds_read_b64_tr_b16 v[92:93], v17 offset:40960
    ds_read_b64_tr_b16 v[94:95], v17 offset:41472
    v_mfma_f32_16x16x32_bf16 v[40:43], v[20:23], v[64:67], v[40:43]
    v_mfma_f32_16x16x32_bf16 v[48:51], v[20:23], v[68:71], v[48:51]
    s_waitcnt lgkmcnt(3)
    v_mfma_f32_16x16x32_bf16 v[44:47], v[76:79], v[76:79], v[44:47]
    ds_read_b128 v[100:103], v13 offset:32768
    ds_read_b64_tr_b16 v[104:105], v17 offset:45056
    ds_read_b64_tr_b16 v[106:107], v17 offset:45568
    v_mfma_f32_16x16x32_bf16 v[40:43], v[20:23], v[76:79], v[40:43]
    v_mfma_f32_16x16x32_bf16 v[48:51], v[20:23], v[80:83], v[48:51]
    s_waitcnt lgkmcnt(3)
    v_mfma_f32_16x16x32_bf16 v[44:47], v[88:91], v[88:91], v[44:47]
    s_barrier
    ds_read_b128 v[64:67], v10 offset:49152
    ds_read_b64_tr_b16 v[68:69], v17 offset:49152
    ds_read_b64_tr_b16 v[70:71], v17 offset:49664
    v_mfma_f32_16x16x32_bf16 v[40:43], v[20:23], v[88:91], v[40:43]
    v_mfma_f32_16x16x32_bf16 v[48:51], v[20:23], v[92:95], v[48:51]
    s_waitcnt lgkmcnt(3)
    v_mfma_f32_16x16x32_bf16 v[44:47], v[100:103], v[100:103], v[44:47]
    ds_read_b128 v[76:79], v11 offset:49152
    ds_read_b64_tr_b16 v[80:81], v17 offset:53248
    ds_read_b64_tr_b16 v[82:83], v17 offset:53760
    v_mfma_f32_16x16x32_bf16 v[40:43], v[20:23], v[100:103], v[40:43]
    v_mfma_f32_16x16x32_bf16 v[48:51], v[20:23], v[104:107], v[48:51]
    s_waitcnt lgkmcnt(3)
    v_mfma_f32_16x16x32_bf16 v[44:47], v[64:67], v[64:67], v[44:47]
    ds_read_b128 v[88:91], v12 offset:49152
    ds_read_b64_tr_b16 v[92:93], v17 offset:57344
    ds_read_b64_tr_b16 v[94:95], v17 offset:57856
    v_mfma_f32_16x16x32_bf16 v[40:43], v[20:23], v[64:67], v[40:43]
    v_mfma_f32_16x16x32_bf16 v[48:51], v[20:23], v[68:71], v[48:51]
    s_waitcnt lgkmcnt(3)
    v_mfma_f32_16x16x32_bf16 v[44:47], v[76:79], v[76:79], v[44:47]
    ds_read_b128 v[100:103], v13 offset:49152
    ds_read_b64_tr_b16 v[104:105], v17 offset:61440
    ds_read_b64_tr_b16 v[106:107], v17 offset:61952
    v_mfma_f32_16x16x32_bf16 v[40:43], v[20:23], v[76:79], v[40:43]
    v_mfma_f32_16x16x32_bf16 v[48:51], v[20:23], v[80:83], v[48:51]
    s_waitcnt lgkmcnt(3)
    v_mfma_f32_16x16x32_bf16 v[44:47], v[88:91], v[88:91], v[44:47]
    v_mfma_f32_16x16x32_bf16 v[40:43], v[20:23], v[88:91], v[40:43]
    v_mfma_f32_16x16x32_bf16 v[48:51], v[20:23], v[92:95], v[48:51]
    s_waitcnt lgkmcnt(0)
    v_mfma_f32_16x16x32_bf16 v[44:47], v[100:103], v[100:103], v[44:47]
    v_mfma_f32_16x16x32_bf16 v[40:43], v[20:23], v[100:103], v[40:43]
    v_mfma_f32_16x16x32_bf16 v[48:51], v[20:23], v[104:107], v[48:51]
    s_nop 3
    s_mov_b32 exec_lo, 0x200002
    s_mov_b32 exec_hi, 0x20000200
    v_mov_b32 v44, v45
    s_mov_b32 exec_lo, 0x400004
    s_mov_b32 exec_hi, 0x40000400
    v_mov_b32 v44, v46
    s_mov_b32 exec_lo, 0x800008
    s_mov_b32 exec_hi, 0x80000800
    v_mov_b32 v44, v47
    s_mov_b32 exec_lo, 0x00f0000f
    s_mov_b32 exec_hi, 0xf0000f00
    v_mul_f32 v40, 0x3b000000, v40
    v_mul_f32 v44, 0x3b000000, v44
    v_fma_f32 v44, -v40, v40, v44
    v_max_f32 v44, 0, v44
    v_add_f32 v44, 0x3727c5ac, v44
    v_rsq_f32 v44, v44
    ds_write_b32 v18, v40
    ds_write_b32 v18, v48 offset:512
    ds_write_b32 v18, v44 offset:256
    buffer_store_dword v40, v18, s[28:31], s50 offen sc1
    s_mov_b64 exec, -1
    s_waitcnt lgkmcnt(0)
    s_barrier
    s_endpgm
ka_done:
ka_exit:
    s_endpgm
.p2align 12
.globl sequential_preLN__grouped_kv_mqa__glu_gated_glu__prompt_kernel
.p2align 8
.type sequential_preLN__grouped_kv_mqa__glu_gated_glu__prompt_kernel,@function
sequential_preLN__grouped_kv_mqa__glu_gated_glu__prompt_kernel:
    s_cmp_ge_u32 s2, 256
    s_cbranch_scc1 kb_exit
    s_load_dwordx2 s[24:25], s[0:1], 88
    s_load_dwordx16 s[4:19], s[0:1], 0
    s_load_dwordx4 s[20:23], s[0:1], 64
    v_lshrrev_b32 v3, 6, v0
    v_and_b32 v1, 63, v0
    s_lshr_b32 s56, s2, 3
    v_readfirstlane_b32 s52, v3
    s_and_b32 s55, s56, 15
    s_lshr_b32 s56, s56, 4
    s_and_b32 s54, s2, 7
    s_lshl_b32 s54, s54, 1
    s_add_u32 s54, s54, s56
    v_lshlrev_b32 v2, 4, v1
    s_and_b32 s53, s52, 3
    s_lshl_b32 s56, s54, 4
    s_add_u32 s56, s56, s55
    s_lshl_b32 s44, s56, 13
    s_lshl_b32 s56, s52, 10
    s_add_u32 s99, s56, s44
    s_lshl_b32 s59, s53, 10
    s_waitcnt lgkmcnt(0)
    s_mov_b32 s28, s24
    s_mov_b32 s29, s25
    s_mov_b32 s30, 0x1500000
    s_mov_b32 s31, 0x00020000
    s_cmp_lt_u32 s52, 4
    s_cbranch_scc1 kb_qld
    s_add_u32 s60, s59, 2097152
    s_add_u32 m0, s59, 0
    s_add_u32 s98, s60, 0
    buffer_load_dwordx4 v2, s[28:31], s98 offen lds
    s_add_u32 m0, s59, 4096
    s_add_u32 s98, s60, 4096
    buffer_load_dwordx4 v2, s[28:31], s98 offen lds
    s_add_u32 m0, s59, 8192
    s_add_u32 s98, s60, 8192
    buffer_load_dwordx4 v2, s[28:31], s98 offen lds
    s_add_u32 m0, s59, 12288
    s_add_u32 s98, s60, 12288
    buffer_load_dwordx4 v2, s[28:31], s98 offen lds
    s_add_u32 m0, s59, 16384
    s_add_u32 s98, s60, 16384
    buffer_load_dwordx4 v2, s[28:31], s98 offen lds
    s_add_u32 m0, s59, 20480
    s_add_u32 s98, s60, 20480
    buffer_load_dwordx4 v2, s[28:31], s98 offen lds
kb_qld:
    s_xor_b32 s98, s99, 0x400
    buffer_load_dwordx4 v[4:7], v2, s[28:31], s99 offen
    buffer_load_dwordx4 v[8:11], v2, s[28:31], s98 offen
    s_cmp_lt_u32 s52, 4
    s_cbranch_scc1 kb_grpa
    s_setprio 3
    s_add_u32 m0, s59, 24576
    s_add_u32 s98, s60, 24576
    buffer_load_dwordx4 v2, s[28:31], s98 offen lds
    s_mov_b32 s48, s20
    s_mov_b32 s49, s21
    s_mov_b32 s50, 0x1c0000
    s_mov_b32 s51, 0x00020000
    s_bitcmp1_b32 s53, 0
    s_cselect_b32 s40, s18, s16
    s_cselect_b32 s41, s19, s17
    s_mov_b32 s42, 1835008
    s_mov_b32 s43, 0x00020000
    s_mul_i32 s63, s53, 6144
    s_add_u32 s63, s63, 135168
    v_lshrrev_b32 v3, 3, v1
    s_add_u32 m0, s59, 28672
    s_add_u32 s98, s60, 28672
    buffer_load_dwordx4 v2, s[28:31], s98 offen lds
    v_and_b32 v0, 7, v1
    v_mul_u32_u24 v124, 3584, v3
    v_lshl_add_u32 v124, v0, 4, v124
    v_lshrrev_b32 v3, 2, v1
    v_and_b32 v0, 3, v1
    v_lshlrev_b32 v125, 10, v3
    v_lshl_add_u32 v125, v0, 4, v125
    s_lshl_b32 s61, s2, 2
    s_add_u32 s61, s61, s53
    s_and_b32 s57, s61, 31
    s_lshr_b32 s56, s61, 5
    s_lshl_b32 s26, s56, 17
    s_lshl_b32 s58, s56, 7
    s_add_u32 m0, s59, 32768
    s_add_u32 s98, s60, 32768
    buffer_load_dwordx4 v2, s[28:31], s98 offen lds
    s_lshl_b32 s56, s57, 10
    s_add_u32 s26, s26, s56
    s_add_u32 s26, s26, 5242880
    s_lshr_b32 s57, s57, 1
    s_mul_i32 s57, s57, 114688
    s_add_u32 s58, s58, s57
    s_and_b32 s57, s61, 15
    s_lshr_b32 s56, s61, 4
    s_mul_i32 s27, s57, 114688
    s_lshl_b32 s62, s57, 6
    s_lshl_b32 s57, s56, 11
    s_add_u32 s27, s27, s57
    s_add_u32 s27, s27, 3145728
    s_add_u32 m0, s59, 36864
    s_add_u32 s98, s60, 36864
    buffer_load_dwordx4 v2, s[28:31], s98 offen lds
    s_mul_i32 s57, s56, 9363
    s_lshr_b32 s57, s57, 16
    s_mul_i32 s57, s57, 7
    s_add_u32 s56, s56, s57
    s_lshl_b32 s56, s56, 14
    s_add_u32 s62, s62, s56
    v_lshl_add_u32 v126, v0, 3, s63
    v_bfe_u32 v3, v1, 2, 2
    v_lshl_add_u32 v126, v3, 7, v126
    v_lshrrev_b32 v3, 4, v1
    v_lshl_add_u32 v126, v3, 10, v126
    v_add_u32 v127, s63, v2
    s_waitcnt vmcnt(9)
    s_barrier
    s_add_u32 m0, s59, 40960
    s_add_u32 s98, s60, 40960
    buffer_load_dwordx4 v2, s[28:31], s98 offen lds
    s_lshl_b32 s56, s53, 11
    s_add_u32 s56, s56, 151552
    v_add_u32 v29, s56, v2
    v_xor_b32 v28, 0x800, v29
    s_lshl_b32 s56, s52, 8
    s_add_u32 s56, s56, 160768
    v_lshl_add_u32 v31, v1, 2, s56
    v_xor_b32 v30, 0x100, v31
    s_lshl_b32 s56, s52, 2
    s_add_u32 s56, s56, 159808
    v_mov_b32 v120, s56
    v_xor_b32 v121, 4, v120
    s_and_b32 s56, s53, 1
    s_mul_i32 s56, s56, 2112
    v_add_u32 v20, s56, v2
    v_add_u32 v21, 63360, v20
    v_add_u32 v22, 126720, v20
    s_add_u32 s56, s56, 0x400
    v_lshrrev_b32 v3, 5, v1
    v_and_b32 v23, 15, v1
    v_lshlrev_b32 v23, 4, v23
    v_lshl_add_u32 v23, v3, 8, v23
    v_mov_b32 v26, 0x40000000
    s_mov_b32 exec_lo, 0xffff0000
    s_mov_b32 exec_hi, 0xffff0000
    v_mov_b32 v23, 0x210
    s_mov_b32 exec_lo, 0x00110000
    s_mov_b32 exec_hi, 0x00110000
    v_mov_b32 v23, 0x200
    s_mov_b64 exec, 1
    v_mov_b32 v26, 0
    s_mov_b64 exec, -1
    v_mov_b32 v27, 0xdddddddd
    v_add_u32 v23, s56, v23
    v_add_u32 v24, 63360, v23
    v_add_u32 v25, 126720, v23
    v_lshlrev_b32 v3, 4, v3
    s_add_u32 m0, s59, 45056
    s_add_u32 s98, s60, 45056
    buffer_load_dwordx4 v2, s[28:31], s98 offen lds
    s_lshr_b32 s56, s44, 15
    s_lshl_b32 s45, s56, 8
    s_add_u32 s45, s45, 2359296
    s_lshl_b32 s46, s56, 12
    s_and_b32 s56, s55, 3
    s_lshl_b32 s57, s56, 9
    s_add_u32 s46, s46, s57
    s_lshl_b32 s101, s52, 6
    s_add_u32 s101, s101, s57
    s_add_u32 s101, s101, 2260992
    s_lshl_b32 s57, s53, 2
    s_add_u32 s46, s46, s57
    s_lshl_b32 s57, s53, 2
    s_add_u32 s46, s46, 11536384
    s_lshl_b32 s56, s56, 4
    s_add_u32 s100, s56, s57
    s_add_u32 s47, s100, s45
    s_add_u32 s47, s47, 32960
    v_mov_b64 v[88:89], 0
    v_mov_b64 v[90:91], 0
    v_mov_b64 v[92:93], 0
    v_mov_b64 v[94:95], 0
    v_mov_b64 v[96:97], 0
    v_mov_b64 v[98:99], 0
    v_mov_b64 v[100:101], 0
    v_mov_b64 v[102:103], 0
    v_mov_b64 v[104:105], 0
    v_mov_b64 v[106:107], 0
    v_mov_b64 v[108:109], 0
    v_mov_b64 v[110:111], 0
    v_mov_b64 v[112:113], 0
    v_mov_b64 v[114:115], 0
    v_mov_b64 v[116:117], 0
    v_mov_b64 v[118:119], 0
    v_lshlrev_b32 v0, 2, v1
    v_add_u32 v0, 159744, v0
    ds_write_b32 v0, v88
    s_waitcnt vmcnt(5) lgkmcnt(0)
    s_barrier
    s_add_u32 m0, s59, 49152
    s_add_u32 s98, s60, 49152
    buffer_load_dwordx4 v2, s[28:31], s98 offen lds
    s_add_u32 m0, s59, 53248
    s_add_u32 s98, s60, 53248
    buffer_load_dwordx4 v2, s[28:31], s98 offen lds
    s_add_u32 m0, s59, 57344
    s_add_u32 s98, s60, 57344
    buffer_load_dwordx4 v2, s[28:31], s98 offen lds
    s_add_u32 m0, s59, 61440
    s_add_u32 s98, s60, 61440
    buffer_load_dwordx4 v2, s[28:31], s98 offen lds
    s_add_u32 m0, s59, 65536
    s_add_u32 s98, s60, 65536
    buffer_load_dwordx4 v2, s[28:31], s98 offen lds
    s_add_u32 m0, s59, 69632
    s_add_u32 s98, s60, 69632
    buffer_load_dwordx4 v2, s[28:31], s98 offen lds
    s_waitcnt vmcnt(6)
    s_lshl_b32 s56, s53, 2
    s_add_u32 s56, s56, 159776
    v_mov_b32 v122, s56
    v_mov_b32 v123, 1
    ds_write_b32 v122, v123
    s_add_u32 m0, s63, 0
    s_add_u32 s56, s58, 0
    buffer_load_dwordx4 v124, s[40:43], s56 offen lds
    s_add_u32 m0, s63, 1024
    s_add_u32 s56, s58, 28672
    buffer_load_dwordx4 v124, s[40:43], s56 offen lds
    s_add_u32 m0, s63, 2048
    s_add_u32 s56, s58, 57344
    buffer_load_dwordx4 v124, s[40:43], s56 offen lds
    s_add_u32 m0, s63, 3072
    s_add_u32 s56, s58, 86016
    buffer_load_dwordx4 v124, s[40:43], s56 offen lds
    s_add_u32 m0, s63, 4096
    s_add_u32 s56, s62, 0
    buffer_load_dwordx4 v125, s[48:51], s56 offen lds
    s_add_u32 m0, s63, 5120
    s_add_u32 s56, s62, 114688
    buffer_load_dwordx4 v125, s[48:51], s56 offen lds
    s_add_u32 m0, s59, 73728
    s_add_u32 s98, s60, 73728
    buffer_load_dwordx4 v2, s[28:31], s98 offen lds
    s_add_u32 m0, s59, 77824
    s_add_u32 s98, s60, 77824
    buffer_load_dwordx4 v2, s[28:31], s98 offen lds
    s_add_u32 m0, s59, 81920
    s_add_u32 s98, s60, 81920
    buffer_load_dwordx4 v2, s[28:31], s98 offen lds
    s_add_u32 m0, s59, 86016
    s_add_u32 s98, s60, 86016
    buffer_load_dwordx4 v2, s[28:31], s98 offen lds
    s_waitcnt vmcnt(10)
    s_lshl_b32 s56, s53, 2
    s_add_u32 s56, s56, 159776
    v_mov_b32 v122, s56
    v_mov_b32 v123, 2
    ds_write_b32 v122, v123
    s_mov_b64 exec, 0
    s_cmp_eq_u32 s53, 0
    s_cbranch_scc1 pad_0
    s_cmp_eq_u32 s53, 1
    s_cbranch_scc1 pad_1
    s_cmp_eq_u32 s53, 2
    s_cbranch_scc1 pad_2
    s_cbranch_execz pad_3
kb_warm:
    s_mov_b64 exec, -1
    s_add_u32 m0, s59, 90112
    s_add_u32 s98, s60, 90112
    buffer_load_dwordx4 v2, s[28:31], s98 offen lds
    s_add_u32 m0, s59, 94208
    s_add_u32 s98, s60, 94208
    buffer_load_dwordx4 v2, s[28:31], s98 offen lds
    s_add_u32 m0, s59, 98304
    s_add_u32 s98, s60, 98304
    buffer_load_dwordx4 v2, s[28:31], s98 offen lds
    s_add_u32 m0, s59, 102400
    s_add_u32 s98, s60, 102400
    buffer_load_dwordx4 v2, s[28:31], s98 offen lds
    s_add_u32 m0, s59, 106496
    s_add_u32 s98, s60, 106496
    buffer_load_dwordx4 v2, s[28:31], s98 offen lds
    s_add_u32 m0, s59, 110592
    s_add_u32 s98, s60, 110592
    buffer_load_dwordx4 v2, s[28:31], s98 offen lds
    s_add_u32 m0, s59, 114688
    s_add_u32 s98, s60, 114688
    buffer_load_dwordx4 v2, s[28:31], s98 offen lds
    s_add_u32 m0, s59, 118784
    s_add_u32 s98, s60, 118784
    buffer_load_dwordx4 v2, s[28:31], s98 offen lds
    s_add_u32 m0, s59, 122880
    s_add_u32 s98, s60, 122880
    buffer_load_dwordx4 v2, s[28:31], s98 offen lds
    s_add_u32 m0, s59, 126976
    s_add_u32 s98, s60, 126976
    buffer_load_dwordx4 v2, s[28:31], s98 offen lds
    s_add_u32 m0, s59, 131072
    s_add_u32 s98, s60, 131072
    buffer_load_dwordx4 v2, s[28:31], s98 offen lds
    buffer_load_dwordx4 v[32:35], v3, s[28:31], s101 offen offset:0
    buffer_load_dwordx4 v[36:39], v3, s[28:31], s101 offen offset:32
    s_add_u32 s60, s99, 9437184
    s_cmp_ge_u32 s2, 224
    s_cselect_b32 s26, 0x40000000, s26
    s_cselect_b32 s27, 0x40000000, s27
    s_waitcnt vmcnt(17)
    ds_read_b64_tr_b16 v[128:129], v126 offset:0
    ds_read_b64_tr_b16 v[130:131], v126 offset:512
    ds_read_b64_tr_b16 v[132:133], v126 offset:32
    ds_read_b64_tr_b16 v[134:135], v126 offset:544
    ds_read_b64_tr_b16 v[136:137], v126 offset:64
    ds_read_b64_tr_b16 v[138:139], v126 offset:576
    ds_read_b64_tr_b16 v[140:141], v126 offset:96
    ds_read_b64_tr_b16 v[142:143], v126 offset:608
    ds_read_b64_tr_b16 v[144:145], v127 offset:4096
    ds_read_b64_tr_b16 v[146:147], v127 offset:5120
    ds_read_b64_tr_b16 v[148:149], v127 offset:4104
    ds_read_b64_tr_b16 v[150:151], v127 offset:5128
    s_waitcnt lgkmcnt(10)
    buffer_store_dwordx4 v[128:131], v2, s[28:31], s26 offen sc1
    s_add_u32 s26, s26, 32768
    s_waitcnt lgkmcnt(8)
    buffer_store_dwordx4 v[132:135], v2, s[28:31], s26 offen sc1
    s_add_u32 s26, s26, 32768
    s_waitcnt lgkmcnt(6)
    buffer_store_dwordx4 v[136:139], v2, s[28:31], s26 offen sc1
    s_add_u32 s26, s26, 32768
    s_waitcnt lgkmcnt(4)
    buffer_store_dwordx4 v[140:143], v2, s[28:31], s26 offen sc1
    s_waitcnt lgkmcnt(2)
    buffer_store_dwordx4 v[144:147], v2, s[28:31], s27 offen sc1
    s_add_u32 s27, s27, 1024
    s_waitcnt lgkmcnt(0)
    buffer_store_dwordx4 v[148:151], v2, s[28:31], s27 offen sc1
    s_getreg_b32 s57, hwreg(HW_REG_XCC_ID, 0, 4)
    s_add_u32 s57, s57, 1
    s_lshl_b32 s56, s54, 5
    s_add_u32 s56, s56, s55
    s_lshl_b32 s56, s56, 2
    s_add_u32 s56, s56, 2408448
    s_cmp_eq_u32 s53, 0
    s_cselect_b32 s56, s56, 0x40000000
    v_mov_b32 v124, 1
    v_mov_b32 v125, s57
    buffer_store_dword v125, v26, s[28:31], s56 offen sc1
    s_waitcnt vmcnt(7)
    s_lshl_b32 s56, s53, 2
    s_add_u32 s56, s56, 159776
    v_mov_b32 v122, s56
    v_mov_b32 v123, 3
    ds_write_b32 v122, v123
    s_and_b32 s56, s2, 31
    s_lshl_b32 s56, s56, 7
    s_add_u32 s56, s56, 2359296
    s_waitcnt vmcnt(0)
    s_mov_b64 exec, 1
    buffer_atomic_add v124, v26, s[28:31], s56 offen sc0 sc1
    s_mov_b64 exec, -1
    s_waitcnt vmcnt(0)
    v_readfirstlane_b32 s98, v124
    s_cmp_eq_u32 s98, 31
    s_cbranch_scc1 kb_rl_top
kb_rl_sent:
    s_cmp_ge_u32 s98, 24
    s_cbranch_scc1 kb_notw
    v_lshlrev_b32 v123, 7, v1
    s_lshr_b32 s56, s44, 15
    s_lshl_b32 s56, s56, 11
    s_add_u32 s56, s56, 11796480
    s_mov_b64 exec, 0xffff
    buffer_load_dword v125, v123, s[28:31], s56 offen sc1
    s_mov_b64 exec, 0xff
    buffer_load_dword v125, v123, s[28:31], s60 offen sc1
    s_lshl_b32 s56, s53, 11
    s_add_u32 s56, s56, s44
    s_mov_b64 exec, 0xffff
    buffer_load_dword v125, v123, s[28:31], s56 offen sc1
    s_mov_b64 exec, 0xf
    buffer_load_dword v125, v123, s[28:31], s46 offen sc1
    s_mov_b64 exec, -1
    s_and_b32 s56, s54, 1
    s_lshl_b32 s56, s56, 2
    s_lshr_b32 s57, s55, 2
    s_add_u32 s56, s56, s57
    s_lshl_b32 s56, s56, 12
    s_lshl_b32 s57, s100, 13
    s_add_u32 s56, s56, s57
    s_add_u32 s56, s56, 2621440
    v_lshlrev_b32 v123, 7, v1
    s_mov_b32 exec_hi, 0
    buffer_load_dword v125, v123, s[28:31], s56 offen sc1
    s_mov_b32 exec_hi, -1
    s_mov_b32 s32, s4
    s_mov_b32 s33, s5
    s_mov_b32 s34, 0x200000
    s_mov_b32 s35, 0x00020000
    s_and_b32 s56, s44, 0xffff8000
    s_lshl_b32 s57, s53, 13
    s_add_u32 s56, s56, s57
    s_and_b32 s57, s55, 3
    s_lshl_b32 s57, s57, 8
    s_add_u32 s56, s56, s57
    v_lshrrev_b32 v123, 1, v1
    v_lshlrev_b32 v123, 10, v123
    v_and_b32 v122, 1, v1
    v_lshl_add_u32 v123, v122, 7, v123
    s_mov_b64 exec, 0xffff
    buffer_load_dword v125, v123, s[32:35], s56 offen
    s_mov_b64 exec, -1
kb_notw:
    s_and_b32 s56, s55, 7
    s_mul_i32 s59, s56, 229376
    s_mul_i32 s56, s53, 28672
    s_add_u32 s59, s59, s56
    s_add_u32 s59, s59, 3145728
    s_and_b32 s56, s53, 1
    s_mul_i32 s56, s56, 114688
    s_sub_u32 s101, s59, s56
    s_add_u32 s101, s101, 114688
    s_add_u32 s59, s59, s56
    s_lshl_b32 s56, s53, 2
    s_add_u32 s56, s56, 159744
    v_mov_b32 v0, s56
    s_setprio 1
    s_branch kb_battn
kb_rl_top:
    v_mov_b32 v125, 1
    s_mov_b32 s56, 2363392
    s_mov_b64 exec, 1
    buffer_atomic_add v125, v26, s[28:31], s56 offen sc0 sc1
    s_mov_b64 exec, -1
    v_lshrrev_b32 v124, 2, v1
    v_lshlrev_b32 v124, 6, v124
    v_add_u32 v124, v124, v2
    v_mov_b32 v128, 1
    v_mov_b32 v129, 1
    v_mov_b32 v130, 1
    v_mov_b32 v131, 1
    s_waitcnt vmcnt(0)
    v_readfirstlane_b32 s57, v125
    s_cmp_lg_u32 s57, 31
    s_cbranch_scc1 kb_rl_sent
    buffer_store_dwordx4 v[128:131], v124, s[28:31], s56 offen offset:2048 sc1
    s_branch kb_rl_sent
.p2align 12
kb_grpa:
    s_setprio 2
    s_lshl_b32 s56, s53, 11
    s_add_u32 s56, s56, 135168
    v_add_u32 v29, s56, v2
    v_xor_b32 v28, 0x800, v29
    s_lshl_b32 s56, s52, 8
    s_add_u32 s56, s56, 160768
    v_lshl_add_u32 v31, v1, 2, s56
    v_xor_b32 v30, 0x100, v31
    s_lshl_b32 s56, s52, 2
    s_add_u32 s56, s56, 159808
    v_mov_b32 v120, s56
    v_xor_b32 v121, 4, v120
    s_and_b32 s56, s53, 1
    s_mul_i32 s56, s56, 2112
    v_add_u32 v20, s56, v2
    v_add_u32 v21, 63360, v20
    v_add_u32 v22, 126720, v20
    s_add_u32 s56, s56, 0x400
    v_lshrrev_b32 v3, 5, v1
    v_and_b32 v23, 15, v1
    v_lshlrev_b32 v23, 4, v23
    v_lshl_add_u32 v23, v3, 8, v23
    v_mov_b32 v26, 0x40000000
    s_mov_b32 exec_lo, 0xffff0000
    s_mov_b32 exec_hi, 0xffff0000
    v_mov_b32 v23, 0x210
    s_mov_b32 exec_lo, 0x00110000
    s_mov_b32 exec_hi, 0x00110000
    v_mov_b32 v23, 0x200
    s_mov_b64 exec, 1
    v_mov_b32 v26, 0
    s_mov_b64 exec, -1
    v_mov_b32 v27, 0xdddddddd
    v_add_u32 v23, s56, v23
    v_add_u32 v24, 63360, v23
    v_add_u32 v25, 126720, v23
    v_lshlrev_b32 v3, 4, v3
    s_lshr_b32 s56, s44, 15
    s_lshl_b32 s45, s56, 8
    s_add_u32 s45, s45, 2359296
    s_lshl_b32 s46, s56, 12
    s_and_b32 s56, s55, 3
    s_lshl_b32 s57, s56, 9
    s_add_u32 s46, s46, s57
    s_lshl_b32 s101, s52, 6
    s_add_u32 s101, s101, s57
    s_add_u32 s101, s101, 2260992
    s_lshl_b32 s57, s53, 2
    s_add_u32 s46, s46, s57
    s_lshl_b32 s57, s53, 2
    s_add_u32 s46, s46, 11534336
    s_lshl_b32 s56, s56, 4
    s_add_u32 s100, s56, s57
    s_add_u32 s47, s100, s45
    s_add_u32 s47, s47, 32896
    v_mov_b64 v[88:89], 0
    v_mov_b64 v[90:91], 0
    v_mov_b64 v[92:93], 0
    v_mov_b64 v[94:95], 0
    v_mov_b64 v[96:97], 0
    v_mov_b64 v[98:99], 0
    v_mov_b64 v[100:101], 0
    v_mov_b64 v[102:103], 0
    v_mov_b64 v[104:105], 0
    v_mov_b64 v[106:107], 0
    v_mov_b64 v[108:109], 0
    v_mov_b64 v[110:111], 0
    v_mov_b64 v[112:113], 0
    v_mov_b64 v[114:115], 0
    v_mov_b64 v[116:117], 0
    v_mov_b64 v[118:119], 0
    buffer_load_dwordx4 v[32:35], v3, s[28:31], s101 offen offset:0
    buffer_load_dwordx4 v[36:39], v3, s[28:31], s101 offen offset:32
    s_mov_b32 s32, s4
    s_mov_b32 s33, s5
    s_mov_b32 s34, 0x200000
    s_mov_b32 s35, 0x00020000
    s_add_u32 s60, s99, 9437184
    s_lshl_b32 s59, s100, 13
    s_add_u32 s59, s59, 2621440
    s_and_b32 s3, s44, 0xffff8000
    s_lshr_b32 s27, s3, 8
    s_add_u32 s27, s27, 2269184
    s_lshl_b32 s56, s100, 4
    s_add_u32 s3, s3, s56
    s_waitcnt vmcnt(2)
    s_barrier
    ds_read_b128 v[12:15], v20 offset:0
    ds_read_b128 v[40:43], v23 offset:0
    ds_read_b128 v[44:47], v23 offset:544
    ds_read_b128 v[16:19], v20 offset:4224
    ds_read_b128 v[48:51], v23 offset:4224
    ds_read_b128 v[52:55], v23 offset:4768
    s_waitcnt lgkmcnt(5)
    v_mfma_f32_32x32x16_bf16 v[56:71], v[12:15], v[8:11], 0
    s_nop 11
    v_exp_f32 v56, v56
    v_exp_f32 v57, v57
    s_waitcnt lgkmcnt(2)
    v_exp_f32 v58, v58
    v_exp_f32 v59, v59
    v_exp_f32 v60, v60
    v_mfma_f32_32x32x16_bf16 v[72:87], v[12:15], v[4:7], 0
    ds_read_b128 v[12:15], v20 offset:8448
    v_exp_f32 v61, v61
    v_exp_f32 v62, v62
    v_exp_f32 v63, v63
    v_exp_f32 v64, v64
    v_exp_f32 v65, v65
    v_smfmac_f32_32x32x32_bf16 v[104:119], v[40:43], v[56:63], v27
    v_exp_f32 v66, v66
    v_exp_f32 v67, v67
    v_exp_f32 v68, v68
    v_exp_f32 v69, v69
    v_exp_f32 v70, v70
    v_exp_f32 v71, v71
    v_exp_f32 v72, v72
    v_exp_f32 v73, v73
    v_smfmac_f32_32x32x32_bf16 v[104:119], v[44:47], v[64:71], v27
    v_exp_f32 v74, v74
    v_exp_f32 v75, v75
    v_exp_f32 v76, v76
    v_mfma_f32_32x32x16_bf16 v[56:71], v[16:19], v[8:11], 0
    v_exp_f32 v77, v77
    v_exp_f32 v78, v78
    v_exp_f32 v79, v79
    v_exp_f32 v80, v80
    v_exp_f32 v81, v81
    v_smfmac_f32_32x32x32_bf16 v[88:103], v[40:43], v[72:79], v27
    ds_read_b128 v[40:43], v23 offset:8448
    v_exp_f32 v82, v82
    v_exp_f32 v83, v83
    v_exp_f32 v84, v84
    v_exp_f32 v85, v85
    v_exp_f32 v86, v86
    v_exp_f32 v87, v87
    v_exp_f32 v56, v56
    v_exp_f32 v57, v57
    s_waitcnt lgkmcnt(1)
    v_smfmac_f32_32x32x32_bf16 v[88:103], v[44:47], v[80:87], v27
    s_barrier
    ds_read_b128 v[44:47], v23 offset:8992
    v_exp_f32 v58, v58
    v_exp_f32 v59, v59
    v_exp_f32 v60, v60
    v_mfma_f32_32x32x16_bf16 v[72:87], v[16:19], v[4:7], 0
    ds_read_b128 v[16:19], v20 offset:12672
    v_exp_f32 v61, v61
    v_exp_f32 v62, v62
    v_exp_f32 v63, v63
    v_exp_f32 v64, v64
    v_exp_f32 v65, v65
    v_smfmac_f32_32x32x32_bf16 v[104:119], v[48:51], v[56:63], v27
    v_exp_f32 v66, v66
    v_exp_f32 v67, v67
    v_exp_f32 v68, v68
    v_exp_f32 v69, v69
    v_exp_f32 v70, v70
    v_exp_f32 v71, v71
    v_exp_f32 v72, v72
    v_exp_f32 v73, v73
    v_smfmac_f32_32x32x32_bf16 v[104:119], v[52:55], v[64:71], v27
    v_exp_f32 v74, v74
    v_exp_f32 v75, v75
    v_exp_f32 v76, v76
    v_mfma_f32_32x32x16_bf16 v[56:71], v[12:15], v[8:11], 0
    v_exp_f32 v77, v77
    v_exp_f32 v78, v78
    v_exp_f32 v79, v79
    v_exp_f32 v80, v80
    v_exp_f32 v81, v81
    v_smfmac_f32_32x32x32_bf16 v[88:103], v[48:51], v[72:79], v27
    ds_read_b128 v[48:51], v23 offset:12672
    v_exp_f32 v82, v82
    v_exp_f32 v83, v83
    v_exp_f32 v84, v84
    v_exp_f32 v85, v85
    v_exp_f32 v86, v86
    v_exp_f32 v87, v87
    v_exp_f32 v56, v56
    v_exp_f32 v57, v57
    s_waitcnt lgkmcnt(1)
    v_smfmac_f32_32x32x32_bf16 v[88:103], v[52:55], v[80:87], v27
    ds_read_b128 v[52:55], v23 offset:13216
    v_exp_f32 v58, v58
    v_exp_f32 v59, v59
    v_exp_f32 v60, v60
    v_mfma_f32_32x32x16_bf16 v[72:87], v[12:15], v[4:7], 0
    ds_read_b128 v[12:15], v20 offset:16896
    v_exp_f32 v61, v61
    v_exp_f32 v62, v62
    v_exp_f32 v63, v63
    v_exp_f32 v64, v64
    v_exp_f32 v65, v65
    v_smfmac_f32_32x32x32_bf16 v[104:119], v[40:43], v[56:63], v27
    v_exp_f32 v66, v66
    v_exp_f32 v67, v67
    v_exp_f32 v68, v68
    v_exp_f32 v69, v69
    v_exp_f32 v70, v70
    v_exp_f32 v71, v71
    v_exp_f32 v72, v72
    v_exp_f32 v73, v73
    v_smfmac_f32_32x32x32_bf16 v[104:119], v[44:47], v[64:71], v27
    v_exp_f32 v74, v74
    v_exp_f32 v75, v75
    v_exp_f32 v76, v76
    v_mfma_f32_32x32x16_bf16 v[56:71], v[16:19], v[8:11], 0
    v_exp_f32 v77, v77
    v_exp_f32 v78, v78
    v_exp_f32 v79, v79
    v_exp_f32 v80, v80
    v_exp_f32 v81, v81
    v_smfmac_f32_32x32x32_bf16 v[88:103], v[40:43], v[72:79], v27
    ds_read_b128 v[40:43], v23 offset:16896
    v_exp_f32 v82, v82
    v_exp_f32 v83, v83
    v_exp_f32 v84, v84
    v_exp_f32 v85, v85
    v_exp_f32 v86, v86
    v_exp_f32 v87, v87
    v_exp_f32 v56, v56
    v_exp_f32 v57, v57
    s_waitcnt lgkmcnt(1)
    v_smfmac_f32_32x32x32_bf16 v[88:103], v[44:47], v[80:87], v27
    ds_read_b128 v[44:47], v23 offset:17440
    v_exp_f32 v58, v58
    v_exp_f32 v59, v59
    v_exp_f32 v60, v60
    v_mfma_f32_32x32x16_bf16 v[72:87], v[16:19], v[4:7], 0
    ds_read_b128 v[16:19], v20 offset:21120
    v_exp_f32 v61, v61
    v_exp_f32 v62, v62
    v_exp_f32 v63, v63
    v_exp_f32 v64, v64
    v_exp_f32 v65, v65
    v_smfmac_f32_32x32x32_bf16 v[104:119], v[48:51], v[56:63], v27
    v_exp_f32 v66, v66
    v_exp_f32 v67, v67
    v_exp_f32 v68, v68
    v_exp_f32 v69, v69
    v_exp_f32 v70, v70
    v_exp_f32 v71, v71
    v_and_b32 v122, 3, v1
    v_lshlrev_b32 v122, 2, v122
    v_add_u32 v122, 159776, v122
    s_mov_b32 s61, 262144
    ds_read_b32 v123, v122
    v_exp_f32 v72, v72
    v_exp_f32 v73, v73
    v_smfmac_f32_32x32x32_bf16 v[104:119], v[52:55], v[64:71], v27
    v_exp_f32 v74, v74
    v_exp_f32 v75, v75
    v_exp_f32 v76, v76
    v_mfma_f32_32x32x16_bf16 v[56:71], v[12:15], v[8:11], 0
    v_exp_f32 v77, v77
    v_exp_f32 v78, v78
    v_exp_f32 v79, v79
    v_exp_f32 v80, v80
    v_exp_f32 v81, v81
    v_smfmac_f32_32x32x32_bf16 v[88:103], v[48:51], v[72:79], v27
    ds_read_b128 v[48:51], v23 offset:21120
    v_exp_f32 v82, v82
    v_exp_f32 v83, v83
    v_exp_f32 v84, v84
    v_exp_f32 v85, v85
    v_exp_f32 v86, v86
    v_exp_f32 v87, v87
lw_kv0:
    s_waitcnt lgkmcnt(0)
    v_cmp_le_u32 vcc, 1, v123
    s_cmp_eq_u64 vcc, -1
    s_cbranch_scc0 lr_kv0
ld_kv0:
    v_exp_f32 v56, v56
    v_exp_f32 v57, v57
    s_waitcnt lgkmcnt(1)
    v_smfmac_f32_32x32x32_bf16 v[88:103], v[52:55], v[80:87], v27
    ds_read_b128 v[52:55], v23 offset:21664
    v_exp_f32 v58, v58
    v_exp_f32 v59, v59
    v_exp_f32 v60, v60
    v_mfma_f32_32x32x16_bf16 v[72:87], v[12:15], v[4:7], 0
    ds_read_b128 v[12:15], v20 offset:25344
    v_exp_f32 v61, v61
    v_exp_f32 v62, v62
    v_exp_f32 v63, v63
    v_exp_f32 v64, v64
    v_exp_f32 v65, v65
    v_smfmac_f32_32x32x32_bf16 v[104:119], v[40:43], v[56:63], v27
    v_exp_f32 v66, v66
    v_exp_f32 v67, v67
    v_exp_f32 v68, v68
    v_exp_f32 v69, v69
    v_exp_f32 v70, v70
    v_exp_f32 v71, v71
    v_exp_f32 v72, v72
    v_exp_f32 v73, v73
    v_smfmac_f32_32x32x32_bf16 v[104:119], v[44:47], v[64:71], v27
    v_exp_f32 v74, v74
    v_exp_f32 v75, v75
    v_exp_f32 v76, v76
    v_mfma_f32_32x32x16_bf16 v[56:71], v[16:19], v[8:11], 0
    v_exp_f32 v77, v77
    v_exp_f32 v78, v78
    v_exp_f32 v79, v79
    v_exp_f32 v80, v80
    v_exp_f32 v81, v81
    v_smfmac_f32_32x32x32_bf16 v[88:103], v[40:43], v[72:79], v27
    ds_read_b128 v[40:43], v23 offset:25344
    v_exp_f32 v82, v82
    v_exp_f32 v83, v83
    v_exp_f32 v84, v84
    v_exp_f32 v85, v85
    v_exp_f32 v86, v86
    v_exp_f32 v87, v87
    v_exp_f32 v56, v56
    v_exp_f32 v57, v57
    s_waitcnt lgkmcnt(1)
    v_smfmac_f32_32x32x32_bf16 v[88:103], v[44:47], v[80:87], v27
    ds_read_b128 v[44:47], v23 offset:25888
    v_exp_f32 v58, v58
    v_exp_f32 v59, v59
    v_exp_f32 v60, v60
    v_mfma_f32_32x32x16_bf16 v[72:87], v[16:19], v[4:7], 0
    ds_read_b128 v[16:19], v20 offset:29568
    v_exp_f32 v61, v61
    v_exp_f32 v62, v62
    v_exp_f32 v63, v63
    v_exp_f32 v64, v64
    v_exp_f32 v65, v65
    v_smfmac_f32_32x32x32_bf16 v[104:119], v[48:51], v[56:63], v27
    v_exp_f32 v66, v66
    v_exp_f32 v67, v67
    v_exp_f32 v68, v68
    v_exp_f32 v69, v69
    v_exp_f32 v70, v70
    v_exp_f32 v71, v71
    v_exp_f32 v72, v72
    v_exp_f32 v73, v73
    v_smfmac_f32_32x32x32_bf16 v[104:119], v[52:55], v[64:71], v27
    v_exp_f32 v74, v74
    v_exp_f32 v75, v75
    v_exp_f32 v76, v76
    v_mfma_f32_32x32x16_bf16 v[56:71], v[12:15], v[8:11], 0
    v_exp_f32 v77, v77
    v_exp_f32 v78, v78
    v_exp_f32 v79, v79
    v_exp_f32 v80, v80
    v_exp_f32 v81, v81
    v_smfmac_f32_32x32x32_bf16 v[88:103], v[48:51], v[72:79], v27
    ds_read_b128 v[48:51], v23 offset:29568
    v_exp_f32 v82, v82
    v_exp_f32 v83, v83
    v_exp_f32 v84, v84
    v_exp_f32 v85, v85
    v_exp_f32 v86, v86
    v_exp_f32 v87, v87
    v_exp_f32 v56, v56
    v_exp_f32 v57, v57
    s_waitcnt lgkmcnt(1)
    v_smfmac_f32_32x32x32_bf16 v[88:103], v[52:55], v[80:87], v27
    ds_read_b128 v[52:55], v23 offset:30112
    v_exp_f32 v58, v58
    v_exp_f32 v59, v59
    v_exp_f32 v60, v60
    v_mfma_f32_32x32x16_bf16 v[72:87], v[12:15], v[4:7], 0
    ds_read_b128 v[12:15], v20 offset:33792
    v_exp_f32 v61, v61
    v_exp_f32 v62, v62
    v_exp_f32 v63, v63
    v_exp_f32 v64, v64
    v_exp_f32 v65, v65
    v_smfmac_f32_32x32x32_bf16 v[104:119], v[40:43], v[56:63], v27
    v_exp_f32 v66, v66
    v_exp_f32 v67, v67
    v_exp_f32 v68, v68
    v_exp_f32 v69, v69
    v_exp_f32 v70, v70
    v_exp_f32 v71, v71
    v_exp_f32 v72, v72
    v_exp_f32 v73, v73
    v_smfmac_f32_32x32x32_bf16 v[104:119], v[44:47], v[64:71], v27
    v_exp_f32 v74, v74
    v_exp_f32 v75, v75
    v_exp_f32 v76, v76
    v_mfma_f32_32x32x16_bf16 v[56:71], v[16:19], v[8:11], 0
    v_exp_f32 v77, v77
    v_exp_f32 v78, v78
    v_exp_f32 v79, v79
    v_exp_f32 v80, v80
    v_exp_f32 v81, v81
    v_smfmac_f32_32x32x32_bf16 v[88:103], v[40:43], v[72:79], v27
    ds_read_b128 v[40:43], v23 offset:33792
    v_exp_f32 v82, v82
    v_exp_f32 v83, v83
    v_exp_f32 v84, v84
    v_exp_f32 v85, v85
    v_exp_f32 v86, v86
    v_exp_f32 v87, v87
    v_exp_f32 v56, v56
    v_exp_f32 v57, v57
    s_waitcnt lgkmcnt(1)
    v_smfmac_f32_32x32x32_bf16 v[88:103], v[44:47], v[80:87], v27
    ds_read_b128 v[44:47], v23 offset:34336
    v_exp_f32 v58, v58
    v_exp_f32 v59, v59
    v_exp_f32 v60, v60
    v_mfma_f32_32x32x16_bf16 v[72:87], v[16:19], v[4:7], 0
    ds_read_b128 v[16:19], v20 offset:38016
    v_exp_f32 v61, v61
    v_exp_f32 v62, v62
    v_exp_f32 v63, v63
    v_exp_f32 v64, v64
    v_exp_f32 v65, v65
    v_smfmac_f32_32x32x32_bf16 v[104:119], v[48:51], v[56:63], v27
    v_exp_f32 v66, v66
    v_exp_f32 v67, v67
    v_exp_f32 v68, v68
    v_exp_f32 v69, v69
    v_exp_f32 v70, v70
    v_exp_f32 v71, v71
    v_exp_f32 v72, v72
    v_exp_f32 v73, v73
    v_smfmac_f32_32x32x32_bf16 v[104:119], v[52:55], v[64:71], v27
    v_exp_f32 v74, v74
    v_exp_f32 v75, v75
    v_exp_f32 v76, v76
    v_mfma_f32_32x32x16_bf16 v[56:71], v[12:15], v[8:11], 0
    v_exp_f32 v77, v77
    v_exp_f32 v78, v78
    v_exp_f32 v79, v79
    v_exp_f32 v80, v80
    v_exp_f32 v81, v81
    v_smfmac_f32_32x32x32_bf16 v[88:103], v[48:51], v[72:79], v27
    ds_read_b128 v[48:51], v23 offset:38016
    v_exp_f32 v82, v82
    v_exp_f32 v83, v83
    v_exp_f32 v84, v84
    v_exp_f32 v85, v85
    v_exp_f32 v86, v86
    v_exp_f32 v87, v87
    v_exp_f32 v56, v56
    v_exp_f32 v57, v57
    s_waitcnt lgkmcnt(1)
    v_smfmac_f32_32x32x32_bf16 v[88:103], v[52:55], v[80:87], v27
    ds_read_b128 v[52:55], v23 offset:38560
    v_exp_f32 v58, v58
    v_exp_f32 v59, v59
    v_exp_f32 v60, v60
    v_mfma_f32_32x32x16_bf16 v[72:87], v[12:15], v[4:7], 0
    ds_read_b128 v[12:15], v20 offset:42240
    v_exp_f32 v61, v61
    v_exp_f32 v62, v62
    v_exp_f32 v63, v63
    v_exp_f32 v64, v64
    v_exp_f32 v65, v65
    v_smfmac_f32_32x32x32_bf16 v[104:119], v[40:43], v[56:63], v27
    v_exp_f32 v66, v66
    v_exp_f32 v67, v67
    v_exp_f32 v68, v68
    v_exp_f32 v69, v69
    v_exp_f32 v70, v70
    v_exp_f32 v71, v71
    v_and_b32 v122, 3, v1
    v_lshlrev_b32 v122, 2, v122
    v_add_u32 v122, 159776, v122
    s_mov_b32 s61, 262144
    ds_read_b32 v123, v122
    v_exp_f32 v72, v72
    v_exp_f32 v73, v73
    v_smfmac_f32_32x32x32_bf16 v[104:119], v[44:47], v[64:71], v27
    v_exp_f32 v74, v74
    v_exp_f32 v75, v75
    v_exp_f32 v76, v76
    v_mfma_f32_32x32x16_bf16 v[56:71], v[16:19], v[8:11], 0
    v_exp_f32 v77, v77
    v_exp_f32 v78, v78
    v_exp_f32 v79, v79
    v_exp_f32 v80, v80
    v_exp_f32 v81, v81
    v_smfmac_f32_32x32x32_bf16 v[88:103], v[40:43], v[72:79], v27
    ds_read_b128 v[40:43], v23 offset:42240
    v_exp_f32 v82, v82
    v_exp_f32 v83, v83
    v_exp_f32 v84, v84
    v_exp_f32 v85, v85
    v_exp_f32 v86, v86
    v_exp_f32 v87, v87
lw_kv1:
    s_waitcnt lgkmcnt(0)
    v_cmp_le_u32 vcc, 2, v123
    s_cmp_eq_u64 vcc, -1
    s_cbranch_scc0 lr_kv1
ld_kv1:
    v_exp_f32 v56, v56
    v_exp_f32 v57, v57
    s_waitcnt lgkmcnt(1)
    v_smfmac_f32_32x32x32_bf16 v[88:103], v[44:47], v[80:87], v27
    ds_read_b128 v[44:47], v23 offset:42784
    v_exp_f32 v58, v58
    v_exp_f32 v59, v59
    v_exp_f32 v60, v60
    v_mfma_f32_32x32x16_bf16 v[72:87], v[16:19], v[4:7], 0
    ds_read_b128 v[16:19], v20 offset:46464
    v_exp_f32 v61, v61
    v_exp_f32 v62, v62
    v_exp_f32 v63, v63
    v_exp_f32 v64, v64
    v_exp_f32 v65, v65
    v_smfmac_f32_32x32x32_bf16 v[104:119], v[48:51], v[56:63], v27
    v_exp_f32 v66, v66
    v_exp_f32 v67, v67
    v_exp_f32 v68, v68
    v_exp_f32 v69, v69
    v_exp_f32 v70, v70
    v_exp_f32 v71, v71
    v_exp_f32 v72, v72
    v_exp_f32 v73, v73
    v_smfmac_f32_32x32x32_bf16 v[104:119], v[52:55], v[64:71], v27
    v_exp_f32 v74, v74
    v_exp_f32 v75, v75
    v_exp_f32 v76, v76
    v_mfma_f32_32x32x16_bf16 v[56:71], v[12:15], v[8:11], 0
    v_exp_f32 v77, v77
    v_exp_f32 v78, v78
    v_exp_f32 v79, v79
    v_exp_f32 v80, v80
    v_exp_f32 v81, v81
    v_smfmac_f32_32x32x32_bf16 v[88:103], v[48:51], v[72:79], v27
    ds_read_b128 v[48:51], v23 offset:46464
    v_exp_f32 v82, v82
    v_exp_f32 v83, v83
    v_exp_f32 v84, v84
    v_exp_f32 v85, v85
    v_exp_f32 v86, v86
    v_exp_f32 v87, v87
    v_exp_f32 v56, v56
    v_exp_f32 v57, v57
    s_waitcnt lgkmcnt(1)
    v_smfmac_f32_32x32x32_bf16 v[88:103], v[52:55], v[80:87], v27
    ds_read_b128 v[52:55], v23 offset:47008
    v_exp_f32 v58, v58
    v_exp_f32 v59, v59
    v_exp_f32 v60, v60
    v_mfma_f32_32x32x16_bf16 v[72:87], v[12:15], v[4:7], 0
    ds_read_b128 v[12:15], v20 offset:50688
    v_exp_f32 v61, v61
    v_exp_f32 v62, v62
    v_exp_f32 v63, v63
    v_exp_f32 v64, v64
    v_exp_f32 v65, v65
    v_smfmac_f32_32x32x32_bf16 v[104:119], v[40:43], v[56:63], v27
    v_exp_f32 v66, v66
    v_exp_f32 v67, v67
    v_exp_f32 v68, v68
    v_exp_f32 v69, v69
    v_exp_f32 v70, v70
    v_exp_f32 v71, v71
    v_exp_f32 v72, v72
    v_exp_f32 v73, v73
    v_smfmac_f32_32x32x32_bf16 v[104:119], v[44:47], v[64:71], v27
    v_exp_f32 v74, v74
    v_exp_f32 v75, v75
    v_exp_f32 v76, v76
    v_mfma_f32_32x32x16_bf16 v[56:71], v[16:19], v[8:11], 0
    v_exp_f32 v77, v77
    v_exp_f32 v78, v78
    v_exp_f32 v79, v79
    v_exp_f32 v80, v80
    v_exp_f32 v81, v81
    v_smfmac_f32_32x32x32_bf16 v[88:103], v[40:43], v[72:79], v27
    ds_read_b128 v[40:43], v23 offset:50688
    v_exp_f32 v82, v82
    v_exp_f32 v83, v83
    v_exp_f32 v84, v84
    v_exp_f32 v85, v85
    v_exp_f32 v86, v86
    v_exp_f32 v87, v87
    v_exp_f32 v56, v56
    v_exp_f32 v57, v57
    s_waitcnt lgkmcnt(1)
    v_smfmac_f32_32x32x32_bf16 v[88:103], v[44:47], v[80:87], v27
    ds_read_b128 v[44:47], v23 offset:51232
    v_exp_f32 v58, v58
    v_exp_f32 v59, v59
    v_exp_f32 v60, v60
    v_mfma_f32_32x32x16_bf16 v[72:87], v[16:19], v[4:7], 0
    ds_read_b128 v[16:19], v20 offset:54912
    v_exp_f32 v61, v61
    v_exp_f32 v62, v62
    v_exp_f32 v63, v63
    v_exp_f32 v64, v64
    v_exp_f32 v65, v65
    v_smfmac_f32_32x32x32_bf16 v[104:119], v[48:51], v[56:63], v27
    v_exp_f32 v66, v66
    v_exp_f32 v67, v67
    v_exp_f32 v68, v68
    v_exp_f32 v69, v69
    v_exp_f32 v70, v70
    v_exp_f32 v71, v71
    v_exp_f32 v72, v72
    v_exp_f32 v73, v73
    v_smfmac_f32_32x32x32_bf16 v[104:119], v[52:55], v[64:71], v27
    v_exp_f32 v74, v74
    v_exp_f32 v75, v75
    v_exp_f32 v76, v76
    v_mfma_f32_32x32x16_bf16 v[56:71], v[12:15], v[8:11], 0
    v_exp_f32 v77, v77
    v_exp_f32 v78, v78
    v_exp_f32 v79, v79
    v_exp_f32 v80, v80
    v_exp_f32 v81, v81
    v_smfmac_f32_32x32x32_bf16 v[88:103], v[48:51], v[72:79], v27
    ds_read_b128 v[48:51], v23 offset:54912
    v_exp_f32 v82, v82
    v_exp_f32 v83, v83
    v_exp_f32 v84, v84
    v_exp_f32 v85, v85
    v_exp_f32 v86, v86
    v_exp_f32 v87, v87
    v_exp_f32 v56, v56
    v_exp_f32 v57, v57
    s_waitcnt lgkmcnt(1)
    v_smfmac_f32_32x32x32_bf16 v[88:103], v[52:55], v[80:87], v27
    ds_read_b128 v[52:55], v23 offset:55456
    v_exp_f32 v58, v58
    v_exp_f32 v59, v59
    v_exp_f32 v60, v60
    v_mfma_f32_32x32x16_bf16 v[72:87], v[12:15], v[4:7], 0
    ds_read_b128 v[12:15], v20 offset:59136
    v_exp_f32 v61, v61
    v_exp_f32 v62, v62
    v_exp_f32 v63, v63
    v_exp_f32 v64, v64
    v_exp_f32 v65, v65
    v_smfmac_f32_32x32x32_bf16 v[104:119], v[40:43], v[56:63], v27
    v_exp_f32 v66, v66
    v_exp_f32 v67, v67
    v_exp_f32 v68, v68
    v_exp_f32 v69, v69
    v_exp_f32 v70, v70
    v_exp_f32 v71, v71
    v_exp_f32 v72, v72
    v_exp_f32 v73, v73
    v_smfmac_f32_32x32x32_bf16 v[104:119], v[44:47], v[64:71], v27
    v_exp_f32 v74, v74
    v_exp_f32 v75, v75
    v_exp_f32 v76, v76
    v_mfma_f32_32x32x16_bf16 v[56:71], v[16:19], v[8:11], 0
    v_exp_f32 v77, v77
    v_exp_f32 v78, v78
    v_exp_f32 v79, v79
    v_exp_f32 v80, v80
    v_exp_f32 v81, v81
    v_smfmac_f32_32x32x32_bf16 v[88:103], v[40:43], v[72:79], v27
    ds_read_b128 v[40:43], v23 offset:59136
    v_exp_f32 v82, v82
    v_exp_f32 v83, v83
    v_exp_f32 v84, v84
    v_exp_f32 v85, v85
    v_exp_f32 v86, v86
    v_exp_f32 v87, v87
    v_exp_f32 v56, v56
    v_exp_f32 v57, v57
    s_waitcnt lgkmcnt(1)
    v_smfmac_f32_32x32x32_bf16 v[88:103], v[44:47], v[80:87], v27
    ds_read_b128 v[44:47], v23 offset:59680
    v_exp_f32 v58, v58
    v_exp_f32 v59, v59
    v_exp_f32 v60, v60
    v_mfma_f32_32x32x16_bf16 v[72:87], v[16:19], v[4:7], 0
    ds_read_b128 v[16:19], v21 offset:0
    v_exp_f32 v61, v61
    v_exp_f32 v62, v62
    v_exp_f32 v63, v63
    v_exp_f32 v64, v64
    v_exp_f32 v65, v65
    v_smfmac_f32_32x32x32_bf16 v[104:119], v[48:51], v[56:63], v27
    v_exp_f32 v66, v66
    v_exp_f32 v67, v67
    v_exp_f32 v68, v68
    v_exp_f32 v69, v69
    v_exp_f32 v70, v70
    v_exp_f32 v71, v71
    v_exp_f32 v72, v72
    v_exp_f32 v73, v73
    v_smfmac_f32_32x32x32_bf16 v[104:119], v[52:55], v[64:71], v27
    v_exp_f32 v74, v74
    v_exp_f32 v75, v75
    v_exp_f32 v76, v76
    v_mfma_f32_32x32x16_bf16 v[56:71], v[12:15], v[8:11], 0
    v_exp_f32 v77, v77
    v_exp_f32 v78, v78
    v_exp_f32 v79, v79
    v_exp_f32 v80, v80
    v_exp_f32 v81, v81
    v_smfmac_f32_32x32x32_bf16 v[88:103], v[48:51], v[72:79], v27
    ds_read_b128 v[48:51], v24 offset:0
    v_exp_f32 v82, v82
    v_exp_f32 v83, v83
    v_exp_f32 v84, v84
    v_exp_f32 v85, v85
    v_exp_f32 v86, v86
    v_exp_f32 v87, v87
    v_and_b32 v122, 3, v1
    v_lshlrev_b32 v122, 2, v122
    v_add_u32 v122, 159776, v122
    s_mov_b32 s61, 262144
    ds_read_b32 v123, v122
    v_exp_f32 v56, v56
    v_exp_f32 v57, v57
    s_waitcnt lgkmcnt(1)
    v_smfmac_f32_32x32x32_bf16 v[88:103], v[52:55], v[80:87], v27
    ds_read_b128 v[52:55], v24 offset:544
    v_exp_f32 v58, v58
    v_exp_f32 v59, v59
    v_exp_f32 v60, v60
    v_mfma_f32_32x32x16_bf16 v[72:87], v[12:15], v[4:7], 0
    ds_read_b128 v[12:15], v21 offset:4224
    v_exp_f32 v61, v61
    v_exp_f32 v62, v62
    v_exp_f32 v63, v63
    v_exp_f32 v64, v64
    v_exp_f32 v65, v65
    v_smfmac_f32_32x32x32_bf16 v[104:119], v[40:43], v[56:63], v27
    v_exp_f32 v66, v66
    v_exp_f32 v67, v67
    v_exp_f32 v68, v68
    v_exp_f32 v69, v69
    v_exp_f32 v70, v70
    v_exp_f32 v71, v71
lw_kv2:
    s_waitcnt lgkmcnt(0)
    v_cmp_le_u32 vcc, 3, v123
    s_cmp_eq_u64 vcc, -1
    s_cbranch_scc0 lr_kv2
ld_kv2:
    v_exp_f32 v72, v72
    v_exp_f32 v73, v73
    v_smfmac_f32_32x32x32_bf16 v[104:119], v[44:47], v[64:71], v27
    v_exp_f32 v74, v74
    v_exp_f32 v75, v75
    v_exp_f32 v76, v76
    v_mfma_f32_32x32x16_bf16 v[56:71], v[16:19], v[8:11], 0
    v_exp_f32 v77, v77
    v_exp_f32 v78, v78
    v_exp_f32 v79, v79
    v_exp_f32 v80, v80
    v_exp_f32 v81, v81
    v_smfmac_f32_32x32x32_bf16 v[88:103], v[40:43], v[72:79], v27
    ds_read_b128 v[40:43], v24 offset:4224
    v_exp_f32 v82, v82
    v_exp_f32 v83, v83
    v_exp_f32 v84, v84
    v_exp_f32 v85, v85
    v_exp_f32 v86, v86
    v_exp_f32 v87, v87
    v_exp_f32 v56, v56
    v_exp_f32 v57, v57
    s_waitcnt lgkmcnt(1)
    v_smfmac_f32_32x32x32_bf16 v[88:103], v[44:47], v[80:87], v27
    ds_read_b128 v[44:47], v24 offset:4768
    v_exp_f32 v58, v58
    v_exp_f32 v59, v59
    v_exp_f32 v60, v60
    v_mfma_f32_32x32x16_bf16 v[72:87], v[16:19], v[4:7], 0
    ds_read_b128 v[16:19], v21 offset:8448
    v_exp_f32 v61, v61
    v_exp_f32 v62, v62
    v_exp_f32 v63, v63
    v_exp_f32 v64, v64
    v_exp_f32 v65, v65
    v_smfmac_f32_32x32x32_bf16 v[104:119], v[48:51], v[56:63], v27
    v_exp_f32 v66, v66
    v_exp_f32 v67, v67
    v_exp_f32 v68, v68
    v_exp_f32 v69, v69
    v_exp_f32 v70, v70
    v_exp_f32 v71, v71
    v_exp_f32 v72, v72
    v_exp_f32 v73, v73
    v_smfmac_f32_32x32x32_bf16 v[104:119], v[52:55], v[64:71], v27
    v_exp_f32 v74, v74
    v_exp_f32 v75, v75
    v_exp_f32 v76, v76
    v_mfma_f32_32x32x16_bf16 v[56:71], v[12:15], v[8:11], 0
    v_exp_f32 v77, v77
    v_exp_f32 v78, v78
    v_exp_f32 v79, v79
    v_exp_f32 v80, v80
    v_exp_f32 v81, v81
    v_smfmac_f32_32x32x32_bf16 v[88:103], v[48:51], v[72:79], v27
    ds_read_b128 v[48:51], v24 offset:8448
    v_exp_f32 v82, v82
    v_exp_f32 v83, v83
    v_exp_f32 v84, v84
    v_exp_f32 v85, v85
    v_exp_f32 v86, v86
    v_exp_f32 v87, v87
    v_exp_f32 v56, v56
    v_exp_f32 v57, v57
    s_waitcnt lgkmcnt(1)
    v_smfmac_f32_32x32x32_bf16 v[88:103], v[52:55], v[80:87], v27
    ds_read_b128 v[52:55], v24 offset:8992
    v_exp_f32 v58, v58
    v_exp_f32 v59, v59
    v_exp_f32 v60, v60
    v_mfma_f32_32x32x16_bf16 v[72:87], v[12:15], v[4:7], 0
    ds_read_b128 v[12:15], v21 offset:12672
    v_exp_f32 v61, v61
    v_exp_f32 v62, v62
    v_exp_f32 v63, v63
    v_exp_f32 v64, v64
    v_exp_f32 v65, v65
    v_smfmac_f32_32x32x32_bf16 v[104:119], v[40:43], v[56:63], v27
    v_exp_f32 v66, v66
    v_exp_f32 v67, v67
    v_exp_f32 v68, v68
    v_exp_f32 v69, v69
    v_exp_f32 v70, v70
    v_exp_f32 v71, v71
    v_exp_f32 v72, v72
    v_exp_f32 v73, v73
    v_smfmac_f32_32x32x32_bf16 v[104:119], v[44:47], v[64:71], v27
    v_exp_f32 v74, v74
    v_exp_f32 v75, v75
    v_exp_f32 v76, v76
    v_mfma_f32_32x32x16_bf16 v[56:71], v[16:19], v[8:11], 0
    v_exp_f32 v77, v77
    v_exp_f32 v78, v78
    v_exp_f32 v79, v79
pad_0:
    s_cbranch_execz pad_4
    v_exp_f32 v80, v80
    v_exp_f32 v81, v81
    v_smfmac_f32_32x32x32_bf16 v[88:103], v[40:43], v[72:79], v27
    ds_read_b128 v[40:43], v24 offset:12672
    v_exp_f32 v82, v82
    v_exp_f32 v83, v83
    v_exp_f32 v84, v84
    v_exp_f32 v85, v85
    v_exp_f32 v86, v86
    v_exp_f32 v87, v87
    v_exp_f32 v56, v56
    v_exp_f32 v57, v57
    s_waitcnt lgkmcnt(1)
    v_smfmac_f32_32x32x32_bf16 v[88:103], v[44:47], v[80:87], v27
    ds_read_b128 v[44:47], v24 offset:13216
    v_exp_f32 v58, v58
    v_exp_f32 v59, v59
    v_exp_f32 v60, v60
    v_mfma_f32_32x32x16_bf16 v[72:87], v[16:19], v[4:7], 0
    ds_read_b128 v[16:19], v21 offset:16896
    v_exp_f32 v61, v61
    v_exp_f32 v62, v62
    v_exp_f32 v63, v63
    v_exp_f32 v64, v64
    v_exp_f32 v65, v65
    v_smfmac_f32_32x32x32_bf16 v[104:119], v[48:51], v[56:63], v27
    v_exp_f32 v66, v66
    v_exp_f32 v67, v67
    v_exp_f32 v68, v68
    v_exp_f32 v69, v69
    v_exp_f32 v70, v70
    v_exp_f32 v71, v71
    v_exp_f32 v72, v72
    v_exp_f32 v73, v73
    v_smfmac_f32_32x32x32_bf16 v[104:119], v[52:55], v[64:71], v27
    v_exp_f32 v74, v74
    v_exp_f32 v75, v75
    v_exp_f32 v76, v76
    v_mfma_f32_32x32x16_bf16 v[56:71], v[12:15], v[8:11], 0
    v_exp_f32 v77, v77
    v_exp_f32 v78, v78
    v_exp_f32 v79, v79
    v_exp_f32 v80, v80
    v_exp_f32 v81, v81
    v_smfmac_f32_32x32x32_bf16 v[88:103], v[48:51], v[72:79], v27
    ds_read_b128 v[48:51], v24 offset:16896
    v_exp_f32 v82, v82
    v_exp_f32 v83, v83
    v_exp_f32 v84, v84
    v_exp_f32 v85, v85
    v_exp_f32 v86, v86
    v_exp_f32 v87, v87
    v_exp_f32 v56, v56
    v_exp_f32 v57, v57
    s_waitcnt lgkmcnt(1)
    v_smfmac_f32_32x32x32_bf16 v[88:103], v[52:55], v[80:87], v27
    ds_read_b128 v[52:55], v24 offset:17440
    v_exp_f32 v58, v58
    v_exp_f32 v59, v59
    v_exp_f32 v60, v60
    v_mfma_f32_32x32x16_bf16 v[72:87], v[12:15], v[4:7], 0
    ds_read_b128 v[12:15], v21 offset:21120
    v_exp_f32 v61, v61
    v_exp_f32 v62, v62
    v_exp_f32 v63, v63
    v_exp_f32 v64, v64
    v_exp_f32 v65, v65
    v_smfmac_f32_32x32x32_bf16 v[104:119], v[40:43], v[56:63], v27
    v_exp_f32 v66, v66
    v_exp_f32 v67, v67
    v_exp_f32 v68, v68
    v_exp_f32 v69, v69
    v_exp_f32 v70, v70
    v_exp_f32 v71, v71
    v_exp_f32 v72, v72
    v_exp_f32 v73, v73
    v_smfmac_f32_32x32x32_bf16 v[104:119], v[44:47], v[64:71], v27
    v_exp_f32 v74, v74
    v_exp_f32 v75, v75
    v_exp_f32 v76, v76
    v_mfma_f32_32x32x16_bf16 v[56:71], v[16:19], v[8:11], 0
    v_exp_f32 v77, v77
    v_exp_f32 v78, v78
    v_exp_f32 v79, v79
    v_exp_f32 v80, v80
    v_exp_f32 v81, v81
    v_smfmac_f32_32x32x32_bf16 v[88:103], v[40:43], v[72:79], v27
    ds_read_b128 v[40:43], v24 offset:21120
    v_exp_f32 v82, v82
    v_exp_f32 v83, v83
    v_exp_f32 v84, v84
    v_exp_f32 v85, v85
    v_exp_f32 v86, v86
    v_exp_f32 v87, v87
    v_exp_f32 v56, v56
    v_exp_f32 v57, v57
    s_waitcnt lgkmcnt(1)
    v_smfmac_f32_32x32x32_bf16 v[88:103], v[44:47], v[80:87], v27
    ds_read_b128 v[44:47], v24 offset:21664
    v_exp_f32 v58, v58
    v_exp_f32 v59, v59
    v_exp_f32 v60, v60
    v_mfma_f32_32x32x16_bf16 v[72:87], v[16:19], v[4:7], 0
    ds_read_b128 v[16:19], v21 offset:25344
    v_exp_f32 v61, v61
    v_exp_f32 v62, v62
    v_exp_f32 v63, v63
    v_exp_f32 v64, v64
    v_exp_f32 v65, v65
    v_smfmac_f32_32x32x32_bf16 v[104:119], v[48:51], v[56:63], v27
    v_exp_f32 v66, v66
    v_exp_f32 v67, v67
    v_exp_f32 v68, v68
    v_exp_f32 v69, v69
    v_exp_f32 v70, v70
    v_exp_f32 v71, v71
    v_exp_f32 v72, v72
    v_exp_f32 v73, v73
    v_smfmac_f32_32x32x32_bf16 v[104:119], v[52:55], v[64:71], v27
    v_exp_f32 v74, v74
    v_exp_f32 v75, v75
    v_exp_f32 v76, v76
    v_mfma_f32_32x32x16_bf16 v[56:71], v[12:15], v[8:11], 0
    v_exp_f32 v77, v77
    v_exp_f32 v78, v78
    v_exp_f32 v79, v79
    v_exp_f32 v80, v80
    v_exp_f32 v81, v81
    v_smfmac_f32_32x32x32_bf16 v[88:103], v[48:51], v[72:79], v27
    ds_read_b128 v[48:51], v24 offset:25344
    v_exp_f32 v82, v82
    v_exp_f32 v83, v83
    v_exp_f32 v84, v84
    v_exp_f32 v85, v85
    v_exp_f32 v86, v86
    v_exp_f32 v87, v87
    v_exp_f32 v56, v56
    v_exp_f32 v57, v57
    s_waitcnt lgkmcnt(1)
    v_smfmac_f32_32x32x32_bf16 v[88:103], v[52:55], v[80:87], v27
    ds_read_b128 v[52:55], v24 offset:25888
    v_exp_f32 v58, v58
    v_exp_f32 v59, v59
    v_exp_f32 v60, v60
    v_mfma_f32_32x32x16_bf16 v[72:87], v[12:15], v[4:7], 0
    ds_read_b128 v[12:15], v21 offset:29568
    v_exp_f32 v61, v61
    v_exp_f32 v62, v62
    v_exp_f32 v63, v63
    v_exp_f32 v64, v64
    v_exp_f32 v65, v65
    v_smfmac_f32_32x32x32_bf16 v[104:119], v[40:43], v[56:63], v27
    v_exp_f32 v66, v66
    v_exp_f32 v67, v67
    v_exp_f32 v68, v68
    v_exp_f32 v69, v69
    v_exp_f32 v70, v70
    v_exp_f32 v71, v71
    v_exp_f32 v72, v72
    v_exp_f32 v73, v73
    v_smfmac_f32_32x32x32_bf16 v[104:119], v[44:47], v[64:71], v27
    v_exp_f32 v74, v74
    v_exp_f32 v75, v75
    v_exp_f32 v76, v76
    v_mfma_f32_32x32x16_bf16 v[56:71], v[16:19], v[8:11], 0
    v_exp_f32 v77, v77
    v_exp_f32 v78, v78
    v_exp_f32 v79, v79
    v_exp_f32 v80, v80
    v_exp_f32 v81, v81
    v_smfmac_f32_32x32x32_bf16 v[88:103], v[40:43], v[72:79], v27
    ds_read_b128 v[40:43], v24 offset:29568
    v_exp_f32 v82, v82
    v_exp_f32 v83, v83
    v_exp_f32 v84, v84
    v_exp_f32 v85, v85
    v_exp_f32 v86, v86
    v_exp_f32 v87, v87
    v_exp_f32 v56, v56
    v_exp_f32 v57, v57
    s_waitcnt lgkmcnt(1)
    v_smfmac_f32_32x32x32_bf16 v[88:103], v[44:47], v[80:87], v27
    ds_read_b128 v[44:47], v24 offset:30112
    v_exp_f32 v58, v58
    v_exp_f32 v59, v59
    v_exp_f32 v60, v60
    v_mfma_f32_32x32x16_bf16 v[72:87], v[16:19], v[4:7], 0
    ds_read_b128 v[16:19], v21 offset:33792
    v_exp_f32 v61, v61
    v_exp_f32 v62, v62
    v_exp_f32 v63, v63
    v_exp_f32 v64, v64
    v_exp_f32 v65, v65
    v_smfmac_f32_32x32x32_bf16 v[104:119], v[48:51], v[56:63], v27
    v_exp_f32 v66, v66
    v_exp_f32 v67, v67
    v_exp_f32 v68, v68
    v_exp_f32 v69, v69
    v_exp_f32 v70, v70
    v_exp_f32 v71, v71
    v_exp_f32 v72, v72
    v_exp_f32 v73, v73
    v_smfmac_f32_32x32x32_bf16 v[104:119], v[52:55], v[64:71], v27
    v_exp_f32 v74, v74
    v_exp_f32 v75, v75
    v_exp_f32 v76, v76
    v_mfma_f32_32x32x16_bf16 v[56:71], v[12:15], v[8:11], 0
    v_exp_f32 v77, v77
    v_exp_f32 v78, v78
    v_exp_f32 v79, v79
    v_exp_f32 v80, v80
    v_exp_f32 v81, v81
    v_smfmac_f32_32x32x32_bf16 v[88:103], v[48:51], v[72:79], v27
    ds_read_b128 v[48:51], v24 offset:33792
    v_exp_f32 v82, v82
    v_exp_f32 v83, v83
    v_exp_f32 v84, v84
    v_exp_f32 v85, v85
    v_exp_f32 v86, v86
    v_exp_f32 v87, v87
    v_exp_f32 v56, v56
    v_exp_f32 v57, v57
    s_waitcnt lgkmcnt(1)
    v_smfmac_f32_32x32x32_bf16 v[88:103], v[52:55], v[80:87], v27
    ds_read_b128 v[52:55], v24 offset:34336
    v_exp_f32 v58, v58
    v_exp_f32 v59, v59
    v_exp_f32 v60, v60
    v_mfma_f32_32x32x16_bf16 v[72:87], v[12:15], v[4:7], 0
    ds_read_b128 v[12:15], v21 offset:38016
    v_exp_f32 v61, v61
    v_exp_f32 v62, v62
    v_exp_f32 v63, v63
    v_exp_f32 v64, v64
    v_exp_f32 v65, v65
    v_smfmac_f32_32x32x32_bf16 v[104:119], v[40:43], v[56:63], v27
    v_exp_f32 v66, v66
    v_exp_f32 v67, v67
    v_exp_f32 v68, v68
    v_exp_f32 v69, v69
    v_exp_f32 v70, v70
    v_exp_f32 v71, v71
    v_exp_f32 v72, v72
    v_exp_f32 v73, v73
    v_smfmac_f32_32x32x32_bf16 v[104:119], v[44:47], v[64:71], v27
    v_exp_f32 v74, v74
    v_exp_f32 v75, v75
    v_exp_f32 v76, v76
    v_mfma_f32_32x32x16_bf16 v[56:71], v[16:19], v[8:11], 0
    v_exp_f32 v77, v77
    v_exp_f32 v78, v78
    v_exp_f32 v79, v79
    v_exp_f32 v80, v80
    v_exp_f32 v81, v81
    v_smfmac_f32_32x32x32_bf16 v[88:103], v[40:43], v[72:79], v27
    ds_read_b128 v[40:43], v24 offset:38016
    v_exp_f32 v82, v82
    v_exp_f32 v83, v83
    v_exp_f32 v84, v84
    v_exp_f32 v85, v85
    v_exp_f32 v86, v86
    v_exp_f32 v87, v87
    v_exp_f32 v56, v56
    v_exp_f32 v57, v57
    s_waitcnt lgkmcnt(1)
    v_smfmac_f32_32x32x32_bf16 v[88:103], v[44:47], v[80:87], v27
    ds_read_b128 v[44:47], v24 offset:38560
    v_exp_f32 v58, v58
    v_exp_f32 v59, v59
    v_exp_f32 v60, v60
    v_mfma_f32_32x32x16_bf16 v[72:87], v[16:19], v[4:7], 0
    ds_read_b128 v[16:19], v21 offset:42240
    v_exp_f32 v61, v61
    v_exp_f32 v62, v62
    v_exp_f32 v63, v63
    v_exp_f32 v64, v64
    v_exp_f32 v65, v65
    v_smfmac_f32_32x32x32_bf16 v[104:119], v[48:51], v[56:63], v27
    v_exp_f32 v66, v66
    v_exp_f32 v67, v67
    v_exp_f32 v68, v68
    v_exp_f32 v69, v69
    v_exp_f32 v70, v70
    v_exp_f32 v71, v71
    v_exp_f32 v72, v72
    v_exp_f32 v73, v73
    v_smfmac_f32_32x32x32_bf16 v[104:119], v[52:55], v[64:71], v27
    v_exp_f32 v74, v74
    v_exp_f32 v75, v75
    v_exp_f32 v76, v76
    v_mfma_f32_32x32x16_bf16 v[56:71], v[12:15], v[8:11], 0
    v_exp_f32 v77, v77
    v_exp_f32 v78, v78
    v_exp_f32 v79, v79
    v_exp_f32 v80, v80
    v_exp_f32 v81, v81
    v_smfmac_f32_32x32x32_bf16 v[88:103], v[48:51], v[72:79], v27
    ds_read_b128 v[48:51], v24 offset:42240
    v_exp_f32 v82, v82
    v_exp_f32 v83, v83
    v_exp_f32 v84, v84
    v_exp_f32 v85, v85
    v_exp_f32 v86, v86
    v_exp_f32 v87, v87
    v_exp_f32 v56, v56
    v_exp_f32 v57, v57
    s_waitcnt lgkmcnt(1)
    v_smfmac_f32_32x32x32_bf16 v[88:103], v[52:55], v[80:87], v27
    ds_read_b128 v[52:55], v24 offset:42784
    v_exp_f32 v58, v58
    v_exp_f32 v59, v59
    v_exp_f32 v60, v60
    v_mfma_f32_32x32x16_bf16 v[72:87], v[12:15], v[4:7], 0
    ds_read_b128 v[12:15], v21 offset:46464
    v_exp_f32 v61, v61
    v_exp_f32 v62, v62
    v_exp_f32 v63, v63
    v_exp_f32 v64, v64
    v_exp_f32 v65, v65
    v_smfmac_f32_32x32x32_bf16 v[104:119], v[40:43], v[56:63], v27
    v_exp_f32 v66, v66
    v_exp_f32 v67, v67
    v_exp_f32 v68, v68
    v_exp_f32 v69, v69
    v_exp_f32 v70, v70
    v_exp_f32 v71, v71
    v_exp_f32 v72, v72
    v_exp_f32 v73, v73
    v_smfmac_f32_32x32x32_bf16 v[104:119], v[44:47], v[64:71], v27
    v_exp_f32 v74, v74
    v_exp_f32 v75, v75
    v_exp_f32 v76, v76
    v_mfma_f32_32x32x16_bf16 v[56:71], v[16:19], v[8:11], 0
    v_exp_f32 v77, v77
    v_exp_f32 v78, v78
    v_exp_f32 v79, v79
    v_exp_f32 v80, v80
    v_exp_f32 v81, v81
    v_smfmac_f32_32x32x32_bf16 v[88:103], v[40:43], v[72:79], v27
    ds_read_b128 v[40:43], v24 offset:46464
    v_exp_f32 v82, v82
    v_exp_f32 v83, v83
    v_exp_f32 v84, v84
    v_exp_f32 v85, v85
    v_exp_f32 v86, v86
    v_exp_f32 v87, v87
    v_exp_f32 v56, v56
    v_exp_f32 v57, v57
    s_waitcnt lgkmcnt(1)
    v_smfmac_f32_32x32x32_bf16 v[88:103], v[44:47], v[80:87], v27
    ds_read_b128 v[44:47], v24 offset:47008
    v_exp_f32 v58, v58
    v_exp_f32 v59, v59
    v_exp_f32 v60, v60
    v_mfma_f32_32x32x16_bf16 v[72:87], v[16:19], v[4:7], 0
    ds_read_b128 v[16:19], v21 offset:50688
    v_exp_f32 v61, v61
    v_exp_f32 v62, v62
    v_exp_f32 v63, v63
    v_exp_f32 v64, v64
    v_exp_f32 v65, v65
    v_smfmac_f32_32x32x32_bf16 v[104:119], v[48:51], v[56:63], v27
    v_exp_f32 v66, v66
    v_exp_f32 v67, v67
    v_exp_f32 v68, v68
    v_exp_f32 v69, v69
    v_exp_f32 v70, v70
    v_exp_f32 v71, v71
    v_exp_f32 v72, v72
    v_exp_f32 v73, v73
    v_smfmac_f32_32x32x32_bf16 v[104:119], v[52:55], v[64:71], v27
    v_exp_f32 v74, v74
    v_exp_f32 v75, v75
    v_exp_f32 v76, v76
    v_mfma_f32_32x32x16_bf16 v[56:71], v[12:15], v[8:11], 0
    v_exp_f32 v77, v77
    v_exp_f32 v78, v78
    v_exp_f32 v79, v79
    v_exp_f32 v80, v80
    v_exp_f32 v81, v81
    v_smfmac_f32_32x32x32_bf16 v[88:103], v[48:51], v[72:79], v27
    ds_read_b128 v[48:51], v24 offset:50688
    v_exp_f32 v82, v82
    v_exp_f32 v83, v83
    v_exp_f32 v84, v84
    v_exp_f32 v85, v85
    v_exp_f32 v86, v86
    v_exp_f32 v87, v87
    v_exp_f32 v56, v56
    v_exp_f32 v57, v57
    s_waitcnt lgkmcnt(1)
    v_smfmac_f32_32x32x32_bf16 v[88:103], v[52:55], v[80:87], v27
    ds_read_b128 v[52:55], v24 offset:51232
    v_exp_f32 v58, v58
    v_exp_f32 v59, v59
    v_exp_f32 v60, v60
    v_mfma_f32_32x32x16_bf16 v[72:87], v[12:15], v[4:7], 0
    ds_read_b128 v[12:15], v21 offset:54912
    v_exp_f32 v61, v61
    v_exp_f32 v62, v62
    v_exp_f32 v63, v63
    v_exp_f32 v64, v64
    v_exp_f32 v65, v65
    v_smfmac_f32_32x32x32_bf16 v[104:119], v[40:43], v[56:63], v27
    v_exp_f32 v66, v66
    v_exp_f32 v67, v67
    v_exp_f32 v68, v68
    v_exp_f32 v69, v69
    v_exp_f32 v70, v70
    v_exp_f32 v71, v71
    v_exp_f32 v72, v72
    v_exp_f32 v73, v73
    v_smfmac_f32_32x32x32_bf16 v[104:119], v[44:47], v[64:71], v27
    v_exp_f32 v74, v74
    v_exp_f32 v75, v75
    v_exp_f32 v76, v76
    v_mfma_f32_32x32x16_bf16 v[56:71], v[16:19], v[8:11], 0
    v_exp_f32 v77, v77
    v_exp_f32 v78, v78
    v_exp_f32 v79, v79
    v_exp_f32 v80, v80
    v_exp_f32 v81, v81
    v_smfmac_f32_32x32x32_bf16 v[88:103], v[40:43], v[72:79], v27
    ds_read_b128 v[40:43], v24 offset:54912
    v_exp_f32 v82, v82
    v_exp_f32 v83, v83
    v_exp_f32 v84, v84
    v_exp_f32 v85, v85
    v_exp_f32 v86, v86
    v_exp_f32 v87, v87
    v_exp_f32 v56, v56
    v_exp_f32 v57, v57
    s_waitcnt lgkmcnt(1)
    v_smfmac_f32_32x32x32_bf16 v[88:103], v[44:47], v[80:87], v27
    ds_read_b128 v[44:47], v24 offset:55456
    v_exp_f32 v58, v58
    v_exp_f32 v59, v59
    v_exp_f32 v60, v60
    v_mfma_f32_32x32x16_bf16 v[72:87], v[16:19], v[4:7], 0
    ds_read_b128 v[16:19], v21 offset:59136
    v_exp_f32 v61, v61
    v_exp_f32 v62, v62
    v_exp_f32 v63, v63
    v_exp_f32 v64, v64
    v_exp_f32 v65, v65
    v_smfmac_f32_32x32x32_bf16 v[104:119], v[48:51], v[56:63], v27
    v_exp_f32 v66, v66
    v_exp_f32 v67, v67
    v_exp_f32 v68, v68
    v_exp_f32 v69, v69
    v_exp_f32 v70, v70
    v_exp_f32 v71, v71
    v_exp_f32 v72, v72
    v_exp_f32 v73, v73
    v_smfmac_f32_32x32x32_bf16 v[104:119], v[52:55], v[64:71], v27
    v_exp_f32 v74, v74
    v_exp_f32 v75, v75
    v_exp_f32 v76, v76
    v_mfma_f32_32x32x16_bf16 v[56:71], v[12:15], v[8:11], 0
    v_exp_f32 v77, v77
    v_exp_f32 v78, v78
    v_exp_f32 v79, v79
    v_exp_f32 v80, v80
    v_exp_f32 v81, v81
    v_smfmac_f32_32x32x32_bf16 v[88:103], v[48:51], v[72:79], v27
    ds_read_b128 v[48:51], v24 offset:59136
    v_exp_f32 v82, v82
    v_exp_f32 v83, v83
    v_exp_f32 v84, v84
    v_exp_f32 v85, v85
    v_exp_f32 v86, v86
    v_exp_f32 v87, v87
    v_exp_f32 v56, v56
    v_exp_f32 v57, v57
    s_waitcnt lgkmcnt(1)
    v_smfmac_f32_32x32x32_bf16 v[88:103], v[52:55], v[80:87], v27
    ds_read_b128 v[52:55], v24 offset:59680
    v_exp_f32 v58, v58
    v_exp_f32 v59, v59
    v_exp_f32 v60, v60
    v_mfma_f32_32x32x16_bf16 v[72:87], v[12:15], v[4:7], 0
    ds_read_b128 v[12:15], v22 offset:0
    v_exp_f32 v61, v61
    v_exp_f32 v62, v62
    v_exp_f32 v63, v63
    v_exp_f32 v64, v64
    v_exp_f32 v65, v65
    v_smfmac_f32_32x32x32_bf16 v[104:119], v[40:43], v[56:63], v27
    v_exp_f32 v66, v66
    v_exp_f32 v67, v67
    v_exp_f32 v68, v68
    v_exp_f32 v69, v69
    v_exp_f32 v70, v70
    v_exp_f32 v71, v71
    v_exp_f32 v72, v72
    v_exp_f32 v73, v73
    v_smfmac_f32_32x32x32_bf16 v[104:119], v[44:47], v[64:71], v27
    v_exp_f32 v74, v74
    v_exp_f32 v75, v75
    v_exp_f32 v76, v76
    v_mfma_f32_32x32x16_bf16 v[56:71], v[16:19], v[8:11], 0
    v_exp_f32 v77, v77
    v_exp_f32 v78, v78
    v_exp_f32 v79, v79
    v_exp_f32 v80, v80
    v_exp_f32 v81, v81
    v_smfmac_f32_32x32x32_bf16 v[88:103], v[40:43], v[72:79], v27
    ds_read_b128 v[40:43], v25 offset:0
    v_exp_f32 v82, v82
    v_exp_f32 v83, v83
    v_exp_f32 v84, v84
    v_exp_f32 v85, v85
    v_exp_f32 v86, v86
    v_exp_f32 v87, v87
    v_exp_f32 v56, v56
    v_exp_f32 v57, v57
    s_waitcnt lgkmcnt(1)
    v_smfmac_f32_32x32x32_bf16 v[88:103], v[44:47], v[80:87], v27
    ds_read_b128 v[44:47], v25 offset:544
    v_exp_f32 v58, v58
    v_exp_f32 v59, v59
    v_exp_f32 v60, v60
    v_mfma_f32_32x32x16_bf16 v[72:87], v[16:19], v[4:7], 0
    ds_read_b128 v[16:19], v22 offset:4224
    v_exp_f32 v61, v61
    v_exp_f32 v62, v62
    v_exp_f32 v63, v63
    v_exp_f32 v64, v64
    v_exp_f32 v65, v65
    v_smfmac_f32_32x32x32_bf16 v[104:119], v[48:51], v[56:63], v27
    v_exp_f32 v66, v66
    v_exp_f32 v67, v67
    v_exp_f32 v68, v68
    v_exp_f32 v69, v69
    v_exp_f32 v70, v70
    v_exp_f32 v71, v71
    v_exp_f32 v72, v72
    v_exp_f32 v73, v73
    v_smfmac_f32_32x32x32_bf16 v[104:119], v[52:55], v[64:71], v27
    v_exp_f32 v74, v74
    v_exp_f32 v75, v75
    v_exp_f32 v76, v76
    v_mfma_f32_32x32x16_bf16 v[56:71], v[12:15], v[8:11], 0
    v_exp_f32 v77, v77
    v_exp_f32 v78, v78
    v_exp_f32 v79, v79
    v_exp_f32 v80, v80
    v_exp_f32 v81, v81
    v_smfmac_f32_32x32x32_bf16 v[88:103], v[48:51], v[72:79], v27
    ds_read_b128 v[48:51], v25 offset:4224
    v_exp_f32 v82, v82
    v_exp_f32 v83, v83
    v_exp_f32 v84, v84
    v_exp_f32 v85, v85
    v_exp_f32 v86, v86
    v_exp_f32 v87, v87
    v_exp_f32 v56, v56
    v_exp_f32 v57, v57
    s_waitcnt lgkmcnt(1)
    v_smfmac_f32_32x32x32_bf16 v[88:103], v[52:55], v[80:87], v27
    ds_read_b128 v[52:55], v25 offset:4768
    v_exp_f32 v58, v58
    v_exp_f32 v59, v59
    v_exp_f32 v60, v60
    v_mfma_f32_32x32x16_bf16 v[72:87], v[16:19], v[8:11], 0
    v_exp_f32 v61, v61
    v_exp_f32 v62, v62
    v_exp_f32 v63, v63
    v_exp_f32 v64, v64
    v_exp_f32 v65, v65
    v_smfmac_f32_32x32x32_bf16 v[104:119], v[40:43], v[56:63], v27
    v_exp_f32 v66, v66
    v_exp_f32 v67, v67
    v_exp_f32 v68, v68
    v_exp_f32 v69, v69
    v_exp_f32 v70, v70
    v_exp_f32 v71, v71
    v_exp_f32 v72, v72
    v_exp_f32 v73, v73
    s_waitcnt lgkmcnt(0)
    v_smfmac_f32_32x32x32_bf16 v[104:119], v[44:47], v[64:71], v27
    v_exp_f32 v74, v74
    v_exp_f32 v75, v75
    v_exp_f32 v76, v76
    v_mfma_f32_32x32x16_bf16 v[56:71], v[12:15], v[4:7], 0
    v_exp_f32 v77, v77
    v_exp_f32 v78, v78
    v_exp_f32 v79, v79
    v_exp_f32 v80, v80
    v_exp_f32 v81, v81
    v_smfmac_f32_32x32x32_bf16 v[104:119], v[48:51], v[72:79], v27
    v_exp_f32 v82, v82
    v_exp_f32 v83, v83
    v_exp_f32 v84, v84
    v_exp_f32 v85, v85
    v_exp_f32 v86, v86
    v_exp_f32 v87, v87
    v_exp_f32 v56, v56
    v_exp_f32 v57, v57
    v_smfmac_f32_32x32x32_bf16 v[104:119], v[52:55], v[80:87], v27
    v_exp_f32 v58, v58
    v_exp_f32 v59, v59
    v_exp_f32 v60, v60
    v_mfma_f32_32x32x16_bf16 v[72:87], v[16:19], v[4:7], 0
    v_exp_f32 v61, v61
    v_exp_f32 v62, v62
    v_exp_f32 v63, v63
    v_exp_f32 v64, v64
    v_exp_f32 v65, v65
    v_exp_f32 v66, v66
    v_exp_f32 v67, v67
    v_exp_f32 v68, v68
    v_smfmac_f32_32x32x32_bf16 v[88:103], v[40:43], v[56:63], v27
    ds_write_b32 v30, v112
    ds_write_b128 v28, v[104:107]
    ds_write_b128 v28, v[108:111] offset:1024
    ds_write_b32 v120, v27
    v_exp_f32 v69, v69
    v_exp_f32 v70, v70
    v_exp_f32 v71, v71
    v_exp_f32 v72, v72
    v_exp_f32 v73, v73
    v_smfmac_f32_32x32x32_bf16 v[88:103], v[44:47], v[64:71], v27
    v_exp_f32 v74, v74
    v_exp_f32 v75, v75
    v_exp_f32 v76, v76
    v_exp_f32 v77, v77
    v_exp_f32 v78, v78
    v_exp_f32 v79, v79
    v_exp_f32 v80, v80
    v_exp_f32 v81, v81
    v_smfmac_f32_32x32x32_bf16 v[88:103], v[48:51], v[72:79], v27
    ds_read_b32 v114, v121
    ds_read_b32 v112, v31
    ds_read_b128 v[104:107], v29
    ds_read_b128 v[108:111], v29 offset:1024
    v_exp_f32 v82, v82
    v_exp_f32 v83, v83
    v_exp_f32 v84, v84
    v_exp_f32 v85, v85
    v_exp_f32 v86, v86
    v_exp_f32 v87, v87
    s_mov_b32 s56, 0x1f800000
    s_mov_b32 s57, 0x5f800000
    v_smfmac_f32_32x32x32_bf16 v[88:103], v[52:55], v[80:87], v27
    s_mov_b32 s61, 262144
    v_mov_b32 v17, 1
    v_mov_b32 v18, 0x40000000
    s_mov_b32 exec_hi, 0
    v_lshlrev_b32 v18, 4, v1
    s_mov_b32 exec_hi, -1
    s_nop 2
xw_a:
    s_waitcnt lgkmcnt(0) vmcnt(0)
    v_cmp_ne_u32 vcc, 0, v114
    s_cmp_eq_u64 vcc, -1
    s_cbranch_scc0 xr_a
xd_a:
    v_add_f32 v96, v96, v112
    v_pk_add_f32 v[88:89], v[88:89], v[104:105]
    v_pk_add_f32 v[90:91], v[90:91], v[106:107]
    v_cmp_lt_f32 vcc, s56, v96
    v_cmp_gt_f32 s[96:97], s57, v96
    v_rcp_f32 v98, v96
    v_pk_add_f32 v[92:93], v[92:93], v[108:109]
    v_pk_add_f32 v[94:95], v[94:95], v[110:111]
    s_and_b64 vcc, vcc, s[96:97]
    s_cmp_eq_u64 vcc, -1
    s_cbranch_scc0 slow_a
norm_a:
    v_mov_b32 v99, v98
    v_pk_mul_f32 v[88:89], v[88:89], v[98:99]
    v_pk_mul_f32 v[90:91], v[90:91], v[98:99]
    v_pk_mul_f32 v[92:93], v[92:93], v[98:99]
    v_pk_mul_f32 v[94:95], v[94:95], v[98:99]
    v_cvt_pk_bf16_f32 v12, v88, v89
    v_cvt_pk_bf16_f32 v13, v90, v91
    v_cvt_pk_bf16_f32 v14, v92, v93
    v_cvt_pk_bf16_f32 v15, v94, v95
    buffer_store_dwordx4 v[12:15], v2, s[28:31], s60 offen sc1
    v_pk_mul_f32 v[100:101], v[88:89], v[32:33]
    v_pk_fma_f32 v[100:101], v[90:91], v[34:35], v[100:101]
    v_pk_fma_f32 v[100:101], v[92:93], v[36:37], v[100:101]
    v_pk_fma_f32 v[100:101], v[94:95], v[38:39], v[100:101]
    v_add_f32 v102, v100, v101
    v_add_f32 v100, v100, v101
    s_nop 1
    v_permlane32_swap_b32 v100, v102
    v_add_f32 v100, v100, v102
    buffer_store_dword v100, v18, s[28:31], s46 offen sc1
    v_and_b32 v0, 31, v1
    v_lshlrev_b32 v105, 10, v0
    v_lshl_add_u32 v105, v3, 1, v105
    v_lshlrev_b32 v107, 4, v0
    v_lshl_add_u32 v107, v3, 6, v107
    v_and_b32 v106, 15, v1
    v_lshlrev_b32 v106, 4, v106
    v_lshl_add_u32 v106, v3, 5, v106
    v_and_b32 v3, 16, v1
    v_lshl_add_u32 v106, v3, 6, v106
    v_lshlrev_b32 v0, 2, v0
    buffer_load_dwordx4 v[56:59], v105, s[32:35], s3 offen
    buffer_load_dwordx4 v[60:63], v105, s[32:35], s3 offen offset:16
    buffer_load_dword v104, v0, s[28:31], s27 offen
    v_mov_b32 v108, 0x40000000
    s_mov_b64 exec, 0xffff
    v_lshlrev_b32 v108, 7, v1
    s_mov_b64 exec, -1
    v_and_b32 v110, 3, v1
    v_lshlrev_b32 v110, 2, v110
    v_add_u32 v110, 159792, v110
    s_mov_b32 s61, 262144
    ds_read_b32 v111, v110
lw_wd:
    s_waitcnt lgkmcnt(0)
    v_cmp_le_u32 vcc, 1, v111
    s_cmp_eq_u64 vcc, -1
    s_cbranch_scc0 lr_wd
ld_wd:
    v_readfirstlane_b32 s98, v111
    s_mul_i32 s63, s55, 229376
    s_lshl_b32 s58, s53, 13
    s_add_u32 s63, s63, s58
    s_add_u32 s63, s63, 5242880
    s_sub_u32 s98, s98, 1
    s_and_b32 s101, s54, 1
    s_lshl_b32 s101, s101, 12
    s_add_u32 s101, s101, s63
    v_and_b32 v5, 15, v1
    v_lshlrev_b32 v5, 2, v5
    s_add_u32 s57, s45, 32896
    s_and_b32 s46, s46, 0xfffff000
    s_mov_b64 exec, 0xff
    s_add_u32 s56, s60, 4096
    buffer_load_dword v109, v108, s[28:31], s56 offen sc1
    s_mov_b64 exec, -1
    s_and_b32 s57, s46, 0xfffff000
    s_and_b32 s56, s55, 3
    s_lshl_b32 s56, s56, 9
    s_add_u32 s57, s57, s56
    s_mov_b64 exec, 0xf
    s_add_u32 s56, s57, 2048
    buffer_load_dword v109, v108, s[28:31], s56 offen sc1
    s_mov_b64 exec, -1
    s_lshr_b32 s26, s44, 15
    s_lshl_b32 s26, s26, 11
    s_and_b32 s56, s55, 3
    s_lshl_b32 s56, s56, 8
    s_add_u32 s26, s26, s56
    s_lshl_b32 s56, s53, 2
    s_add_u32 s26, s26, s56
    s_add_u32 s26, s26, 11796480
    s_mov_b64 exec, 0x3
    s_add_u32 s56, s26, 0
    buffer_load_dword v109, v108, s[28:31], s56 offen sc1
    s_mov_b64 exec, -1
    s_mov_b64 exec, 0x3
    s_add_u32 s56, s26, 1024
    buffer_load_dword v109, v108, s[28:31], s56 offen sc1
    s_mov_b64 exec, -1
    s_lshl_b32 s27, s53, 11
    s_add_u32 s27, s27, s44
    s_add_u32 s27, s27, 0
    s_add_u32 s56, s27, 0
    buffer_load_dword v109, v108, s[28:31], s56 offen sc1
    s_mov_b64 exec, 0x3
    s_add_u32 s56, s45, 16384
    buffer_load_dword v109, v108, s[28:31], s56 offen sc1
    s_mov_b64 exec, -1
    s_mov_b64 exec, 0x3
    s_add_u32 s56, s45, 32768
    buffer_load_dword v109, v108, s[28:31], s56 offen sc1
    s_mov_b64 exec, -1
    s_add_u32 s57, s45, 32896
    s_add_u32 s56, s101, 32768
    buffer_load_dword v109, v108, s[28:31], s56 offen sc1
    buffer_load_dwordx4 v[128:131], v2, s[28:31], s59 offen offset:0
    buffer_load_dwordx4 v[132:135], v2, s[28:31], s59 offen offset:1024
    buffer_load_dwordx4 v[136:139], v2, s[28:31], s59 offen offset:2048
    buffer_load_dwordx4 v[140:143], v2, s[28:31], s59 offen offset:3072
    s_add_u32 s59, s59, 0x1000
    buffer_load_dwordx4 v[144:147], v2, s[28:31], s59 offen offset:0
    buffer_load_dwordx4 v[148:151], v2, s[28:31], s59 offen offset:1024
    buffer_load_dwordx4 v[152:155], v2, s[28:31], s59 offen offset:2048
    buffer_load_dwordx4 v[156:159], v2, s[28:31], s59 offen offset:3072
    s_add_u32 s56, s101, 34816
    buffer_load_dword v109, v108, s[28:31], s56 offen sc1
    s_add_u32 s59, s59, 0x1000
    buffer_load_dwordx4 v[160:163], v2, s[28:31], s59 offen offset:0
    buffer_load_dwordx4 v[164:167], v2, s[28:31], s59 offen offset:1024
    buffer_load_dwordx4 v[168:171], v2, s[28:31], s59 offen offset:2048
    buffer_load_dwordx4 v[172:175], v2, s[28:31], s59 offen offset:3072
    s_add_u32 s59, s59, 0x1000
    buffer_load_dwordx4 v[176:179], v2, s[28:31], s59 offen offset:0
    buffer_load_dwordx4 v[180:183], v2, s[28:31], s59 offen offset:1024
    s_waitcnt vmcnt(23)
    s_cmp_eq_u32 s98, 1
    s_cbranch_scc0 far_fa
    buffer_store_dword v17, v26, s[28:31], s47 offen
back_fa:
    v_lshlrev_b32 v112, 16, v56
    v_and_b32 v113, 0xffff0000, v56
    v_lshlrev_b32 v114, 16, v57
    v_and_b32 v115, 0xffff0000, v57
    v_lshlrev_b32 v116, 16, v58
    v_and_b32 v117, 0xffff0000, v58
    v_lshlrev_b32 v118, 16, v59
    v_and_b32 v119, 0xffff0000, v59
    v_lshlrev_b32 v120, 16, v60
    v_and_b32 v121, 0xffff0000, v60
pad_1:
    s_cbranch_execz pad_5
    v_lshlrev_b32 v122, 16, v61
    v_and_b32 v123, 0xffff0000, v61
    v_lshlrev_b32 v124, 16, v62
    v_and_b32 v125, 0xffff0000, v62
    v_lshlrev_b32 v126, 16, v63
    v_and_b32 v127, 0xffff0000, v63
    v_mov_b32 v9, v26
    v_mov_b32 v13, 1
    v_add_u32 v6, 135168, v2
    buffer_load_dwordx4 v[184:187], v2, s[28:31], s59 offen offset:2048
    buffer_load_dwordx4 v[188:191], v2, s[28:31], s59 offen offset:3072
    s_add_u32 s56, s101, 65536
    buffer_load_dword v109, v108, s[28:31], s56 offen sc1
    s_add_u32 s59, s59, 0x1000
    buffer_load_dwordx4 v[192:195], v2, s[28:31], s59 offen offset:0
    buffer_load_dwordx4 v[196:199], v2, s[28:31], s59 offen offset:1024
    buffer_load_dwordx4 v[200:203], v2, s[28:31], s59 offen offset:2048
    buffer_load_dwordx4 v[204:207], v2, s[28:31], s59 offen offset:3072
    s_add_u32 s59, s59, 0x1000
    buffer_load_dwordx4 v[208:211], v2, s[28:31], s59 offen offset:0
    buffer_load_dwordx4 v[212:215], v2, s[28:31], s59 offen offset:1024
    buffer_load_dwordx4 v[216:219], v2, s[28:31], s59 offen offset:2048
    buffer_load_dwordx4 v[220:223], v2, s[28:31], s59 offen offset:3072
    s_add_u32 s56, s101, 67584
    buffer_load_dword v109, v108, s[28:31], s56 offen sc1
    s_add_u32 s59, s59, 0x1000
    buffer_load_dwordx4 v[224:227], v2, s[28:31], s59 offen offset:0
    buffer_load_dwordx4 v[228:231], v2, s[28:31], s59 offen offset:1024
    buffer_load_dword v4, v5, s[28:31], s57 offen sc1
    buffer_load_dwordx4 v[232:235], v2, s[28:31], s59 offen offset:2048
    buffer_load_dwordx4 v[236:239], v2, s[28:31], s59 offen offset:3072
    s_add_u32 s59, s59, 0x1000
    buffer_load_dwordx4 v[240:243], v2, s[28:31], s59 offen offset:0
    buffer_load_dwordx4 v[244:247], v2, s[28:31], s59 offen offset:1024
    buffer_load_dwordx4 v[248:251], v2, s[28:31], s59 offen offset:2048
    buffer_load_dwordx4 v[252:255], v2, s[28:31], s59 offen offset:3072
    s_and_b32 s59, s44, 0xffff8000
    s_add_u32 s59, s59, 9437184
    s_lshl_b32 s56, s53, 13
    s_add_u32 s59, s59, s56
    s_add_u32 s56, s101, 98304
    buffer_load_dword v109, v108, s[28:31], s56 offen sc1
    s_lshl_b32 s56, s53, 12
    s_add_u32 m0, s56, 135168
    s_waitcnt vmcnt(7)
    s_mov_b32 s61, 32768
poll_o0:
    v_cmp_le_u32 vcc, 1, v4
    s_cmp_eq_u64 vcc, -1
    s_cbranch_scc0 again_o0
done_o0:
    buffer_load_dwordx4 v[80:83], v107, s[28:31], s46 offen offset:0 sc1
    buffer_load_dwordx4 v[84:87], v107, s[28:31], s46 offen offset:512 sc1
    buffer_load_dwordx4 v2, s[28:31], s59 offen offset:0 sc1 lds
    buffer_load_dwordx4 v2, s[28:31], s59 offen offset:1024 sc1 lds
    buffer_load_dwordx4 v2, s[28:31], s59 offen offset:2048 sc1 lds
    buffer_load_dwordx4 v2, s[28:31], s59 offen offset:3072 sc1 lds
    s_add_u32 s56, s101, 100352
    buffer_load_dword v109, v108, s[28:31], s56 offen sc1
    v_and_b32 v110, 3, v1
    v_lshlrev_b32 v110, 2, v110
    v_add_u32 v110, 159744, v110
    s_mov_b32 s61, 262144
    ds_read_b32 v111, v110
lw_s0:
    s_waitcnt lgkmcnt(0)
    v_cmp_le_u32 vcc, 1, v111
    s_cmp_eq_u64 vcc, -1
    s_cbranch_scc0 lr_s0
ld_s0:
    s_add_u32 m0, s58, 0
    s_add_u32 s56, s63, 0
    buffer_load_dwordx4 v2, s[28:31], s56 offen offset:0 sc1 lds
    buffer_load_dwordx4 v2, s[28:31], s56 offen offset:1024 sc1 lds
    buffer_load_dwordx4 v2, s[28:31], s56 offen offset:2048 sc1 lds
    buffer_load_dwordx4 v2, s[28:31], s56 offen offset:3072 sc1 lds
    s_add_u32 s56, s101, 131072
    buffer_load_dword v109, v108, s[28:31], s56 offen sc1
    s_add_u32 m0, s58, 4096
    s_add_u32 s56, s63, 4096
    buffer_load_dwordx4 v2, s[28:31], s56 offen offset:0 sc1 lds
    buffer_load_dwordx4 v2, s[28:31], s56 offen offset:1024 sc1 lds
    buffer_load_dwordx4 v2, s[28:31], s56 offen offset:2048 sc1 lds
    buffer_load_dwordx4 v2, s[28:31], s56 offen offset:3072 sc1 lds
    s_waitcnt vmcnt(10)
    v_pk_add_f32 v[80:81], v[80:81], v[82:83]
    v_pk_add_f32 v[84:85], v[84:85], v[86:87]
    v_pk_add_f32 v[80:81], v[80:81], v[84:85]
    v_add_f32 v88, v80, v81
    s_lshl_b32 s56, s53, 2
    s_add_u32 s56, s56, 159760
    v_mov_b32 v110, s56
    v_mov_b32 v111, 1
    ds_write_b32 v110, v111
    s_add_u32 s56, s101, 133120
    buffer_load_dword v109, v108, s[28:31], s56 offen sc1
    v_and_b32 v110, 3, v1
    v_lshlrev_b32 v110, 2, v110
    v_add_u32 v110, 159744, v110
    s_mov_b32 s61, 262144
    ds_read_b32 v111, v110
lw_s1:
    s_waitcnt lgkmcnt(0)
    v_cmp_le_u32 vcc, 2, v111
    s_cmp_eq_u64 vcc, -1
    s_cbranch_scc0 lr_s1
ld_s1:
    s_add_u32 m0, s58, 32768
    s_add_u32 s56, s63, 32768
    buffer_load_dwordx4 v2, s[28:31], s56 offen offset:0 sc1 lds
    buffer_load_dwordx4 v2, s[28:31], s56 offen offset:1024 sc1 lds
    buffer_load_dwordx4 v2, s[28:31], s56 offen offset:2048 sc1 lds
    buffer_load_dwordx4 v2, s[28:31], s56 offen offset:3072 sc1 lds
    s_add_u32 m0, s58, 36864
    s_add_u32 s56, s63, 36864
    buffer_load_dwordx4 v2, s[28:31], s56 offen offset:0 sc1 lds
    buffer_load_dwordx4 v2, s[28:31], s56 offen offset:1024 sc1 lds
    buffer_load_dwordx4 v2, s[28:31], s56 offen offset:2048 sc1 lds
    buffer_load_dwordx4 v2, s[28:31], s56 offen offset:3072 sc1 lds
    v_and_b32 v110, 3, v1
    v_lshlrev_b32 v110, 2, v110
    v_add_u32 v110, 159760, v110
    s_mov_b32 s61, 262144
    ds_read_b32 v111, v110
lw_o:
    s_waitcnt lgkmcnt(0)
    v_cmp_le_u32 vcc, 1, v111
    s_cmp_eq_u64 vcc, -1
    s_cbranch_scc0 lr_o
ld_o:
    ds_read_b128 v[16:19], v6 offset:0
    ds_read_b128 v[20:23], v6 offset:1024
    ds_read_b128 v[24:27], v6 offset:2048
    ds_read_b128 v[28:31], v6 offset:3072
    ds_read_b128 v[32:35], v6 offset:4096
    ds_read_b128 v[36:39], v6 offset:5120
    ds_read_b128 v[40:43], v6 offset:6144
    ds_read_b128 v[44:47], v6 offset:7168
    ds_read_b128 v[48:51], v6 offset:8192
    ds_read_b128 v[52:55], v6 offset:9216
    ds_read_b128 v[56:59], v6 offset:10240
    ds_read_b128 v[60:63], v6 offset:11264
    s_waitcnt lgkmcnt(8)
    ds_read_b128 v[64:67], v6 offset:12288
    ds_read_b128 v[68:71], v6 offset:13312
    ds_read_b128 v[72:75], v6 offset:14336
    ds_read_b128 v[76:79], v6 offset:15360
    s_waitcnt lgkmcnt(0)
    s_waitcnt vmcnt(0)
    v_mov_b32 v110, 159744
    ds_read_b32 v111, v110
    s_waitcnt lgkmcnt(0)
    v_readfirstlane_b32 s61, v111
    s_cmp_ge_u32 s61, 3
    s_cbranch_scc1 kb_late
    s_add_u32 s56, s101, 163840
    buffer_load_dword v109, v108, s[28:31], s56 offen sc1
    s_add_u32 s56, s101, 165888
    buffer_load_dword v109, v108, s[28:31], s56 offen sc1
kb_late:
    v_and_b32 v110, 3, v1
    v_lshlrev_b32 v110, 2, v110
    v_add_u32 v110, 159744, v110
    s_mov_b32 s61, 262144
    ds_read_b32 v111, v110
lw_s2:
    s_waitcnt lgkmcnt(0)
    v_cmp_le_u32 vcc, 3, v111
    s_cmp_eq_u64 vcc, -1
    s_cbranch_scc0 lr_s2
ld_s2:
    s_add_u32 m0, s58, 65536
    s_add_u32 s56, s63, 65536
    buffer_load_dwordx4 v2, s[28:31], s56 offen offset:0 sc1 lds
    buffer_load_dwordx4 v2, s[28:31], s56 offen offset:1024 sc1 lds
    buffer_load_dwordx4 v2, s[28:31], s56 offen offset:2048 sc1 lds
    buffer_load_dwordx4 v2, s[28:31], s56 offen offset:3072 sc1 lds
    s_add_u32 m0, s58, 69632
    s_add_u32 s56, s63, 69632
    buffer_load_dwordx4 v2, s[28:31], s56 offen offset:0 sc1 lds
    buffer_load_dwordx4 v2, s[28:31], s56 offen offset:1024 sc1 lds
    buffer_load_dwordx4 v2, s[28:31], s56 offen offset:2048 sc1 lds
    buffer_load_dwordx4 v2, s[28:31], s56 offen offset:3072 sc1 lds
    s_mov_b64 exec, 0xff
    s_add_u32 s56, s60, 4096
    buffer_load_dword v109, v108, s[28:31], s56 offen sc1
    s_mov_b64 exec, -1
    s_and_b32 s57, s46, 0xfffff000
    s_and_b32 s56, s55, 3
    s_lshl_b32 s56, s56, 9
    s_add_u32 s57, s57, s56
    s_mov_b64 exec, 0xf
    s_add_u32 s56, s57, 2048
    buffer_load_dword v109, v108, s[28:31], s56 offen sc1
    s_mov_b64 exec, -1
    s_lshr_b32 s26, s44, 15
    s_lshl_b32 s26, s26, 11
    s_and_b32 s56, s55, 3
    s_lshl_b32 s56, s56, 8
    s_add_u32 s26, s26, s56
    s_lshl_b32 s56, s53, 2
    s_add_u32 s26, s26, s56
    s_add_u32 s26, s26, 11796480
    s_mov_b64 exec, 0x3
    s_add_u32 s56, s26, 0
    buffer_load_dword v109, v108, s[28:31], s56 offen sc1
    s_mov_b64 exec, -1
    s_mov_b64 exec, 0x3
    s_add_u32 s56, s26, 1024
    buffer_load_dword v109, v108, s[28:31], s56 offen sc1
    s_mov_b64 exec, -1
    s_lshl_b32 s27, s53, 11
    s_add_u32 s27, s27, s44
    s_add_u32 s27, s27, 0
    s_add_u32 s56, s27, 0
    buffer_load_dword v109, v108, s[28:31], s56 offen sc1
    s_mov_b64 exec, 0x3
    s_add_u32 s56, s45, 16384
    buffer_load_dword v109, v108, s[28:31], s56 offen sc1
    s_mov_b64 exec, -1
    s_mov_b64 exec, 0x3
    s_add_u32 s56, s45, 32768
    buffer_load_dword v109, v108, s[28:31], s56 offen sc1
    s_mov_b64 exec, -1
    s_lshl_b32 s56, s53, 12
    s_add_u32 m0, s56, 143360
    s_add_u32 s59, s59, 0x1000
    s_add_u32 s57, s45, 32960
    v_add_u32 v6, 143360, v2
    s_setprio 0
    s_barrier
    v_mfma_f32_32x32x16_bf16 v[112:127], v[128:131], v[16:19], v[112:127]
    v_mfma_f32_32x32x16_bf16 v[112:127], v[132:135], v[20:23], v[112:127]
    v_mfma_f32_32x32x16_bf16 v[112:127], v[136:139], v[24:27], v[112:127]
    v_mfma_f32_32x32x16_bf16 v[112:127], v[140:143], v[28:31], v[112:127]
    v_mfma_f32_32x32x16_bf16 v[112:127], v[160:163], v[32:35], v[112:127]
    v_mfma_f32_32x32x16_bf16 v[112:127], v[164:167], v[36:39], v[112:127]
    v_mfma_f32_32x32x16_bf16 v[112:127], v[168:171], v[40:43], v[112:127]
    v_mfma_f32_32x32x16_bf16 v[112:127], v[172:175], v[44:47], v[112:127]
    s_setprio 3
    s_mov_b32 s61, 32768
poll_o1:
    buffer_load_dword v4, v5, s[28:31], s57 offen sc1
    s_waitcnt vmcnt(0)
    v_cmp_le_u32 vcc, 1, v4
    s_sub_u32 s61, s61, 1
    s_cselect_b64 vcc, -1, vcc
    s_cmp_eq_u64 vcc, -1
    s_cbranch_scc0 poll_o1
done_o1:
    buffer_load_dwordx4 v[80:83], v107, s[28:31], s46 offen offset:2048 sc1
    buffer_load_dwordx4 v[84:87], v107, s[28:31], s46 offen offset:2560 sc1
    buffer_load_dwordx4 v2, s[28:31], s59 offen offset:0 sc1 lds
    buffer_load_dwordx4 v2, s[28:31], s59 offen offset:1024 sc1 lds
    buffer_load_dwordx4 v2, s[28:31], s59 offen offset:2048 sc1 lds
    buffer_load_dwordx4 v2, s[28:31], s59 offen offset:3072 sc1 lds
    v_mfma_f32_32x32x16_bf16 v[112:127], v[192:195], v[48:51], v[112:127]
    v_mfma_f32_32x32x16_bf16 v[112:127], v[196:199], v[52:55], v[112:127]
    v_mfma_f32_32x32x16_bf16 v[112:127], v[200:203], v[56:59], v[112:127]
    v_mfma_f32_32x32x16_bf16 v[112:127], v[204:207], v[60:63], v[112:127]
    v_mfma_f32_32x32x16_bf16 v[112:127], v[224:227], v[64:67], v[112:127]
    v_mfma_f32_32x32x16_bf16 v[112:127], v[228:231], v[68:71], v[112:127]
    v_mfma_f32_32x32x16_bf16 v[112:127], v[232:235], v[72:75], v[112:127]
    v_mfma_f32_32x32x16_bf16 v[112:127], v[236:239], v[76:79], v[112:127]
    s_waitcnt vmcnt(4)
    v_pk_add_f32 v[80:81], v[80:81], v[82:83]
    v_pk_add_f32 v[84:85], v[84:85], v[86:87]
    v_pk_add_f32 v[80:81], v[80:81], v[84:85]
    v_add_f32 v89, v80, v81
    v_add_f32 v90, v88, v89
    v_add_f32 v88, v88, v89
    s_waitcnt vmcnt(0)
    s_barrier
    ds_read_b128 v[16:19], v6 offset:0
    ds_read_b128 v[20:23], v6 offset:1024
    ds_read_b128 v[24:27], v6 offset:2048
    ds_read_b128 v[28:31], v6 offset:3072
    ds_read_b128 v[32:35], v6 offset:4096
    ds_read_b128 v[36:39], v6 offset:5120
    ds_read_b128 v[40:43], v6 offset:6144
    ds_read_b128 v[44:47], v6 offset:7168
    v_permlane32_swap_b32 v88, v90
    v_add_f32 v88, v88, v90
    v_add_f32 v89, v88, v104
    v_add_f32 v88, v88, v104
    v_pk_add_f32 v[112:113], v[112:113], v[88:89] neg_lo:[0,1] neg_hi:[0,1]
    v_pk_add_f32 v[114:115], v[114:115], v[88:89] neg_lo:[0,1] neg_hi:[0,1]
    v_pk_add_f32 v[116:117], v[116:117], v[88:89] neg_lo:[0,1] neg_hi:[0,1]
    v_pk_add_f32 v[118:119], v[118:119], v[88:89] neg_lo:[0,1] neg_hi:[0,1]
    v_pk_add_f32 v[120:121], v[120:121], v[88:89] neg_lo:[0,1] neg_hi:[0,1]
    v_pk_add_f32 v[122:123], v[122:123], v[88:89] neg_lo:[0,1] neg_hi:[0,1]
    v_pk_add_f32 v[124:125], v[124:125], v[88:89] neg_lo:[0,1] neg_hi:[0,1]
    v_pk_add_f32 v[126:127], v[126:127], v[88:89] neg_lo:[0,1] neg_hi:[0,1]
    s_nop 0
    s_waitcnt lgkmcnt(7)
    v_mfma_f32_32x32x16_bf16 v[112:127], v[144:147], v[16:19], v[112:127]
    ds_read_b128 v[48:51], v6 offset:8192
    s_waitcnt lgkmcnt(7)
    v_mfma_f32_32x32x16_bf16 v[112:127], v[148:151], v[20:23], v[112:127]
    ds_read_b128 v[52:55], v6 offset:9216
    s_waitcnt lgkmcnt(7)
    v_mfma_f32_32x32x16_bf16 v[112:127], v[152:155], v[24:27], v[112:127]
    ds_read_b128 v[56:59], v6 offset:10240
    s_waitcnt lgkmcnt(7)
    v_mfma_f32_32x32x16_bf16 v[112:127], v[156:159], v[28:31], v[112:127]
    ds_read_b128 v[60:63], v6 offset:11264
    s_waitcnt lgkmcnt(7)
    v_mfma_f32_32x32x16_bf16 v[112:127], v[176:179], v[32:35], v[112:127]
    ds_read_b128 v[64:67], v6 offset:12288
    s_waitcnt lgkmcnt(7)
    v_mfma_f32_32x32x16_bf16 v[112:127], v[180:183], v[36:39], v[112:127]
    ds_read_b128 v[68:71], v6 offset:13312
    s_waitcnt lgkmcnt(7)
    v_mfma_f32_32x32x16_bf16 v[112:127], v[184:187], v[40:43], v[112:127]
    ds_read_b128 v[72:75], v6 offset:14336
    s_waitcnt lgkmcnt(7)
    v_mfma_f32_32x32x16_bf16 v[112:127], v[188:191], v[44:47], v[112:127]
    ds_read_b128 v[76:79], v6 offset:15360
    s_waitcnt lgkmcnt(7)
    v_mfma_f32_32x32x16_bf16 v[112:127], v[208:211], v[48:51], v[112:127]
    s_waitcnt lgkmcnt(6)
    v_mfma_f32_32x32x16_bf16 v[112:127], v[212:215], v[52:55], v[112:127]
    s_waitcnt lgkmcnt(5)
    v_mfma_f32_32x32x16_bf16 v[112:127], v[216:219], v[56:59], v[112:127]
    s_waitcnt lgkmcnt(4)
    v_mfma_f32_32x32x16_bf16 v[112:127], v[220:223], v[60:63], v[112:127]
    s_waitcnt lgkmcnt(3)
    v_mfma_f32_32x32x16_bf16 v[112:127], v[240:243], v[64:67], v[112:127]
    s_waitcnt lgkmcnt(2)
    v_mfma_f32_32x32x16_bf16 v[112:127], v[244:247], v[68:71], v[112:127]
    s_waitcnt lgkmcnt(1)
    v_mfma_f32_32x32x16_bf16 v[112:127], v[248:251], v[72:75], v[112:127]
    s_waitcnt lgkmcnt(0)
    v_mfma_f32_32x32x16_bf16 v[112:127], v[252:255], v[76:79], v[112:127]
    s_nop 1
    v_mov_b32 v14, 0x40000000
    v_mov_b32 v15, 0x40000000
    s_cmp_eq_u32 s100, 0
    s_cselect_b32 s56, 0, 0x40000000
    s_mov_b32 exec_hi, 0
    v_mov_b32 v14, v106
    v_add_u32 v15, s56, v0
    s_mov_b32 exec_hi, -1
    s_add_u32 s58, s45, 16512
    s_sub_u32 s47, s47, 16512
    v_cvt_pk_bf16_f32 v96, v112, v113
    v_cvt_pk_bf16_f32 v97, v114, v115
    v_cvt_pk_bf16_f32 v98, v116, v117
    v_cvt_pk_bf16_f32 v99, v118, v119
    s_cmp_eq_u32 s98, 1
    s_cbranch_scc0 far_hn
    buffer_store_dwordx4 v[96:99], v106, s[28:31], s27 offen
    v_cvt_pk_bf16_f32 v100, v120, v121
    v_cvt_pk_bf16_f32 v101, v122, v123
    v_cvt_pk_bf16_f32 v102, v124, v125
    v_cvt_pk_bf16_f32 v103, v126, v127
    buffer_store_dwordx4 v[100:103], v106, s[28:31], s27 offen offset:256
    v_pk_mul_f32 v[90:91], v[112:113], v[112:113]
    v_pk_fma_f32 v[90:91], v[114:115], v[114:115], v[90:91]
    v_pk_fma_f32 v[90:91], v[116:117], v[116:117], v[90:91]
    v_pk_fma_f32 v[90:91], v[118:119], v[118:119], v[90:91]
    v_pk_fma_f32 v[90:91], v[120:121], v[120:121], v[90:91]
    v_pk_fma_f32 v[90:91], v[122:123], v[122:123], v[90:91]
    v_pk_fma_f32 v[90:91], v[124:125], v[124:125], v[90:91]
    v_pk_fma_f32 v[90:91], v[126:127], v[126:127], v[90:91]
    v_add_f32 v92, v90, v91
    v_add_f32 v90, v90, v91
    buffer_store_dword v88, v15, s[28:31], s58 offen
    s_nop 0
    v_permlane32_swap_b32 v90, v92
    v_add_f32 v90, v90, v92
    buffer_store_dword v90, v14, s[28:31], s26 offen
back_hn:
    s_barrier
    s_lshl_b32 s56, s54, 2
    s_add_u32 s56, s56, s53
    s_mul_i32 s59, s56, 114688
    s_lshr_b32 s57, s55, 1
    s_mul_i32 s57, s57, 12288
    s_add_u32 s59, s59, s57
    s_lshl_b32 s57, s55, 10
    s_add_u32 s59, s59, s57
    s_add_u32 s59, s59, 13631488
    s_lshl_b32 s63, s56, 15
    s_add_u32 s63, s63, 0
    s_lshl_b32 s26, s56, 11
    s_add_u32 s26, s26, 11796480
    s_lshl_b32 s56, s56, 8
    s_lshl_b32 s57, s55, 2
    s_add_u32 s62, s56, s57
    s_add_u32 s62, s62, 2392064
    s_add_u32 s57, s56, 2375680
    v_add_u32 v7, 0x10000, v2
    v_add_u32 v8, 0x20000, v2
    s_waitcnt vmcnt(0)
    s_cmp_eq_u32 s98, 1
    s_cbranch_scc0 far_fh
    buffer_store_dword v13, v9, s[28:31], s47 offen
back_fh:
    s_setprio 2
    s_mov_b32 s61, 32768
poll_hn:
    buffer_load_dword v4, v5, s[28:31], s57 offen sc1
    s_waitcnt vmcnt(0)
    v_cmp_le_u32 vcc, 1, v4
    s_sub_u32 s61, s61, 1
    s_cselect_b64 vcc, -1, vcc
    s_cmp_eq_u64 vcc, -1
    s_cbranch_scc0 poll_hn
done_hn:
    buffer_load_dwordx4 v[128:131], v2, s[28:31], s63 offen offset:0 sc1
    buffer_load_dwordx4 v[132:135], v2, s[28:31], s63 offen offset:1024 sc1
    buffer_load_dwordx4 v[136:139], v2, s[28:31], s63 offen offset:2048 sc1
    buffer_load_dwordx4 v[140:143], v2, s[28:31], s63 offen offset:3072 sc1
    s_add_u32 s63, s63, 0x1000
    buffer_load_dwordx4 v[144:147], v2, s[28:31], s63 offen offset:0 sc1
    buffer_load_dwordx4 v[148:151], v2, s[28:31], s63 offen offset:1024 sc1
    buffer_load_dwordx4 v[152:155], v2, s[28:31], s63 offen offset:2048 sc1
    buffer_load_dwordx4 v[156:159], v2, s[28:31], s63 offen offset:3072 sc1
    s_add_u32 s63, s63, 0x1000
    buffer_load_dwordx4 v[160:163], v2, s[28:31], s63 offen offset:0 sc1
    buffer_load_dwordx4 v[164:167], v2, s[28:31], s63 offen offset:1024 sc1
    buffer_load_dwordx4 v[168:171], v2, s[28:31], s63 offen offset:2048 sc1
    buffer_load_dwordx4 v[172:175], v2, s[28:31], s63 offen offset:3072 sc1
    ds_read_b128 v[80:83], v2 offset:0
    ds_read_b128 v[84:87], v2 offset:32768
    ds_read_b128 v[88:91], v2 offset:1024
    ds_read_b128 v[92:95], v2 offset:33792
    ds_read_b128 v[96:99], v2 offset:2048
    ds_read_b128 v[100:103], v2 offset:34816
    ds_read_b128 v[104:107], v2 offset:3072
    s_waitcnt lgkmcnt(5) vmcnt(10)
    v_mfma_f32_16x16x32_bf16 v[16:19], v[80:83], v[128:131], 0
    ds_read_b128 v[108:111], v2 offset:35840
    v_mfma_f32_16x16x32_bf16 v[20:23], v[80:83], v[132:135], 0
    s_add_u32 s63, s63, 0x1000
    buffer_load_dwordx4 v[176:179], v2, s[28:31], s63 offen offset:0 sc1
    v_mfma_f32_16x16x32_bf16 v[32:35], v[84:87], v[128:131], 0
    ds_read_b128 v[80:83], v2 offset:4096
    s_waitcnt lgkmcnt(5)
    v_mfma_f32_16x16x32_bf16 v[36:39], v[84:87], v[132:135], 0
    buffer_load_dwordx4 v[120:123], v2, s[28:31], s26 offen offset:0 sc1
    v_mfma_f32_16x16x32_bf16 v[24:27], v[88:91], v[128:131], 0
    ds_read_b128 v[84:87], v2 offset:36864
    v_mfma_f32_16x16x32_bf16 v[28:31], v[88:91], v[132:135], 0
    buffer_load_dwordx4 v[180:183], v2, s[28:31], s63 offen offset:1024 sc1
    v_mfma_f32_16x16x32_bf16 v[40:43], v[92:95], v[128:131], 0
    ds_read_b128 v[88:91], v2 offset:5120
    s_waitcnt lgkmcnt(5) vmcnt(11)
    v_mfma_f32_16x16x32_bf16 v[44:47], v[92:95], v[132:135], 0
    buffer_load_dwordx4 v[124:127], v2, s[28:31], s26 offen offset:1024 sc1
    v_mfma_f32_16x16x32_bf16 v[16:19], v[96:99], v[136:139], v[16:19]
    ds_read_b128 v[92:95], v2 offset:37888
    v_mfma_f32_16x16x32_bf16 v[20:23], v[96:99], v[140:143], v[20:23]
    buffer_load_dwordx4 v[184:187], v2, s[28:31], s63 offen offset:2048 sc1
    v_mfma_f32_16x16x32_bf16 v[32:35], v[100:103], v[136:139], v[32:35]
    ds_read_b128 v[96:99], v2 offset:6144
    s_waitcnt lgkmcnt(5)
    v_mfma_f32_16x16x32_bf16 v[36:39], v[100:103], v[140:143], v[36:39]
    v_mfma_f32_16x16x32_bf16 v[24:27], v[104:107], v[136:139], v[24:27]
    ds_read_b128 v[100:103], v2 offset:38912
    v_mfma_f32_16x16x32_bf16 v[28:31], v[104:107], v[140:143], v[28:31]
    buffer_load_dwordx4 v[188:191], v2, s[28:31], s63 offen offset:3072 sc1
    v_mfma_f32_16x16x32_bf16 v[40:43], v[108:111], v[136:139], v[40:43]
    ds_read_b128 v[104:107], v2 offset:7168
    s_waitcnt lgkmcnt(5) vmcnt(12)
    v_mfma_f32_16x16x32_bf16 v[44:47], v[108:111], v[140:143], v[44:47]
    v_mfma_f32_16x16x32_bf16 v[16:19], v[80:83], v[144:147], v[16:19]
    ds_read_b128 v[108:111], v2 offset:39936
    v_mfma_f32_16x16x32_bf16 v[20:23], v[80:83], v[148:151], v[20:23]
    s_add_u32 s63, s63, 0x1000
    buffer_load_dwordx4 v[192:195], v2, s[28:31], s63 offen offset:0 sc1
    v_mfma_f32_16x16x32_bf16 v[32:35], v[84:87], v[144:147], v[32:35]
    ds_read_b128 v[80:83], v2 offset:8192
    s_waitcnt lgkmcnt(5)
    v_mfma_f32_16x16x32_bf16 v[36:39], v[84:87], v[148:151], v[36:39]
    v_mfma_f32_16x16x32_bf16 v[24:27], v[88:91], v[144:147], v[24:27]
    ds_read_b128 v[84:87], v2 offset:40960
    v_mfma_f32_16x16x32_bf16 v[28:31], v[88:91], v[148:151], v[28:31]
    buffer_load_dwordx4 v[196:199], v2, s[28:31], s63 offen offset:1024 sc1
    v_mfma_f32_16x16x32_bf16 v[40:43], v[92:95], v[144:147], v[40:43]
    ds_read_b128 v[88:91], v2 offset:9216
    s_waitcnt lgkmcnt(5) vmcnt(12)
    v_mfma_f32_16x16x32_bf16 v[44:47], v[92:95], v[148:151], v[44:47]
    v_mfma_f32_16x16x32_bf16 v[16:19], v[96:99], v[152:155], v[16:19]
    ds_read_b128 v[92:95], v2 offset:41984
    v_mfma_f32_16x16x32_bf16 v[20:23], v[96:99], v[156:159], v[20:23]
    buffer_load_dwordx4 v[200:203], v2, s[28:31], s63 offen offset:2048 sc1
    v_mfma_f32_16x16x32_bf16 v[32:35], v[100:103], v[152:155], v[32:35]
    ds_read_b128 v[96:99], v2 offset:10240
    s_waitcnt lgkmcnt(5)
    v_mfma_f32_16x16x32_bf16 v[36:39], v[100:103], v[156:159], v[36:39]
    v_mfma_f32_16x16x32_bf16 v[24:27], v[104:107], v[152:155], v[24:27]
    ds_read_b128 v[100:103], v2 offset:43008
    v_mfma_f32_16x16x32_bf16 v[28:31], v[104:107], v[156:159], v[28:31]
    buffer_load_dwordx4 v[204:207], v2, s[28:31], s63 offen offset:3072 sc1
    v_mfma_f32_16x16x32_bf16 v[40:43], v[108:111], v[152:155], v[40:43]
    ds_read_b128 v[104:107], v2 offset:11264
    s_waitcnt lgkmcnt(5) vmcnt(12)
    v_mfma_f32_16x16x32_bf16 v[44:47], v[108:111], v[156:159], v[44:47]
    v_mfma_f32_16x16x32_bf16 v[16:19], v[80:83], v[160:163], v[16:19]
    ds_read_b128 v[108:111], v2 offset:44032
    v_mfma_f32_16x16x32_bf16 v[20:23], v[80:83], v[164:167], v[20:23]
    s_add_u32 s63, s63, 0x1000
    buffer_load_dwordx4 v[208:211], v2, s[28:31], s63 offen offset:0 sc1
    v_mfma_f32_16x16x32_bf16 v[32:35], v[84:87], v[160:163], v[32:35]
    ds_read_b128 v[80:83], v2 offset:12288
    s_waitcnt lgkmcnt(5)
    v_mfma_f32_16x16x32_bf16 v[36:39], v[84:87], v[164:167], v[36:39]
    v_mfma_f32_16x16x32_bf16 v[24:27], v[88:91], v[160:163], v[24:27]
    ds_read_b128 v[84:87], v2 offset:45056
    v_mfma_f32_16x16x32_bf16 v[28:31], v[88:91], v[164:167], v[28:31]
    buffer_load_dwordx4 v[212:215], v2, s[28:31], s63 offen offset:1024 sc1
    v_mfma_f32_16x16x32_bf16 v[40:43], v[92:95], v[160:163], v[40:43]
    ds_read_b128 v[88:91], v2 offset:13312
    s_waitcnt lgkmcnt(5) vmcnt(12)
    v_mfma_f32_16x16x32_bf16 v[44:47], v[92:95], v[164:167], v[44:47]
    v_mfma_f32_16x16x32_bf16 v[16:19], v[96:99], v[168:171], v[16:19]
    ds_read_b128 v[92:95], v2 offset:46080
    v_mfma_f32_16x16x32_bf16 v[20:23], v[96:99], v[172:175], v[20:23]
    buffer_load_dwordx4 v[216:219], v2, s[28:31], s63 offen offset:2048 sc1
    v_mfma_f32_16x16x32_bf16 v[32:35], v[100:103], v[168:171], v[32:35]
    ds_read_b128 v[96:99], v2 offset:14336
    s_waitcnt lgkmcnt(5)
    v_mfma_f32_16x16x32_bf16 v[36:39], v[100:103], v[172:175], v[36:39]
    v_mfma_f32_16x16x32_bf16 v[24:27], v[104:107], v[168:171], v[24:27]
    ds_read_b128 v[100:103], v2 offset:47104
    v_mfma_f32_16x16x32_bf16 v[28:31], v[104:107], v[172:175], v[28:31]
    buffer_load_dwordx4 v[220:223], v2, s[28:31], s63 offen offset:3072 sc1
    v_mfma_f32_16x16x32_bf16 v[40:43], v[108:111], v[168:171], v[40:43]
    ds_read_b128 v[104:107], v2 offset:15360
    s_waitcnt lgkmcnt(5) vmcnt(11)
    v_mfma_f32_16x16x32_bf16 v[44:47], v[108:111], v[172:175], v[44:47]
    v_mfma_f32_16x16x32_bf16 v[16:19], v[80:83], v[176:179], v[16:19]
    ds_read_b128 v[108:111], v2 offset:48128
    v_mfma_f32_16x16x32_bf16 v[20:23], v[80:83], v[180:183], v[20:23]
    s_add_u32 s63, s63, 0x1000
    buffer_load_dwordx4 v[224:227], v2, s[28:31], s63 offen offset:0 sc1
    v_mfma_f32_16x16x32_bf16 v[32:35], v[84:87], v[176:179], v[32:35]
    ds_read_b128 v[80:83], v2 offset:16384
    s_waitcnt lgkmcnt(5)
    v_mfma_f32_16x16x32_bf16 v[36:39], v[84:87], v[180:183], v[36:39]
    v_mfma_f32_16x16x32_bf16 v[24:27], v[88:91], v[176:179], v[24:27]
    ds_read_b128 v[84:87], v2 offset:49152
    v_mfma_f32_16x16x32_bf16 v[28:31], v[88:91], v[180:183], v[28:31]
    buffer_load_dwordx4 v[228:231], v2, s[28:31], s63 offen offset:1024 sc1
    v_mfma_f32_16x16x32_bf16 v[40:43], v[92:95], v[176:179], v[40:43]
    ds_read_b128 v[88:91], v2 offset:17408
    s_waitcnt lgkmcnt(5) vmcnt(10)
    v_mfma_f32_16x16x32_bf16 v[44:47], v[92:95], v[180:183], v[44:47]
    v_mfma_f32_16x16x32_bf16 v[16:19], v[96:99], v[184:187], v[16:19]
    ds_read_b128 v[92:95], v2 offset:50176
    v_mfma_f32_16x16x32_bf16 v[20:23], v[96:99], v[188:191], v[20:23]
    buffer_load_dwordx4 v[232:235], v2, s[28:31], s63 offen offset:2048 sc1
    v_mfma_f32_16x16x32_bf16 v[32:35], v[100:103], v[184:187], v[32:35]
    ds_read_b128 v[96:99], v2 offset:18432
    s_waitcnt lgkmcnt(5)
    v_mfma_f32_16x16x32_bf16 v[36:39], v[100:103], v[188:191], v[36:39]
    v_pk_add_f32 v[120:121], v[120:121], v[122:123]
    v_mfma_f32_16x16x32_bf16 v[24:27], v[104:107], v[184:187], v[24:27]
    ds_read_b128 v[100:103], v2 offset:51200
    v_mfma_f32_16x16x32_bf16 v[28:31], v[104:107], v[188:191], v[28:31]
    buffer_load_dwordx4 v[236:239], v2, s[28:31], s63 offen offset:3072 sc1
    v_mfma_f32_16x16x32_bf16 v[40:43], v[108:111], v[184:187], v[40:43]
    ds_read_b128 v[104:107], v2 offset:19456
    s_waitcnt lgkmcnt(5) vmcnt(10)
    v_mfma_f32_16x16x32_bf16 v[44:47], v[108:111], v[188:191], v[44:47]
    v_pk_add_f32 v[124:125], v[124:125], v[126:127]
    v_mfma_f32_16x16x32_bf16 v[16:19], v[80:83], v[192:195], v[16:19]
    ds_read_b128 v[108:111], v2 offset:52224
    v_mfma_f32_16x16x32_bf16 v[20:23], v[80:83], v[196:199], v[20:23]
    s_add_u32 s63, s63, 0x1000
    buffer_load_dwordx4 v[240:243], v2, s[28:31], s63 offen offset:0 sc1
    v_mfma_f32_16x16x32_bf16 v[32:35], v[84:87], v[192:195], v[32:35]
    ds_read_b128 v[80:83], v2 offset:20480
    s_waitcnt lgkmcnt(5)
    v_mfma_f32_16x16x32_bf16 v[36:39], v[84:87], v[196:199], v[36:39]
    v_add_f32 v120, v120, v121
    v_mfma_f32_16x16x32_bf16 v[24:27], v[88:91], v[192:195], v[24:27]
    ds_read_b128 v[84:87], v2 offset:53248
    v_mfma_f32_16x16x32_bf16 v[28:31], v[88:91], v[196:199], v[28:31]
    buffer_load_dwordx4 v[244:247], v2, s[28:31], s63 offen offset:1024 sc1
    v_mfma_f32_16x16x32_bf16 v[40:43], v[92:95], v[192:195], v[40:43]
    ds_read_b128 v[88:91], v2 offset:21504
    s_waitcnt lgkmcnt(5) vmcnt(10)
    v_mfma_f32_16x16x32_bf16 v[44:47], v[92:95], v[196:199], v[44:47]
    v_add_f32 v124, v124, v125
    v_mfma_f32_16x16x32_bf16 v[16:19], v[96:99], v[200:203], v[16:19]
    ds_read_b128 v[92:95], v2 offset:54272
    v_mfma_f32_16x16x32_bf16 v[20:23], v[96:99], v[204:207], v[20:23]
    buffer_load_dwordx4 v[248:251], v2, s[28:31], s63 offen offset:2048 sc1
    v_mfma_f32_16x16x32_bf16 v[32:35], v[100:103], v[200:203], v[32:35]
    ds_read_b128 v[96:99], v2 offset:22528
    s_waitcnt lgkmcnt(5)
    v_mfma_f32_16x16x32_bf16 v[36:39], v[100:103], v[204:207], v[36:39]
    v_permlane32_swap_b32 v120, v124
    v_mfma_f32_16x16x32_bf16 v[24:27], v[104:107], v[200:203], v[24:27]
    ds_read_b128 v[100:103], v2 offset:55296
    v_mfma_f32_16x16x32_bf16 v[28:31], v[104:107], v[204:207], v[28:31]
    buffer_load_dwordx4 v[252:255], v2, s[28:31], s63 offen offset:3072 sc1
    v_mfma_f32_16x16x32_bf16 v[40:43], v[108:111], v[200:203], v[40:43]
    ds_read_b128 v[104:107], v2 offset:23552
    s_waitcnt lgkmcnt(5) vmcnt(10)
    v_mfma_f32_16x16x32_bf16 v[44:47], v[108:111], v[204:207], v[44:47]
    v_add_f32 v120, v120, v124
    v_mfma_f32_16x16x32_bf16 v[16:19], v[80:83], v[208:211], v[16:19]
    ds_read_b128 v[108:111], v2 offset:56320
    v_mfma_f32_16x16x32_bf16 v[20:23], v[80:83], v[212:215], v[20:23]
    v_mov_b32 v124, v120
    v_mfma_f32_16x16x32_bf16 v[32:35], v[84:87], v[208:211], v[32:35]
    ds_read_b128 v[80:83], v2 offset:24576
    s_waitcnt lgkmcnt(5)
    v_mfma_f32_16x16x32_bf16 v[36:39], v[84:87], v[212:215], v[36:39]
    v_permlane16_swap_b32 v120, v124
    v_mfma_f32_16x16x32_bf16 v[24:27], v[88:91], v[208:211], v[24:27]
    ds_read_b128 v[84:87], v2 offset:57344
    v_mfma_f32_16x16x32_bf16 v[28:31], v[88:91], v[212:215], v[28:31]
    v_add_f32 v120, v120, v124
    v_mfma_f32_16x16x32_bf16 v[40:43], v[92:95], v[208:211], v[40:43]
pad_2:
    s_cbranch_execz pad_6
    ds_read_b128 v[88:91], v2 offset:25600
    s_waitcnt lgkmcnt(5) vmcnt(8)
    v_mfma_f32_16x16x32_bf16 v[44:47], v[92:95], v[212:215], v[44:47]
    v_mul_f32 v120, 0x3b000000, v120
    v_mfma_f32_16x16x32_bf16 v[16:19], v[96:99], v[216:219], v[16:19]
    ds_read_b128 v[92:95], v2 offset:58368
    v_mfma_f32_16x16x32_bf16 v[20:23], v[96:99], v[220:223], v[20:23]
    v_add_f32 v120, 0x3727c5ac, v120
    v_mfma_f32_16x16x32_bf16 v[32:35], v[100:103], v[216:219], v[32:35]
    ds_read_b128 v[96:99], v2 offset:26624
    s_waitcnt lgkmcnt(5)
    v_mfma_f32_16x16x32_bf16 v[36:39], v[100:103], v[220:223], v[36:39]
    v_rsq_f32 v124, v120
    v_mfma_f32_16x16x32_bf16 v[24:27], v[104:107], v[216:219], v[24:27]
    ds_read_b128 v[100:103], v2 offset:59392
    v_mfma_f32_16x16x32_bf16 v[28:31], v[104:107], v[220:223], v[28:31]
    v_mul_f32 v14, v120, v124
    v_mfma_f32_16x16x32_bf16 v[40:43], v[108:111], v[216:219], v[40:43]
    ds_read_b128 v[104:107], v2 offset:27648
    s_waitcnt lgkmcnt(5) vmcnt(6)
    v_mfma_f32_16x16x32_bf16 v[44:47], v[108:111], v[220:223], v[44:47]
    v_mul_f32 v4, 0x3fb8aa3b, v124
    v_mfma_f32_16x16x32_bf16 v[16:19], v[80:83], v[224:227], v[16:19]
    ds_read_b128 v[108:111], v2 offset:60416
    v_mfma_f32_16x16x32_bf16 v[20:23], v[80:83], v[228:231], v[20:23]
    v_mov_b32 v15, v14
    v_mfma_f32_16x16x32_bf16 v[32:35], v[84:87], v[224:227], v[32:35]
    ds_read_b128 v[80:83], v2 offset:28672
    s_waitcnt lgkmcnt(5)
    v_mfma_f32_16x16x32_bf16 v[36:39], v[84:87], v[228:231], v[36:39]
    v_mov_b32 v5, v4
    v_mfma_f32_16x16x32_bf16 v[24:27], v[88:91], v[224:227], v[24:27]
    ds_read_b128 v[84:87], v2 offset:61440
    v_mfma_f32_16x16x32_bf16 v[28:31], v[88:91], v[228:231], v[28:31]
    v_permlane32_swap_b32 v14, v15
    v_mfma_f32_16x16x32_bf16 v[40:43], v[92:95], v[224:227], v[40:43]
    ds_read_b128 v[88:91], v2 offset:29696
    s_waitcnt lgkmcnt(5) vmcnt(4)
    v_mfma_f32_16x16x32_bf16 v[44:47], v[92:95], v[228:231], v[44:47]
    v_permlane32_swap_b32 v4, v5
    v_mfma_f32_16x16x32_bf16 v[16:19], v[96:99], v[232:235], v[16:19]
    ds_read_b128 v[92:95], v2 offset:62464
    v_mfma_f32_16x16x32_bf16 v[20:23], v[96:99], v[236:239], v[20:23]
    v_mfma_f32_16x16x32_bf16 v[32:35], v[100:103], v[232:235], v[32:35]
    ds_read_b128 v[96:99], v2 offset:30720
    s_waitcnt lgkmcnt(5)
    v_mfma_f32_16x16x32_bf16 v[36:39], v[100:103], v[236:239], v[36:39]
    v_mfma_f32_16x16x32_bf16 v[24:27], v[104:107], v[232:235], v[24:27]
    ds_read_b128 v[100:103], v2 offset:63488
    v_mfma_f32_16x16x32_bf16 v[28:31], v[104:107], v[236:239], v[28:31]
    v_mfma_f32_16x16x32_bf16 v[40:43], v[108:111], v[232:235], v[40:43]
    ds_read_b128 v[104:107], v2 offset:31744
    s_waitcnt lgkmcnt(5) vmcnt(2)
    v_mfma_f32_16x16x32_bf16 v[44:47], v[108:111], v[236:239], v[44:47]
    v_mfma_f32_16x16x32_bf16 v[16:19], v[80:83], v[240:243], v[16:19]
    ds_read_b128 v[108:111], v2 offset:64512
    v_mfma_f32_16x16x32_bf16 v[20:23], v[80:83], v[244:247], v[20:23]
    v_mfma_f32_16x16x32_bf16 v[32:35], v[84:87], v[240:243], v[32:35]
    ds_read_b128 v[80:83], v7 offset:0
    s_waitcnt lgkmcnt(5)
    v_mfma_f32_16x16x32_bf16 v[36:39], v[84:87], v[244:247], v[36:39]
    v_mfma_f32_16x16x32_bf16 v[24:27], v[88:91], v[240:243], v[24:27]
    ds_read_b128 v[84:87], v7 offset:1024
    v_mfma_f32_16x16x32_bf16 v[28:31], v[88:91], v[244:247], v[28:31]
    v_mfma_f32_16x16x32_bf16 v[40:43], v[92:95], v[240:243], v[40:43]
    ds_read_b128 v[88:91], v7 offset:2048
    s_waitcnt lgkmcnt(5) vmcnt(0)
    v_mfma_f32_16x16x32_bf16 v[44:47], v[92:95], v[244:247], v[44:47]
    v_mfma_f32_16x16x32_bf16 v[16:19], v[96:99], v[248:251], v[16:19]
    ds_read_b128 v[92:95], v7 offset:3072
    v_mfma_f32_16x16x32_bf16 v[20:23], v[96:99], v[252:255], v[20:23]
    v_mfma_f32_16x16x32_bf16 v[32:35], v[100:103], v[248:251], v[32:35]
    ds_read_b128 v[96:99], v7 offset:4096
    s_waitcnt lgkmcnt(5)
    v_mfma_f32_16x16x32_bf16 v[36:39], v[100:103], v[252:255], v[36:39]
    v_mfma_f32_16x16x32_bf16 v[24:27], v[104:107], v[248:251], v[24:27]
    ds_read_b128 v[100:103], v7 offset:5120
    v_mfma_f32_16x16x32_bf16 v[28:31], v[104:107], v[252:255], v[28:31]
    v_mfma_f32_16x16x32_bf16 v[40:43], v[108:111], v[248:251], v[40:43]
    ds_read_b128 v[104:107], v7 offset:6144
    s_waitcnt lgkmcnt(5)
    v_mfma_f32_16x16x32_bf16 v[44:47], v[108:111], v[252:255], v[44:47]
    s_barrier
    v_mfma_f32_16x16x32_bf16 v[48:51], v[80:83], v[128:131], 0
    ds_read_b128 v[108:111], v7 offset:7168
    v_mfma_f32_16x16x32_bf16 v[52:55], v[80:83], v[132:135], 0
    v_mfma_f32_16x16x32_bf16 v[56:59], v[84:87], v[128:131], 0
    ds_read_b128 v[80:83], v7 offset:8192
    s_waitcnt lgkmcnt(5)
    v_mfma_f32_16x16x32_bf16 v[60:63], v[84:87], v[132:135], 0
    v_mfma_f32_16x16x32_bf16 v[48:51], v[88:91], v[136:139], v[48:51]
    ds_read_b128 v[84:87], v7 offset:9216
    v_mul_f32 v16, v16, v4
    v_mfma_f32_16x16x32_bf16 v[52:55], v[88:91], v[140:143], v[52:55]
    v_exp_f32 v16, -v16
    v_mfma_f32_16x16x32_bf16 v[56:59], v[92:95], v[136:139], v[56:59]
    ds_read_b128 v[88:91], v7 offset:10240
    s_waitcnt lgkmcnt(5)
    v_mfma_f32_16x16x32_bf16 v[60:63], v[92:95], v[140:143], v[60:63]
    v_fma_f32 v16, v16, v14, v14
    v_mul_f32 v17, v17, v4
    v_mfma_f32_16x16x32_bf16 v[48:51], v[96:99], v[144:147], v[48:51]
    ds_read_b128 v[92:95], v7 offset:11264
    v_mul_f32 v18, v18, v4
    v_mfma_f32_16x16x32_bf16 v[52:55], v[96:99], v[148:151], v[52:55]
    v_rcp_f32 v16, v16
    v_mfma_f32_16x16x32_bf16 v[56:59], v[100:103], v[144:147], v[56:59]
    ds_read_b128 v[96:99], v7 offset:12288
    s_waitcnt lgkmcnt(5)
    v_mfma_f32_16x16x32_bf16 v[60:63], v[100:103], v[148:151], v[60:63]
    v_exp_f32 v17, -v17
    v_mfma_f32_16x16x32_bf16 v[48:51], v[104:107], v[152:155], v[48:51]
    ds_read_b128 v[100:103], v7 offset:13312
    v_mul_f32 v16, v16, v24
    v_mfma_f32_16x16x32_bf16 v[52:55], v[104:107], v[156:159], v[52:55]
    v_exp_f32 v18, -v18
    v_mfma_f32_16x16x32_bf16 v[56:59], v[108:111], v[152:155], v[56:59]
    ds_read_b128 v[104:107], v7 offset:14336
    s_waitcnt lgkmcnt(5)
    v_mfma_f32_16x16x32_bf16 v[60:63], v[108:111], v[156:159], v[60:63]
    v_fma_f32 v17, v17, v14, v14
    v_fma_f32 v18, v18, v14, v14
    v_mfma_f32_16x16x32_bf16 v[48:51], v[80:83], v[160:163], v[48:51]
    ds_read_b128 v[108:111], v7 offset:15360
    v_mul_f32 v19, v19, v4
    v_mfma_f32_16x16x32_bf16 v[52:55], v[80:83], v[164:167], v[52:55]
    v_rcp_f32 v17, v17
    v_mfma_f32_16x16x32_bf16 v[56:59], v[84:87], v[160:163], v[56:59]
    ds_read_b128 v[80:83], v7 offset:16384
    s_waitcnt lgkmcnt(5)
    v_mfma_f32_16x16x32_bf16 v[60:63], v[84:87], v[164:167], v[60:63]
    v_rcp_f32 v18, v18
    v_mfma_f32_16x16x32_bf16 v[48:51], v[88:91], v[168:171], v[48:51]
    ds_read_b128 v[84:87], v7 offset:17408
    v_mul_f32 v17, v17, v25
    v_mfma_f32_16x16x32_bf16 v[52:55], v[88:91], v[172:175], v[52:55]
    v_cvt_pk_bf16_f32 v112, v16, v17
    v_mul_f32 v18, v18, v26
    v_mfma_f32_16x16x32_bf16 v[56:59], v[92:95], v[168:171], v[56:59]
    ds_read_b128 v[88:91], v7 offset:18432
    s_waitcnt lgkmcnt(5)
    v_mfma_f32_16x16x32_bf16 v[60:63], v[92:95], v[172:175], v[60:63]
    v_exp_f32 v19, -v19
    v_mfma_f32_16x16x32_bf16 v[48:51], v[96:99], v[176:179], v[48:51]
    ds_read_b128 v[92:95], v7 offset:19456
    v_fma_f32 v19, v19, v14, v14
    v_mfma_f32_16x16x32_bf16 v[52:55], v[96:99], v[180:183], v[52:55]
    v_rcp_f32 v19, v19
    v_mfma_f32_16x16x32_bf16 v[56:59], v[100:103], v[176:179], v[56:59]
    ds_read_b128 v[96:99], v7 offset:20480
    s_waitcnt lgkmcnt(5)
    v_mfma_f32_16x16x32_bf16 v[60:63], v[100:103], v[180:183], v[60:63]
    v_mul_f32 v19, v19, v27
    v_mul_f32 v20, v20, v5
    v_mfma_f32_16x16x32_bf16 v[48:51], v[104:107], v[184:187], v[48:51]
    ds_read_b128 v[100:103], v7 offset:21504
    v_cvt_pk_bf16_f32 v113, v18, v19
    v_mfma_f32_16x16x32_bf16 v[52:55], v[104:107], v[188:191], v[52:55]
    v_exp_f32 v20, -v20
    v_mfma_f32_16x16x32_bf16 v[56:59], v[108:111], v[184:187], v[56:59]
    ds_read_b128 v[104:107], v7 offset:22528
    s_waitcnt lgkmcnt(5)
    v_mfma_f32_16x16x32_bf16 v[60:63], v[108:111], v[188:191], v[60:63]
    v_fma_f32 v20, v20, v15, v15
    v_mul_f32 v21, v21, v5
    v_mfma_f32_16x16x32_bf16 v[48:51], v[80:83], v[192:195], v[48:51]
    ds_read_b128 v[108:111], v7 offset:23552
    v_mul_f32 v22, v22, v5
    v_mfma_f32_16x16x32_bf16 v[52:55], v[80:83], v[196:199], v[52:55]
    v_rcp_f32 v20, v20
    v_mfma_f32_16x16x32_bf16 v[56:59], v[84:87], v[192:195], v[56:59]
    ds_read_b128 v[80:83], v7 offset:24576
    s_waitcnt lgkmcnt(5)
    v_mfma_f32_16x16x32_bf16 v[60:63], v[84:87], v[196:199], v[60:63]
    v_exp_f32 v21, -v21
    v_mfma_f32_16x16x32_bf16 v[48:51], v[88:91], v[200:203], v[48:51]
    ds_read_b128 v[84:87], v7 offset:25600
    v_mul_f32 v20, v20, v28
    v_mfma_f32_16x16x32_bf16 v[52:55], v[88:91], v[204:207], v[52:55]
    v_exp_f32 v22, -v22
    v_mfma_f32_16x16x32_bf16 v[56:59], v[92:95], v[200:203], v[56:59]
    ds_read_b128 v[88:91], v7 offset:26624
    s_waitcnt lgkmcnt(5)
    v_mfma_f32_16x16x32_bf16 v[60:63], v[92:95], v[204:207], v[60:63]
    v_fma_f32 v21, v21, v15, v15
    v_fma_f32 v22, v22, v15, v15
    v_mfma_f32_16x16x32_bf16 v[48:51], v[96:99], v[208:211], v[48:51]
    ds_read_b128 v[92:95], v7 offset:27648
    v_mul_f32 v23, v23, v5
    v_mfma_f32_16x16x32_bf16 v[52:55], v[96:99], v[212:215], v[52:55]
    v_rcp_f32 v21, v21
    v_mfma_f32_16x16x32_bf16 v[56:59], v[100:103], v[208:211], v[56:59]
    ds_read_b128 v[96:99], v7 offset:28672
    s_waitcnt lgkmcnt(5)
    v_mfma_f32_16x16x32_bf16 v[60:63], v[100:103], v[212:215], v[60:63]
    v_rcp_f32 v22, v22
    v_mfma_f32_16x16x32_bf16 v[48:51], v[104:107], v[216:219], v[48:51]
    ds_read_b128 v[100:103], v7 offset:29696
    v_mul_f32 v21, v21, v29
    v_mfma_f32_16x16x32_bf16 v[52:55], v[104:107], v[220:223], v[52:55]
    v_cvt_pk_bf16_f32 v114, v20, v21
    v_mul_f32 v22, v22, v30
    v_mfma_f32_16x16x32_bf16 v[56:59], v[108:111], v[216:219], v[56:59]
    ds_read_b128 v[104:107], v7 offset:30720
    s_waitcnt lgkmcnt(5)
    v_mfma_f32_16x16x32_bf16 v[60:63], v[108:111], v[220:223], v[60:63]
    v_exp_f32 v23, -v23
    v_mfma_f32_16x16x32_bf16 v[48:51], v[80:83], v[224:227], v[48:51]
    ds_read_b128 v[108:111], v7 offset:31744
    v_fma_f32 v23, v23, v15, v15
    v_mfma_f32_16x16x32_bf16 v[52:55], v[80:83], v[228:231], v[52:55]
    v_rcp_f32 v23, v23
    v_mfma_f32_16x16x32_bf16 v[56:59], v[84:87], v[224:227], v[56:59]
    ds_read_b128 v[80:83], v7 offset:32768
    s_waitcnt lgkmcnt(5)
    v_mfma_f32_16x16x32_bf16 v[60:63], v[84:87], v[228:231], v[60:63]
    v_mul_f32 v23, v23, v31
    v_mul_f32 v32, v32, v4
    v_mfma_f32_16x16x32_bf16 v[48:51], v[88:91], v[232:235], v[48:51]
    ds_read_b128 v[84:87], v7 offset:33792
    v_cvt_pk_bf16_f32 v115, v22, v23
    v_mfma_f32_16x16x32_bf16 v[52:55], v[88:91], v[236:239], v[52:55]
    buffer_store_dwordx4 v[112:115], v2, s[28:31], s59 offen offset:0 sc1
    v_mfma_f32_16x16x32_bf16 v[56:59], v[92:95], v[232:235], v[56:59]
    ds_read_b128 v[88:91], v7 offset:34816
    s_waitcnt lgkmcnt(5)
    v_mfma_f32_16x16x32_bf16 v[60:63], v[92:95], v[236:239], v[60:63]
    v_exp_f32 v32, -v32
    v_mfma_f32_16x16x32_bf16 v[48:51], v[96:99], v[240:243], v[48:51]
    ds_read_b128 v[92:95], v7 offset:35840
    v_fma_f32 v32, v32, v14, v14
    v_mfma_f32_16x16x32_bf16 v[52:55], v[96:99], v[244:247], v[52:55]
    v_rcp_f32 v32, v32
    v_mfma_f32_16x16x32_bf16 v[56:59], v[100:103], v[240:243], v[56:59]
    ds_read_b128 v[96:99], v7 offset:36864
    s_waitcnt lgkmcnt(5)
    v_mfma_f32_16x16x32_bf16 v[60:63], v[100:103], v[244:247], v[60:63]
    v_mul_f32 v32, v32, v40
    v_mul_f32 v33, v33, v4
    v_mfma_f32_16x16x32_bf16 v[48:51], v[104:107], v[248:251], v[48:51]
    ds_read_b128 v[100:103], v7 offset:37888
    v_mul_f32 v34, v34, v4
    v_mfma_f32_16x16x32_bf16 v[52:55], v[104:107], v[252:255], v[52:55]
    v_exp_f32 v33, -v33
    v_mfma_f32_16x16x32_bf16 v[56:59], v[108:111], v[248:251], v[56:59]
    ds_read_b128 v[104:107], v7 offset:38912
    s_waitcnt lgkmcnt(5)
    v_mfma_f32_16x16x32_bf16 v[60:63], v[108:111], v[252:255], v[60:63]
    v_exp_f32 v34, -v34
    v_mfma_f32_16x16x32_bf16 v[64:67], v[80:83], v[128:131], 0
    ds_read_b128 v[108:111], v7 offset:39936
    v_fma_f32 v33, v33, v14, v14
    v_mfma_f32_16x16x32_bf16 v[68:71], v[80:83], v[132:135], 0
    v_rcp_f32 v33, v33
    v_mfma_f32_16x16x32_bf16 v[72:75], v[84:87], v[128:131], 0
    ds_read_b128 v[80:83], v7 offset:40960
    s_waitcnt lgkmcnt(5)
    v_mfma_f32_16x16x32_bf16 v[76:79], v[84:87], v[132:135], 0
    v_mul_f32 v33, v33, v41
    v_fma_f32 v34, v34, v14, v14
    v_mfma_f32_16x16x32_bf16 v[64:67], v[88:91], v[136:139], v[64:67]
    ds_read_b128 v[84:87], v7 offset:41984
    v_cvt_pk_bf16_f32 v116, v32, v33
    v_mfma_f32_16x16x32_bf16 v[68:71], v[88:91], v[140:143], v[68:71]
    v_rcp_f32 v34, v34
    v_mfma_f32_16x16x32_bf16 v[72:75], v[92:95], v[136:139], v[72:75]
    ds_read_b128 v[88:91], v7 offset:43008
    s_waitcnt lgkmcnt(5)
    v_mfma_f32_16x16x32_bf16 v[76:79], v[92:95], v[140:143], v[76:79]
    v_mul_f32 v34, v34, v42
    v_mul_f32 v35, v35, v4
    v_mfma_f32_16x16x32_bf16 v[64:67], v[96:99], v[144:147], v[64:67]
    ds_read_b128 v[92:95], v7 offset:44032
    v_mul_f32 v36, v36, v5
    v_mfma_f32_16x16x32_bf16 v[68:71], v[96:99], v[148:151], v[68:71]
    v_exp_f32 v35, -v35
    v_mfma_f32_16x16x32_bf16 v[72:75], v[100:103], v[144:147], v[72:75]
    ds_read_b128 v[96:99], v7 offset:45056
    s_waitcnt lgkmcnt(5)
    v_mfma_f32_16x16x32_bf16 v[76:79], v[100:103], v[148:151], v[76:79]
    v_exp_f32 v36, -v36
    v_mfma_f32_16x16x32_bf16 v[64:67], v[104:107], v[152:155], v[64:67]
    ds_read_b128 v[100:103], v7 offset:46080
    v_fma_f32 v35, v35, v14, v14
    v_mfma_f32_16x16x32_bf16 v[68:71], v[104:107], v[156:159], v[68:71]
    v_rcp_f32 v35, v35
    v_mfma_f32_16x16x32_bf16 v[72:75], v[108:111], v[152:155], v[72:75]
    ds_read_b128 v[104:107], v7 offset:47104
    s_waitcnt lgkmcnt(5)
    v_mfma_f32_16x16x32_bf16 v[76:79], v[108:111], v[156:159], v[76:79]
    v_mul_f32 v35, v35, v43
    v_fma_f32 v36, v36, v15, v15
    v_mfma_f32_16x16x32_bf16 v[64:67], v[80:83], v[160:163], v[64:67]
    ds_read_b128 v[108:111], v7 offset:48128
    v_cvt_pk_bf16_f32 v117, v34, v35
    v_mfma_f32_16x16x32_bf16 v[68:71], v[80:83], v[164:167], v[68:71]
    v_rcp_f32 v36, v36
    v_mfma_f32_16x16x32_bf16 v[72:75], v[84:87], v[160:163], v[72:75]
    ds_read_b128 v[80:83], v7 offset:49152
    s_waitcnt lgkmcnt(5)
    v_mfma_f32_16x16x32_bf16 v[76:79], v[84:87], v[164:167], v[76:79]
    v_mul_f32 v36, v36, v44
    v_mul_f32 v37, v37, v5
    v_mfma_f32_16x16x32_bf16 v[64:67], v[88:91], v[168:171], v[64:67]
    ds_read_b128 v[84:87], v7 offset:50176
    v_mul_f32 v38, v38, v5
    v_mfma_f32_16x16x32_bf16 v[68:71], v[88:91], v[172:175], v[68:71]
    v_exp_f32 v37, -v37
    v_mfma_f32_16x16x32_bf16 v[72:75], v[92:95], v[168:171], v[72:75]
    ds_read_b128 v[88:91], v7 offset:51200
    s_waitcnt lgkmcnt(5)
    v_mfma_f32_16x16x32_bf16 v[76:79], v[92:95], v[172:175], v[76:79]
    v_exp_f32 v38, -v38
    v_mfma_f32_16x16x32_bf16 v[64:67], v[96:99], v[176:179], v[64:67]
    ds_read_b128 v[92:95], v7 offset:52224
    v_fma_f32 v37, v37, v15, v15
    v_mfma_f32_16x16x32_bf16 v[68:71], v[96:99], v[180:183], v[68:71]
    v_rcp_f32 v37, v37
    v_mfma_f32_16x16x32_bf16 v[72:75], v[100:103], v[176:179], v[72:75]
    ds_read_b128 v[96:99], v7 offset:53248
    s_waitcnt lgkmcnt(5)
    v_mfma_f32_16x16x32_bf16 v[76:79], v[100:103], v[180:183], v[76:79]
    v_mul_f32 v37, v37, v45
    v_fma_f32 v38, v38, v15, v15
    v_mfma_f32_16x16x32_bf16 v[64:67], v[104:107], v[184:187], v[64:67]
    ds_read_b128 v[100:103], v7 offset:54272
    v_cvt_pk_bf16_f32 v118, v36, v37
    v_mfma_f32_16x16x32_bf16 v[68:71], v[104:107], v[188:191], v[68:71]
    v_rcp_f32 v38, v38
    v_mfma_f32_16x16x32_bf16 v[72:75], v[108:111], v[184:187], v[72:75]
    ds_read_b128 v[104:107], v7 offset:55296
    s_waitcnt lgkmcnt(5)
    v_mfma_f32_16x16x32_bf16 v[76:79], v[108:111], v[188:191], v[76:79]
    v_mul_f32 v38, v38, v46
    v_mul_f32 v39, v39, v5
    v_mfma_f32_16x16x32_bf16 v[64:67], v[80:83], v[192:195], v[64:67]
    ds_read_b128 v[108:111], v7 offset:56320
    v_mul_f32 v48, v48, v4
    v_mfma_f32_16x16x32_bf16 v[68:71], v[80:83], v[196:199], v[68:71]
    v_exp_f32 v39, -v39
    v_mfma_f32_16x16x32_bf16 v[72:75], v[84:87], v[192:195], v[72:75]
    ds_read_b128 v[80:83], v7 offset:57344
    s_waitcnt lgkmcnt(5)
    v_mfma_f32_16x16x32_bf16 v[76:79], v[84:87], v[196:199], v[76:79]
    v_fma_f32 v39, v39, v15, v15
    v_mul_f32 v49, v49, v4
    v_mfma_f32_16x16x32_bf16 v[64:67], v[88:91], v[200:203], v[64:67]
    ds_read_b128 v[84:87], v7 offset:58368
    v_mul_f32 v50, v50, v4
    v_mfma_f32_16x16x32_bf16 v[68:71], v[88:91], v[204:207], v[68:71]
    v_rcp_f32 v39, v39
    v_mfma_f32_16x16x32_bf16 v[72:75], v[92:95], v[200:203], v[72:75]
    ds_read_b128 v[88:91], v7 offset:59392
    s_waitcnt lgkmcnt(5)
    v_mfma_f32_16x16x32_bf16 v[76:79], v[92:95], v[204:207], v[76:79]
    v_mul_f32 v39, v39, v47
    v_mul_f32 v51, v51, v4
    v_mfma_f32_16x16x32_bf16 v[64:67], v[96:99], v[208:211], v[64:67]
    ds_read_b128 v[92:95], v7 offset:60416
    v_cvt_pk_bf16_f32 v119, v38, v39
    v_mfma_f32_16x16x32_bf16 v[68:71], v[96:99], v[212:215], v[68:71]
    buffer_store_dwordx4 v[116:119], v2, s[28:31], s59 offen offset:2048 sc1
    v_mfma_f32_16x16x32_bf16 v[72:75], v[100:103], v[208:211], v[72:75]
    ds_read_b128 v[96:99], v7 offset:61440
    s_waitcnt lgkmcnt(5)
    v_mfma_f32_16x16x32_bf16 v[76:79], v[100:103], v[212:215], v[76:79]
    v_exp_f32 v48, -v48
    v_mfma_f32_16x16x32_bf16 v[64:67], v[104:107], v[216:219], v[64:67]
    ds_read_b128 v[100:103], v7 offset:62464
    v_fma_f32 v48, v48, v14, v14
    v_mfma_f32_16x16x32_bf16 v[68:71], v[104:107], v[220:223], v[68:71]
    v_rcp_f32 v48, v48
    v_mfma_f32_16x16x32_bf16 v[72:75], v[108:111], v[216:219], v[72:75]
    ds_read_b128 v[104:107], v7 offset:63488
    s_waitcnt lgkmcnt(5)
    v_mfma_f32_16x16x32_bf16 v[76:79], v[108:111], v[220:223], v[76:79]
    v_exp_f32 v49, -v49
    v_mfma_f32_16x16x32_bf16 v[64:67], v[80:83], v[224:227], v[64:67]
    ds_read_b128 v[108:111], v7 offset:64512
    v_mul_f32 v48, v48, v56
    v_mfma_f32_16x16x32_bf16 v[68:71], v[80:83], v[228:231], v[68:71]
    v_exp_f32 v50, -v50
    v_mfma_f32_16x16x32_bf16 v[72:75], v[84:87], v[224:227], v[72:75]
    ds_read_b128 v[80:83], v8 offset:0
    s_waitcnt lgkmcnt(5)
    v_mfma_f32_16x16x32_bf16 v[76:79], v[84:87], v[228:231], v[76:79]
    v_fma_f32 v49, v49, v14, v14
    v_fma_f32 v50, v50, v14, v14
    v_mfma_f32_16x16x32_bf16 v[64:67], v[88:91], v[232:235], v[64:67]
    ds_read_b128 v[84:87], v8 offset:1024
    v_mul_f32 v52, v52, v5
    v_mfma_f32_16x16x32_bf16 v[68:71], v[88:91], v[236:239], v[68:71]
    v_rcp_f32 v49, v49
    v_mfma_f32_16x16x32_bf16 v[72:75], v[92:95], v[232:235], v[72:75]
    ds_read_b128 v[88:91], v8 offset:2048
    s_waitcnt lgkmcnt(5)
    v_mfma_f32_16x16x32_bf16 v[76:79], v[92:95], v[236:239], v[76:79]
    v_rcp_f32 v50, v50
    v_mfma_f32_16x16x32_bf16 v[64:67], v[96:99], v[240:243], v[64:67]
    s_barrier
    ds_read_b128 v[92:95], v8 offset:3072
    v_mul_f32 v49, v49, v57
    v_mfma_f32_16x16x32_bf16 v[68:71], v[96:99], v[244:247], v[68:71]
    v_cvt_pk_bf16_f32 v112, v48, v49
    v_mul_f32 v50, v50, v58
    v_mfma_f32_16x16x32_bf16 v[72:75], v[100:103], v[240:243], v[72:75]
    ds_read_b128 v[96:99], v8 offset:4096
    s_waitcnt lgkmcnt(5)
    v_mfma_f32_16x16x32_bf16 v[76:79], v[100:103], v[244:247], v[76:79]
    v_exp_f32 v51, -v51
    v_mfma_f32_16x16x32_bf16 v[64:67], v[104:107], v[248:251], v[64:67]
    ds_read_b128 v[100:103], v8 offset:5120
    v_fma_f32 v51, v51, v14, v14
    v_mfma_f32_16x16x32_bf16 v[68:71], v[104:107], v[252:255], v[68:71]
    v_rcp_f32 v51, v51
    v_mfma_f32_16x16x32_bf16 v[72:75], v[108:111], v[248:251], v[72:75]
    ds_read_b128 v[104:107], v8 offset:6144
    s_waitcnt lgkmcnt(5)
    v_mfma_f32_16x16x32_bf16 v[76:79], v[108:111], v[252:255], v[76:79]
    v_exp_f32 v52, -v52
    v_mfma_f32_16x16x32_bf16 v[16:19], v[80:83], v[128:131], 0
    ds_read_b128 v[108:111], v8 offset:7168
    v_mul_f32 v51, v51, v59
    v_mfma_f32_16x16x32_bf16 v[20:23], v[80:83], v[132:135], 0
    v_cvt_pk_bf16_f32 v113, v50, v51
    v_fma_f32 v52, v52, v15, v15
    v_mfma_f32_16x16x32_bf16 v[24:27], v[84:87], v[128:131], 0
    ds_read_b128 v[80:83], v8 offset:8192
    s_waitcnt lgkmcnt(5)
    v_mfma_f32_16x16x32_bf16 v[28:31], v[84:87], v[132:135], 0
    v_rcp_f32 v52, v52
    v_mfma_f32_16x16x32_bf16 v[16:19], v[88:91], v[136:139], v[16:19]
    ds_read_b128 v[84:87], v8 offset:9216
    v_mul_f32 v52, v52, v60
    v_mfma_f32_16x16x32_bf16 v[20:23], v[88:91], v[140:143], v[20:23]
    v_mul_f32 v53, v53, v5
    v_mul_f32 v54, v54, v5
    v_mfma_f32_16x16x32_bf16 v[24:27], v[92:95], v[136:139], v[24:27]
    ds_read_b128 v[88:91], v8 offset:10240
    s_waitcnt lgkmcnt(5)
    v_mfma_f32_16x16x32_bf16 v[28:31], v[92:95], v[140:143], v[28:31]
    v_exp_f32 v53, -v53
    v_mfma_f32_16x16x32_bf16 v[16:19], v[96:99], v[144:147], v[16:19]
    ds_read_b128 v[92:95], v8 offset:11264
    v_fma_f32 v53, v53, v15, v15
    v_mfma_f32_16x16x32_bf16 v[20:23], v[96:99], v[148:151], v[20:23]
    v_rcp_f32 v53, v53
    v_mfma_f32_16x16x32_bf16 v[24:27], v[100:103], v[144:147], v[24:27]
    ds_read_b128 v[96:99], v8 offset:12288
    s_waitcnt lgkmcnt(5)
    v_mfma_f32_16x16x32_bf16 v[28:31], v[100:103], v[148:151], v[28:31]
    v_exp_f32 v54, -v54
    v_mfma_f32_16x16x32_bf16 v[16:19], v[104:107], v[152:155], v[16:19]
    ds_read_b128 v[100:103], v8 offset:13312
    v_mul_f32 v53, v53, v61
    v_mfma_f32_16x16x32_bf16 v[20:23], v[104:107], v[156:159], v[20:23]
    v_cvt_pk_bf16_f32 v114, v52, v53
    v_fma_f32 v54, v54, v15, v15
    v_mfma_f32_16x16x32_bf16 v[24:27], v[108:111], v[152:155], v[24:27]
    ds_read_b128 v[104:107], v8 offset:14336
    s_waitcnt lgkmcnt(5)
    v_mfma_f32_16x16x32_bf16 v[28:31], v[108:111], v[156:159], v[28:31]
    v_rcp_f32 v54, v54
    v_mfma_f32_16x16x32_bf16 v[16:19], v[80:83], v[160:163], v[16:19]
    ds_read_b128 v[108:111], v8 offset:15360
    v_mul_f32 v54, v54, v62
    v_mfma_f32_16x16x32_bf16 v[20:23], v[80:83], v[164:167], v[20:23]
    v_mul_f32 v55, v55, v5
    v_mul_f32 v64, v64, v4
    v_mfma_f32_16x16x32_bf16 v[24:27], v[84:87], v[160:163], v[24:27]
    ds_read_b128 v[80:83], v8 offset:16384
    s_waitcnt lgkmcnt(5)
    v_mfma_f32_16x16x32_bf16 v[28:31], v[84:87], v[164:167], v[28:31]
    v_exp_f32 v55, -v55
    v_mfma_f32_16x16x32_bf16 v[16:19], v[88:91], v[168:171], v[16:19]
    ds_read_b128 v[84:87], v8 offset:17408
    v_fma_f32 v55, v55, v15, v15
    v_mfma_f32_16x16x32_bf16 v[20:23], v[88:91], v[172:175], v[20:23]
    v_rcp_f32 v55, v55
    v_mfma_f32_16x16x32_bf16 v[24:27], v[92:95], v[168:171], v[24:27]
    ds_read_b128 v[88:91], v8 offset:18432
    s_waitcnt lgkmcnt(5)
    v_mfma_f32_16x16x32_bf16 v[28:31], v[92:95], v[172:175], v[28:31]
    v_mul_f32 v55, v55, v63
    v_mul_f32 v65, v65, v4
    v_mfma_f32_16x16x32_bf16 v[16:19], v[96:99], v[176:179], v[16:19]
    ds_read_b128 v[92:95], v8 offset:19456
    v_cvt_pk_bf16_f32 v115, v54, v55
    v_mfma_f32_16x16x32_bf16 v[20:23], v[96:99], v[180:183], v[20:23]
    s_add_u32 s59, s59, 0x1000
    buffer_store_dwordx4 v[112:115], v2, s[28:31], s59 offen offset:0 sc1
    v_mfma_f32_16x16x32_bf16 v[24:27], v[100:103], v[176:179], v[24:27]
    ds_read_b128 v[96:99], v8 offset:20480
    s_waitcnt lgkmcnt(5)
    v_mfma_f32_16x16x32_bf16 v[28:31], v[100:103], v[180:183], v[28:31]
    v_exp_f32 v64, -v64
    v_mfma_f32_16x16x32_bf16 v[16:19], v[104:107], v[184:187], v[16:19]
    s_barrier
    ds_read_b128 v[100:103], v8 offset:21504
    v_fma_f32 v64, v64, v14, v14
    v_mfma_f32_16x16x32_bf16 v[20:23], v[104:107], v[188:191], v[20:23]
    v_rcp_f32 v64, v64
    v_mfma_f32_16x16x32_bf16 v[24:27], v[108:111], v[184:187], v[24:27]
    ds_read_b128 v[104:107], v8 offset:22528
    s_waitcnt lgkmcnt(5)
    v_mfma_f32_16x16x32_bf16 v[28:31], v[108:111], v[188:191], v[28:31]
    v_exp_f32 v65, -v65
    v_mfma_f32_16x16x32_bf16 v[16:19], v[80:83], v[192:195], v[16:19]
    ds_read_b128 v[108:111], v8 offset:23552
    v_mul_f32 v64, v64, v72
    v_mfma_f32_16x16x32_bf16 v[20:23], v[80:83], v[196:199], v[20:23]
    v_fma_f32 v65, v65, v14, v14
    v_mul_f32 v66, v66, v4
    v_mfma_f32_16x16x32_bf16 v[24:27], v[84:87], v[192:195], v[24:27]
    ds_read_b128 v[80:83], v8 offset:24576
    s_waitcnt lgkmcnt(5)
    v_mfma_f32_16x16x32_bf16 v[28:31], v[84:87], v[196:199], v[28:31]
    v_rcp_f32 v65, v65
    v_mfma_f32_16x16x32_bf16 v[16:19], v[88:91], v[200:203], v[16:19]
    ds_read_b128 v[84:87], v8 offset:25600
    v_mov_b32 v11, 2
    v_mfma_f32_16x16x32_bf16 v[20:23], v[88:91], v[204:207], v[20:23]
    s_waitcnt vmcnt(1)
    s_cmp_eq_u32 s98, 1
    s_cbranch_scc0 far_fa2
    buffer_store_dword v11, v9, s[28:31], s62 offen
back_fa2:
    v_mfma_f32_16x16x32_bf16 v[24:27], v[92:95], v[200:203], v[24:27]
    ds_read_b128 v[88:91], v8 offset:26624
    s_waitcnt lgkmcnt(5)
    v_mfma_f32_16x16x32_bf16 v[28:31], v[92:95], v[204:207], v[28:31]
    v_exp_f32 v66, -v66
    v_mfma_f32_16x16x32_bf16 v[16:19], v[96:99], v[208:211], v[16:19]
    ds_read_b128 v[92:95], v8 offset:27648
    v_mul_f32 v65, v65, v73
    v_mfma_f32_16x16x32_bf16 v[20:23], v[96:99], v[212:215], v[20:23]
    v_cvt_pk_bf16_f32 v116, v64, v65
    v_fma_f32 v66, v66, v14, v14
    v_mfma_f32_16x16x32_bf16 v[24:27], v[100:103], v[208:211], v[24:27]
    ds_read_b128 v[96:99], v8 offset:28672
    s_waitcnt lgkmcnt(5)
    v_mfma_f32_16x16x32_bf16 v[28:31], v[100:103], v[212:215], v[28:31]
    v_rcp_f32 v66, v66
    v_mfma_f32_16x16x32_bf16 v[16:19], v[104:107], v[216:219], v[16:19]
    ds_read_b128 v[100:103], v8 offset:29696
    v_mul_f32 v66, v66, v74
    v_mfma_f32_16x16x32_bf16 v[20:23], v[104:107], v[220:223], v[20:23]
    v_mul_f32 v67, v67, v4
    v_mul_f32 v68, v68, v5
    v_mfma_f32_16x16x32_bf16 v[24:27], v[108:111], v[216:219], v[24:27]
    ds_read_b128 v[104:107], v8 offset:30720
    s_waitcnt lgkmcnt(5)
    v_mfma_f32_16x16x32_bf16 v[28:31], v[108:111], v[220:223], v[28:31]
    v_exp_f32 v67, -v67
    v_mfma_f32_16x16x32_bf16 v[16:19], v[80:83], v[224:227], v[16:19]
    ds_read_b128 v[108:111], v8 offset:31744
    v_fma_f32 v67, v67, v14, v14
    v_mfma_f32_16x16x32_bf16 v[20:23], v[80:83], v[228:231], v[20:23]
    v_rcp_f32 v67, v67
    v_mfma_f32_16x16x32_bf16 v[24:27], v[84:87], v[224:227], v[24:27]
    ds_read_b128 v[80:83], v2 offset:0
    s_waitcnt lgkmcnt(5)
    v_mfma_f32_16x16x32_bf16 v[28:31], v[84:87], v[228:231], v[28:31]
    v_exp_f32 v68, -v68
    v_mfma_f32_16x16x32_bf16 v[16:19], v[88:91], v[232:235], v[16:19]
    ds_read_b128 v[84:87], v2 offset:1024
    v_mul_f32 v67, v67, v75
    v_mfma_f32_16x16x32_bf16 v[20:23], v[88:91], v[236:239], v[20:23]
    v_cvt_pk_bf16_f32 v117, v66, v67
    v_fma_f32 v68, v68, v15, v15
    v_mfma_f32_16x16x32_bf16 v[24:27], v[92:95], v[232:235], v[24:27]
    ds_read_b128 v[88:91], v2 offset:2048
    s_waitcnt lgkmcnt(5)
    v_mfma_f32_16x16x32_bf16 v[28:31], v[92:95], v[236:239], v[28:31]
    v_rcp_f32 v68, v68
    v_mfma_f32_16x16x32_bf16 v[16:19], v[96:99], v[240:243], v[16:19]
    ds_read_b128 v[92:95], v2 offset:3072
    v_mul_f32 v68, v68, v76
    v_mfma_f32_16x16x32_bf16 v[20:23], v[96:99], v[244:247], v[20:23]
    v_mul_f32 v69, v69, v5
    v_mul_f32 v70, v70, v5
    v_mfma_f32_16x16x32_bf16 v[24:27], v[100:103], v[240:243], v[24:27]
    ds_read_b128 v[96:99], v2 offset:4096
    s_waitcnt lgkmcnt(5)
    v_mfma_f32_16x16x32_bf16 v[28:31], v[100:103], v[244:247], v[28:31]
    v_exp_f32 v69, -v69
    v_mfma_f32_16x16x32_bf16 v[16:19], v[104:107], v[248:251], v[16:19]
    ds_read_b128 v[100:103], v2 offset:5120
    v_fma_f32 v69, v69, v15, v15
    v_mfma_f32_16x16x32_bf16 v[20:23], v[104:107], v[252:255], v[20:23]
    v_rcp_f32 v69, v69
    v_mfma_f32_16x16x32_bf16 v[24:27], v[108:111], v[248:251], v[24:27]
    ds_read_b128 v[104:107], v2 offset:6144
pad_3:
    s_cbranch_execz pad_7
    s_waitcnt lgkmcnt(5)
    v_mfma_f32_16x16x32_bf16 v[28:31], v[108:111], v[252:255], v[28:31]
    v_exp_f32 v70, -v70
    v_mfma_f32_16x16x32_bf16 v[32:35], v[80:83], v[128:131], 0
    ds_read_b128 v[108:111], v2 offset:7168
    v_mul_f32 v69, v69, v77
    v_mfma_f32_16x16x32_bf16 v[36:39], v[80:83], v[132:135], 0
    v_cvt_pk_bf16_f32 v118, v68, v69
    v_fma_f32 v70, v70, v15, v15
    v_mfma_f32_16x16x32_bf16 v[40:43], v[84:87], v[128:131], 0
    ds_read_b128 v[80:83], v2 offset:8192
    s_waitcnt lgkmcnt(5)
    v_mfma_f32_16x16x32_bf16 v[44:47], v[84:87], v[132:135], 0
    v_rcp_f32 v70, v70
    v_mfma_f32_16x16x32_bf16 v[32:35], v[88:91], v[136:139], v[32:35]
    ds_read_b128 v[84:87], v2 offset:9216
    v_mul_f32 v70, v70, v78
    v_mfma_f32_16x16x32_bf16 v[36:39], v[88:91], v[140:143], v[36:39]
    v_mul_f32 v71, v71, v5
    v_mul_f32 v16, v16, v4
    v_mfma_f32_16x16x32_bf16 v[40:43], v[92:95], v[136:139], v[40:43]
    ds_read_b128 v[88:91], v2 offset:10240
    s_waitcnt lgkmcnt(5)
    v_mfma_f32_16x16x32_bf16 v[44:47], v[92:95], v[140:143], v[44:47]
    v_exp_f32 v71, -v71
    v_mfma_f32_16x16x32_bf16 v[32:35], v[96:99], v[144:147], v[32:35]
    s_barrier
    ds_read_b128 v[92:95], v2 offset:11264
    v_fma_f32 v71, v71, v15, v15
    v_mfma_f32_16x16x32_bf16 v[36:39], v[96:99], v[148:151], v[36:39]
    v_rcp_f32 v71, v71
    v_mfma_f32_16x16x32_bf16 v[40:43], v[100:103], v[144:147], v[40:43]
    ds_read_b128 v[96:99], v2 offset:12288
    s_waitcnt lgkmcnt(5)
    v_mfma_f32_16x16x32_bf16 v[44:47], v[100:103], v[148:151], v[44:47]
    v_mul_f32 v71, v71, v79
    v_mul_f32 v17, v17, v4
    v_mfma_f32_16x16x32_bf16 v[32:35], v[104:107], v[152:155], v[32:35]
    ds_read_b128 v[100:103], v2 offset:13312
    v_cvt_pk_bf16_f32 v119, v70, v71
    v_mfma_f32_16x16x32_bf16 v[36:39], v[104:107], v[156:159], v[36:39]
    buffer_store_dwordx4 v[116:119], v2, s[28:31], s59 offen offset:2048 sc1
    v_mfma_f32_16x16x32_bf16 v[40:43], v[108:111], v[152:155], v[40:43]
    ds_read_b128 v[104:107], v2 offset:14336
    s_waitcnt lgkmcnt(5)
    v_mfma_f32_16x16x32_bf16 v[44:47], v[108:111], v[156:159], v[44:47]
    v_exp_f32 v16, -v16
    v_mfma_f32_16x16x32_bf16 v[32:35], v[80:83], v[160:163], v[32:35]
    ds_read_b128 v[108:111], v2 offset:15360
    v_fma_f32 v16, v16, v14, v14
    v_mfma_f32_16x16x32_bf16 v[36:39], v[80:83], v[164:167], v[36:39]
    v_rcp_f32 v16, v16
    v_mfma_f32_16x16x32_bf16 v[40:43], v[84:87], v[160:163], v[40:43]
    ds_read_b128 v[80:83], v2 offset:16384
    s_waitcnt lgkmcnt(5)
    v_mfma_f32_16x16x32_bf16 v[44:47], v[84:87], v[164:167], v[44:47]
    v_exp_f32 v17, -v17
    v_mfma_f32_16x16x32_bf16 v[32:35], v[88:91], v[168:171], v[32:35]
    ds_read_b128 v[84:87], v2 offset:17408
    v_mov_b32 v12, 3
    v_mfma_f32_16x16x32_bf16 v[36:39], v[88:91], v[172:175], v[36:39]
    s_waitcnt vmcnt(2)
    s_cmp_eq_u32 s98, 1
    s_cbranch_scc0 far_fa3
    buffer_store_dword v12, v9, s[28:31], s62 offen
back_fa3:
    v_mfma_f32_16x16x32_bf16 v[40:43], v[92:95], v[168:171], v[40:43]
    ds_read_b128 v[88:91], v2 offset:18432
    s_waitcnt lgkmcnt(5)
    v_mfma_f32_16x16x32_bf16 v[44:47], v[92:95], v[172:175], v[44:47]
    v_mul_f32 v16, v16, v24
    v_fma_f32 v17, v17, v14, v14
    v_mfma_f32_16x16x32_bf16 v[32:35], v[96:99], v[176:179], v[32:35]
    ds_read_b128 v[92:95], v2 offset:19456
    v_mul_f32 v18, v18, v4
    v_mfma_f32_16x16x32_bf16 v[36:39], v[96:99], v[180:183], v[36:39]
    v_rcp_f32 v17, v17
    v_mfma_f32_16x16x32_bf16 v[40:43], v[100:103], v[176:179], v[40:43]
    ds_read_b128 v[96:99], v2 offset:20480
    s_waitcnt lgkmcnt(5)
    v_mfma_f32_16x16x32_bf16 v[44:47], v[100:103], v[180:183], v[44:47]
    v_exp_f32 v18, -v18
    v_mfma_f32_16x16x32_bf16 v[32:35], v[104:107], v[184:187], v[32:35]
    ds_read_b128 v[100:103], v2 offset:21504
    v_mul_f32 v17, v17, v25
    v_mfma_f32_16x16x32_bf16 v[36:39], v[104:107], v[188:191], v[36:39]
    v_cvt_pk_bf16_f32 v112, v16, v17
    v_fma_f32 v18, v18, v14, v14
    v_mfma_f32_16x16x32_bf16 v[40:43], v[108:111], v[184:187], v[40:43]
    ds_read_b128 v[104:107], v2 offset:22528
    s_waitcnt lgkmcnt(5)
    v_mfma_f32_16x16x32_bf16 v[44:47], v[108:111], v[188:191], v[44:47]
    v_rcp_f32 v18, v18
    v_mfma_f32_16x16x32_bf16 v[32:35], v[80:83], v[192:195], v[32:35]
    ds_read_b128 v[108:111], v2 offset:23552
    v_mul_f32 v18, v18, v26
    v_mfma_f32_16x16x32_bf16 v[36:39], v[80:83], v[196:199], v[36:39]
    v_mul_f32 v19, v19, v4
    v_mul_f32 v20, v20, v5
    v_mfma_f32_16x16x32_bf16 v[40:43], v[84:87], v[192:195], v[40:43]
    ds_read_b128 v[80:83], v2 offset:24576
    s_waitcnt lgkmcnt(5)
    v_mfma_f32_16x16x32_bf16 v[44:47], v[84:87], v[196:199], v[44:47]
    v_exp_f32 v19, -v19
    v_mfma_f32_16x16x32_bf16 v[32:35], v[88:91], v[200:203], v[32:35]
    ds_read_b128 v[84:87], v2 offset:25600
    v_fma_f32 v19, v19, v14, v14
    v_mfma_f32_16x16x32_bf16 v[36:39], v[88:91], v[204:207], v[36:39]
    v_rcp_f32 v19, v19
    v_mfma_f32_16x16x32_bf16 v[40:43], v[92:95], v[200:203], v[40:43]
    ds_read_b128 v[88:91], v2 offset:26624
    s_waitcnt lgkmcnt(5)
    v_mfma_f32_16x16x32_bf16 v[44:47], v[92:95], v[204:207], v[44:47]
    v_exp_f32 v20, -v20
    v_mfma_f32_16x16x32_bf16 v[32:35], v[96:99], v[208:211], v[32:35]
    ds_read_b128 v[92:95], v2 offset:27648
    v_mul_f32 v19, v19, v27
    v_mfma_f32_16x16x32_bf16 v[36:39], v[96:99], v[212:215], v[36:39]
    v_cvt_pk_bf16_f32 v113, v18, v19
    v_fma_f32 v20, v20, v15, v15
    v_mfma_f32_16x16x32_bf16 v[40:43], v[100:103], v[208:211], v[40:43]
    ds_read_b128 v[96:99], v2 offset:28672
    s_waitcnt lgkmcnt(5)
    v_mfma_f32_16x16x32_bf16 v[44:47], v[100:103], v[212:215], v[44:47]
    v_rcp_f32 v20, v20
    v_mfma_f32_16x16x32_bf16 v[32:35], v[104:107], v[216:219], v[32:35]
    ds_read_b128 v[100:103], v2 offset:29696
    v_mul_f32 v20, v20, v28
    v_mfma_f32_16x16x32_bf16 v[36:39], v[104:107], v[220:223], v[36:39]
    v_mul_f32 v21, v21, v5
    v_mul_f32 v22, v22, v5
    v_mfma_f32_16x16x32_bf16 v[40:43], v[108:111], v[216:219], v[40:43]
    ds_read_b128 v[104:107], v2 offset:30720
    s_waitcnt lgkmcnt(5)
    v_mfma_f32_16x16x32_bf16 v[44:47], v[108:111], v[220:223], v[44:47]
    v_exp_f32 v21, -v21
    v_mfma_f32_16x16x32_bf16 v[32:35], v[80:83], v[224:227], v[32:35]
    ds_read_b128 v[108:111], v2 offset:31744
    v_fma_f32 v21, v21, v15, v15
    v_mfma_f32_16x16x32_bf16 v[36:39], v[80:83], v[228:231], v[36:39]
    v_rcp_f32 v21, v21
    v_mfma_f32_16x16x32_bf16 v[40:43], v[84:87], v[224:227], v[40:43]
    ds_read_b128 v[80:83], v2 offset:32768
    s_waitcnt lgkmcnt(5)
    v_mfma_f32_16x16x32_bf16 v[44:47], v[84:87], v[228:231], v[44:47]
    v_exp_f32 v22, -v22
    v_mfma_f32_16x16x32_bf16 v[32:35], v[88:91], v[232:235], v[32:35]
    ds_read_b128 v[84:87], v2 offset:33792
    v_mul_f32 v21, v21, v29
    v_mfma_f32_16x16x32_bf16 v[36:39], v[88:91], v[236:239], v[36:39]
    v_cvt_pk_bf16_f32 v114, v20, v21
    v_fma_f32 v22, v22, v15, v15
    v_mfma_f32_16x16x32_bf16 v[40:43], v[92:95], v[232:235], v[40:43]
    ds_read_b128 v[88:91], v2 offset:34816
    s_waitcnt lgkmcnt(5)
    v_mfma_f32_16x16x32_bf16 v[44:47], v[92:95], v[236:239], v[44:47]
    v_rcp_f32 v22, v22
    v_mfma_f32_16x16x32_bf16 v[32:35], v[96:99], v[240:243], v[32:35]
    ds_read_b128 v[92:95], v2 offset:35840
    v_mul_f32 v22, v22, v30
    v_mfma_f32_16x16x32_bf16 v[36:39], v[96:99], v[244:247], v[36:39]
    v_mul_f32 v23, v23, v5
    v_mfma_f32_16x16x32_bf16 v[40:43], v[100:103], v[240:243], v[40:43]
    ds_read_b128 v[96:99], v2 offset:36864
    s_waitcnt lgkmcnt(5)
    v_mfma_f32_16x16x32_bf16 v[44:47], v[100:103], v[244:247], v[44:47]
    v_exp_f32 v23, -v23
    v_mfma_f32_16x16x32_bf16 v[32:35], v[104:107], v[248:251], v[32:35]
    ds_read_b128 v[100:103], v2 offset:37888
    v_fma_f32 v23, v23, v15, v15
    v_mfma_f32_16x16x32_bf16 v[36:39], v[104:107], v[252:255], v[36:39]
    v_rcp_f32 v23, v23
    v_mfma_f32_16x16x32_bf16 v[40:43], v[108:111], v[248:251], v[40:43]
    ds_read_b128 v[104:107], v2 offset:38912
    s_waitcnt lgkmcnt(5)
    v_mfma_f32_16x16x32_bf16 v[44:47], v[108:111], v[252:255], v[44:47]
    v_mul_f32 v23, v23, v31
    v_mfma_f32_16x16x32_bf16 v[48:51], v[80:83], v[128:131], 0
    ds_read_b128 v[108:111], v2 offset:39936
    v_cvt_pk_bf16_f32 v115, v22, v23
    v_mfma_f32_16x16x32_bf16 v[52:55], v[80:83], v[132:135], 0
    s_add_u32 s59, s59, 0x1000
    buffer_store_dwordx4 v[112:115], v2, s[28:31], s59 offen offset:0 sc1
    v_mfma_f32_16x16x32_bf16 v[56:59], v[84:87], v[128:131], 0
    ds_read_b128 v[80:83], v2 offset:40960
    s_waitcnt lgkmcnt(5)
    v_mfma_f32_16x16x32_bf16 v[60:63], v[84:87], v[132:135], 0
    v_mfma_f32_16x16x32_bf16 v[48:51], v[88:91], v[136:139], v[48:51]
    ds_read_b128 v[84:87], v2 offset:41984
    v_mul_f32 v32, v32, v4
    v_mfma_f32_16x16x32_bf16 v[52:55], v[88:91], v[140:143], v[52:55]
    v_exp_f32 v32, -v32
    v_mfma_f32_16x16x32_bf16 v[56:59], v[92:95], v[136:139], v[56:59]
    ds_read_b128 v[88:91], v2 offset:43008
    s_waitcnt lgkmcnt(5)
    v_mfma_f32_16x16x32_bf16 v[60:63], v[92:95], v[140:143], v[60:63]
    v_fma_f32 v32, v32, v14, v14
    v_mul_f32 v33, v33, v4
    v_mfma_f32_16x16x32_bf16 v[48:51], v[96:99], v[144:147], v[48:51]
    ds_read_b128 v[92:95], v2 offset:44032
    v_mov_b32 v11, 4
    v_mfma_f32_16x16x32_bf16 v[52:55], v[96:99], v[148:151], v[52:55]
    s_waitcnt vmcnt(2)
    s_cmp_eq_u32 s98, 1
    s_cbranch_scc0 far_fa4
    buffer_store_dword v11, v9, s[28:31], s62 offen
back_fa4:
    v_mfma_f32_16x16x32_bf16 v[56:59], v[100:103], v[144:147], v[56:59]
    ds_read_b128 v[96:99], v2 offset:45056
    s_waitcnt lgkmcnt(5)
    v_mfma_f32_16x16x32_bf16 v[60:63], v[100:103], v[148:151], v[60:63]
    v_rcp_f32 v32, v32
    v_mfma_f32_16x16x32_bf16 v[48:51], v[104:107], v[152:155], v[48:51]
    ds_read_b128 v[100:103], v2 offset:46080
    v_mul_f32 v32, v32, v40
    v_mfma_f32_16x16x32_bf16 v[52:55], v[104:107], v[156:159], v[52:55]
    v_exp_f32 v33, -v33
    v_mfma_f32_16x16x32_bf16 v[56:59], v[108:111], v[152:155], v[56:59]
    ds_read_b128 v[104:107], v2 offset:47104
    s_waitcnt lgkmcnt(5)
    v_mfma_f32_16x16x32_bf16 v[60:63], v[108:111], v[156:159], v[60:63]
    v_fma_f32 v33, v33, v14, v14
    v_mul_f32 v34, v34, v4
    v_mfma_f32_16x16x32_bf16 v[48:51], v[80:83], v[160:163], v[48:51]
    ds_read_b128 v[108:111], v2 offset:48128
    v_mul_f32 v35, v35, v4
    v_mfma_f32_16x16x32_bf16 v[52:55], v[80:83], v[164:167], v[52:55]
    v_rcp_f32 v33, v33
    v_mfma_f32_16x16x32_bf16 v[56:59], v[84:87], v[160:163], v[56:59]
    ds_read_b128 v[80:83], v2 offset:49152
    s_waitcnt lgkmcnt(5)
    v_mfma_f32_16x16x32_bf16 v[60:63], v[84:87], v[164:167], v[60:63]
    v_exp_f32 v34, -v34
    v_mfma_f32_16x16x32_bf16 v[48:51], v[88:91], v[168:171], v[48:51]
    ds_read_b128 v[84:87], v2 offset:50176
    v_mul_f32 v33, v33, v41
    v_mfma_f32_16x16x32_bf16 v[52:55], v[88:91], v[172:175], v[52:55]
    v_cvt_pk_bf16_f32 v116, v32, v33
    v_fma_f32 v34, v34, v14, v14
    v_mfma_f32_16x16x32_bf16 v[56:59], v[92:95], v[168:171], v[56:59]
    ds_read_b128 v[88:91], v2 offset:51200
    s_waitcnt lgkmcnt(5)
    v_mfma_f32_16x16x32_bf16 v[60:63], v[92:95], v[172:175], v[60:63]
    v_rcp_f32 v34, v34
    v_mfma_f32_16x16x32_bf16 v[48:51], v[96:99], v[176:179], v[48:51]
    ds_read_b128 v[92:95], v2 offset:52224
    v_mul_f32 v34, v34, v42
    v_mfma_f32_16x16x32_bf16 v[52:55], v[96:99], v[180:183], v[52:55]
    v_exp_f32 v35, -v35
    v_mfma_f32_16x16x32_bf16 v[56:59], v[100:103], v[176:179], v[56:59]
    ds_read_b128 v[96:99], v2 offset:53248
    s_waitcnt lgkmcnt(5)
    v_mfma_f32_16x16x32_bf16 v[60:63], v[100:103], v[180:183], v[60:63]
    v_fma_f32 v35, v35, v14, v14
    v_mul_f32 v36, v36, v5
    v_mfma_f32_16x16x32_bf16 v[48:51], v[104:107], v[184:187], v[48:51]
    ds_read_b128 v[100:103], v2 offset:54272
    v_mul_f32 v37, v37, v5
    v_mfma_f32_16x16x32_bf16 v[52:55], v[104:107], v[188:191], v[52:55]
    v_rcp_f32 v35, v35
    v_mfma_f32_16x16x32_bf16 v[56:59], v[108:111], v[184:187], v[56:59]
    ds_read_b128 v[104:107], v2 offset:55296
    s_waitcnt lgkmcnt(5)
    v_mfma_f32_16x16x32_bf16 v[60:63], v[108:111], v[188:191], v[60:63]
    v_exp_f32 v36, -v36
    v_mfma_f32_16x16x32_bf16 v[48:51], v[80:83], v[192:195], v[48:51]
    ds_read_b128 v[108:111], v2 offset:56320
    v_mul_f32 v35, v35, v43
    v_mfma_f32_16x16x32_bf16 v[52:55], v[80:83], v[196:199], v[52:55]
    v_cvt_pk_bf16_f32 v117, v34, v35
    v_fma_f32 v36, v36, v15, v15
    v_mfma_f32_16x16x32_bf16 v[56:59], v[84:87], v[192:195], v[56:59]
    ds_read_b128 v[80:83], v2 offset:57344
    s_waitcnt lgkmcnt(5)
    v_mfma_f32_16x16x32_bf16 v[60:63], v[84:87], v[196:199], v[60:63]
    v_rcp_f32 v36, v36
    v_mfma_f32_16x16x32_bf16 v[48:51], v[88:91], v[200:203], v[48:51]
    ds_read_b128 v[84:87], v2 offset:58368
    v_mul_f32 v36, v36, v44
    v_mfma_f32_16x16x32_bf16 v[52:55], v[88:91], v[204:207], v[52:55]
    v_exp_f32 v37, -v37
    v_mfma_f32_16x16x32_bf16 v[56:59], v[92:95], v[200:203], v[56:59]
    ds_read_b128 v[88:91], v2 offset:59392
    s_waitcnt lgkmcnt(5)
    v_mfma_f32_16x16x32_bf16 v[60:63], v[92:95], v[204:207], v[60:63]
    v_fma_f32 v37, v37, v15, v15
    v_mul_f32 v38, v38, v5
    v_mfma_f32_16x16x32_bf16 v[48:51], v[96:99], v[208:211], v[48:51]
    ds_read_b128 v[92:95], v2 offset:60416
    v_mul_f32 v39, v39, v5
    v_mfma_f32_16x16x32_bf16 v[52:55], v[96:99], v[212:215], v[52:55]
    v_rcp_f32 v37, v37
    v_mfma_f32_16x16x32_bf16 v[56:59], v[100:103], v[208:211], v[56:59]
    ds_read_b128 v[96:99], v2 offset:61440
    s_waitcnt lgkmcnt(5)
    v_mfma_f32_16x16x32_bf16 v[60:63], v[100:103], v[212:215], v[60:63]
    v_exp_f32 v38, -v38
    v_mfma_f32_16x16x32_bf16 v[48:51], v[104:107], v[216:219], v[48:51]
    ds_read_b128 v[100:103], v2 offset:62464
    v_mul_f32 v37, v37, v45
    v_mfma_f32_16x16x32_bf16 v[52:55], v[104:107], v[220:223], v[52:55]
    v_cvt_pk_bf16_f32 v118, v36, v37
    v_fma_f32 v38, v38, v15, v15
    v_mfma_f32_16x16x32_bf16 v[56:59], v[108:111], v[216:219], v[56:59]
    ds_read_b128 v[104:107], v2 offset:63488
    s_waitcnt lgkmcnt(5)
    v_mfma_f32_16x16x32_bf16 v[60:63], v[108:111], v[220:223], v[60:63]
    v_rcp_f32 v38, v38
    v_mfma_f32_16x16x32_bf16 v[48:51], v[80:83], v[224:227], v[48:51]
    ds_read_b128 v[108:111], v2 offset:64512
    v_mul_f32 v38, v38, v46
    v_mfma_f32_16x16x32_bf16 v[52:55], v[80:83], v[228:231], v[52:55]
    v_exp_f32 v39, -v39
    v_mfma_f32_16x16x32_bf16 v[56:59], v[84:87], v[224:227], v[56:59]
    s_waitcnt lgkmcnt(4)
    v_mfma_f32_16x16x32_bf16 v[60:63], v[84:87], v[228:231], v[60:63]
    v_fma_f32 v39, v39, v15, v15
    v_mfma_f32_16x16x32_bf16 v[48:51], v[88:91], v[232:235], v[48:51]
    v_mfma_f32_16x16x32_bf16 v[52:55], v[88:91], v[236:239], v[52:55]
    v_rcp_f32 v39, v39
    v_mfma_f32_16x16x32_bf16 v[56:59], v[92:95], v[232:235], v[56:59]
    s_waitcnt lgkmcnt(2)
    v_mfma_f32_16x16x32_bf16 v[60:63], v[92:95], v[236:239], v[60:63]
    v_mul_f32 v39, v39, v47
    v_mfma_f32_16x16x32_bf16 v[48:51], v[96:99], v[240:243], v[48:51]
    v_cvt_pk_bf16_f32 v119, v38, v39
    v_mfma_f32_16x16x32_bf16 v[52:55], v[96:99], v[244:247], v[52:55]
    buffer_store_dwordx4 v[116:119], v2, s[28:31], s59 offen offset:2048 sc1
    v_mfma_f32_16x16x32_bf16 v[56:59], v[100:103], v[240:243], v[56:59]
    s_waitcnt lgkmcnt(0)
    v_mfma_f32_16x16x32_bf16 v[60:63], v[100:103], v[244:247], v[60:63]
    v_mfma_f32_16x16x32_bf16 v[48:51], v[104:107], v[248:251], v[48:51]
    v_mov_b32 v12, 5
    v_mfma_f32_16x16x32_bf16 v[52:55], v[104:107], v[252:255], v[52:55]
    s_waitcnt vmcnt(2)
    s_cmp_eq_u32 s98, 1
    s_cbranch_scc0 far_fa5
    buffer_store_dword v12, v9, s[28:31], s62 offen
back_fa5:
    v_mfma_f32_16x16x32_bf16 v[56:59], v[108:111], v[248:251], v[56:59]
    v_mfma_f32_16x16x32_bf16 v[60:63], v[108:111], v[252:255], v[60:63]
    s_setprio 0
    s_nop 4
    v_mul_f32 v48, v48, v4
    v_mul_f32 v49, v49, v4
    v_mul_f32 v50, v50, v4
    v_mul_f32 v51, v51, v4
    v_mul_f32 v52, v52, v5
    v_mul_f32 v53, v53, v5
    v_mul_f32 v54, v54, v5
    v_mul_f32 v55, v55, v5
    v_exp_f32 v48, -v48
    v_exp_f32 v49, -v49
    v_exp_f32 v50, -v50
    v_exp_f32 v51, -v51
    v_exp_f32 v52, -v52
    v_exp_f32 v53, -v53
    v_exp_f32 v54, -v54
    v_exp_f32 v55, -v55
    v_fma_f32 v48, v48, v14, v14
    v_fma_f32 v49, v49, v14, v14
    v_fma_f32 v50, v50, v14, v14
    v_fma_f32 v51, v51, v14, v14
    v_fma_f32 v52, v52, v15, v15
    v_fma_f32 v53, v53, v15, v15
    v_fma_f32 v54, v54, v15, v15
    v_fma_f32 v55, v55, v15, v15
    v_rcp_f32 v48, v48
    v_rcp_f32 v49, v49
    v_rcp_f32 v50, v50
    v_rcp_f32 v51, v51
    v_rcp_f32 v52, v52
    v_rcp_f32 v53, v53
    v_rcp_f32 v54, v54
    v_rcp_f32 v55, v55
    v_mul_f32 v48, v48, v56
    v_mul_f32 v49, v49, v57
    v_mul_f32 v50, v50, v58
    v_mul_f32 v51, v51, v59
    v_mul_f32 v52, v52, v60
    v_mul_f32 v53, v53, v61
    v_mul_f32 v54, v54, v62
    v_mul_f32 v55, v55, v63
    v_cvt_pk_bf16_f32 v112, v48, v49
    v_cvt_pk_bf16_f32 v113, v50, v51
    v_cvt_pk_bf16_f32 v114, v52, v53
    v_cvt_pk_bf16_f32 v115, v54, v55
    s_add_u32 s59, s59, 0x1000
    buffer_store_dwordx4 v[112:115], v2, s[28:31], s59 offen offset:0 sc1
    v_mov_b32 v11, 6
    s_waitcnt vmcnt(2)
    s_cmp_eq_u32 s98, 1
    s_cbranch_scc0 far_fa6
    buffer_store_dword v11, v9, s[28:31], s62 offen
back_fa6:
    v_mov_b32 v12, 7
    s_waitcnt vmcnt(1)
    s_cmp_eq_u32 s98, 1
    s_cbranch_scc0 far_fa7
    buffer_store_dword v12, v9, s[28:31], s62 offen
back_fa7:
    s_add_u32 s60, s60, 0x1000
    v_lshlrev_b32 v4, 3, v2
    s_barrier
    s_mov_b64 exec, 0xffff
    buffer_store_dword v13, v4, s[28:31], s27 offen sc1
    s_mov_b64 exec, 0xff
    buffer_store_dword v13, v4, s[28:31], s60 offen sc1
    s_mov_b64 exec, -1
    s_lshl_b32 s56, s100, 5
    s_add_u32 s56, s56, s46
    buffer_store_dword v13, v9, s[28:31], s56 offen offset:2048 sc1
    s_lshr_b32 s56, s44, 15
    s_lshl_b32 s56, s56, 11
    s_and_b32 s57, s55, 3
    s_lshl_b32 s57, s57, 8
    s_add_u32 s56, s56, s57
    s_lshr_b32 s57, s53, 1
    s_mul_i32 s57, s57, 768
    s_add_u32 s56, s56, s57
    s_lshl_b32 s57, s53, 7
    s_add_u32 s56, s56, s57
    s_add_u32 s56, s56, 11796480
    buffer_store_dword v13, v9, s[28:31], s56 offen sc1
    buffer_store_dword v12, v9, s[28:31], s62 offen sc1
    s_cmp_eq_u32 s100, 0
    s_cselect_b32 s56, s47, 0x40000000
    s_add_u32 s57, s56, 16384
    buffer_store_dword v13, v9, s[28:31], s56 offen sc1
    buffer_store_dword v13, v9, s[28:31], s56 offen offset:128 sc1
    buffer_store_dword v13, v9, s[28:31], s57 offen offset:128 sc1
    s_barrier
    s_endpgm
lr_kv0:
    s_sub_u32 s61, s61, 1
    s_cbranch_scc1 ld_kv0
    s_sleep 1
    ds_read_b32 v123, v122
    s_branch lw_kv0
lr_kv1:
    s_sub_u32 s61, s61, 1
    s_cbranch_scc1 ld_kv1
    s_sleep 1
    ds_read_b32 v123, v122
    s_branch lw_kv1
lr_kv2:
    s_sub_u32 s61, s61, 1
    s_cbranch_scc1 ld_kv2
    s_sleep 1
    ds_read_b32 v123, v122
    s_branch lw_kv2
xr_a:
    s_sub_u32 s61, s61, 1
    s_cbranch_scc1 xd_a
    ds_read_b32 v114, v121
    ds_read_b32 v112, v31
    ds_read_b128 v[104:107], v29
    ds_read_b128 v[108:111], v29 offset:1024
    s_branch xw_a
lr_wd:
    s_sub_u32 s61, s61, 1
    s_cbranch_scc1 ld_wd
    s_sleep 2
    ds_read_b32 v111, v110
    s_branch lw_wd
far_fa:
    buffer_store_dword v17, v26, s[28:31], s47 offen sc1
    s_branch back_fa
again_o0:
    s_sub_u32 s61, s61, 1
    s_cbranch_scc1 done_o0
    s_sleep 1
    buffer_load_dword v4, v5, s[28:31], s57 offen sc1
    s_waitcnt vmcnt(0)
    s_branch poll_o0
lr_s0:
    s_sub_u32 s61, s61, 1
    s_cbranch_scc1 ld_s0
    s_sleep 6
    ds_read_b32 v111, v110
    s_branch lw_s0
lr_s1:
    s_sub_u32 s61, s61, 1
    s_cbranch_scc1 ld_s1
    s_sleep 6
    ds_read_b32 v111, v110
    s_branch lw_s1
lr_o:
    s_sub_u32 s61, s61, 1
    s_cbranch_scc1 ld_o
    s_sleep 2
    ds_read_b32 v111, v110
    s_branch lw_o
lr_s2:
    s_sub_u32 s61, s61, 1
    s_cbranch_scc1 ld_s2
    s_sleep 6
    ds_read_b32 v111, v110
    s_branch lw_s2
far_hn:
    buffer_store_dwordx4 v[96:99], v106, s[28:31], s27 offen sc1
    v_cvt_pk_bf16_f32 v100, v120, v121
    v_cvt_pk_bf16_f32 v101, v122, v123
    v_cvt_pk_bf16_f32 v102, v124, v125
    v_cvt_pk_bf16_f32 v103, v126, v127
    buffer_store_dwordx4 v[100:103], v106, s[28:31], s27 offen offset:256 sc1
    v_pk_mul_f32 v[90:91], v[112:113], v[112:113]
    v_pk_fma_f32 v[90:91], v[114:115], v[114:115], v[90:91]
    v_pk_fma_f32 v[90:91], v[116:117], v[116:117], v[90:91]
    v_pk_fma_f32 v[90:91], v[118:119], v[118:119], v[90:91]
    v_pk_fma_f32 v[90:91], v[120:121], v[120:121], v[90:91]
    v_pk_fma_f32 v[90:91], v[122:123], v[122:123], v[90:91]
    v_pk_fma_f32 v[90:91], v[124:125], v[124:125], v[90:91]
    v_pk_fma_f32 v[90:91], v[126:127], v[126:127], v[90:91]
    v_add_f32 v92, v90, v91
    v_add_f32 v90, v90, v91
    buffer_store_dword v88, v15, s[28:31], s58 offen sc1
    s_nop 0
    v_permlane32_swap_b32 v90, v92
    v_add_f32 v90, v90, v92
    buffer_store_dword v90, v14, s[28:31], s26 offen sc1
    s_branch back_hn
far_fh:
    buffer_store_dword v13, v9, s[28:31], s47 offen sc1
    s_branch back_fh
far_fa2:
    buffer_store_dword v11, v9, s[28:31], s62 offen sc1
    s_branch back_fa2
far_fa3:
    buffer_store_dword v12, v9, s[28:31], s62 offen sc1
    s_branch back_fa3
far_fa4:
    buffer_store_dword v11, v9, s[28:31], s62 offen sc1
    s_branch back_fa4
far_fa5:
    buffer_store_dword v12, v9, s[28:31], s62 offen sc1
    s_branch back_fa5
far_fa6:
    buffer_store_dword v11, v9, s[28:31], s62 offen sc1
    s_branch back_fa6
far_fa7:
    buffer_store_dword v12, v9, s[28:31], s62 offen sc1
    s_branch back_fa7
slow_a:
    v_mov_b32 v72, 0xff800000
    s_and_b32 s57, s53, 1
    s_mul_i32 s57, s57, 2112
    s_sub_u32 s56, 2097152, s57
    s_add_u32 s57, s56, 135168
slow1_a:
    buffer_load_dwordx4 v[12:15], v20, s[28:31], s56 offen
    s_waitcnt vmcnt(0)
    v_mfma_f32_32x32x16_bf16 v[56:71], v[12:15], v[4:7], 0
    s_add_u32 s56, s56, 2112
    s_nop 11
    v_max3_f32 v72, v72, v56, v57
    v_max3_f32 v72, v72, v58, v59
    v_max3_f32 v72, v72, v60, v61
    v_max3_f32 v72, v72, v62, v63
    v_max3_f32 v72, v72, v64, v65
    v_max3_f32 v72, v72, v66, v67
    v_max3_f32 v72, v72, v68, v69
    v_max3_f32 v72, v72, v70, v71
    s_cmp_lg_u32 s56, s57
    s_cbranch_scc1 slow1_a
    v_mov_b32 v73, v72
    s_nop 1
    v_permlane32_swap_b32 v72, v73
    v_max_f32 v72, v72, v73
    v_sub_f32 v72, 0, v72
    v_mov_b32 v73, v72
    v_mov_b32 v74, v72
    v_mov_b32 v75, v72
    v_mov_b32 v76, v72
    v_mov_b32 v77, v72
    v_mov_b32 v78, v72
    v_mov_b32 v79, v72
    v_mov_b32 v80, v72
    v_mov_b32 v81, v72
    v_mov_b32 v82, v72
    v_mov_b32 v83, v72
    v_mov_b32 v84, v72
    v_mov_b32 v85, v72
    v_mov_b32 v86, v72
    v_mov_b32 v87, v72
    v_mov_b32 v88, 0
    v_mov_b32 v89, 0
    v_mov_b32 v90, 0
    v_mov_b32 v91, 0
    v_mov_b32 v92, 0
    v_mov_b32 v93, 0
    v_mov_b32 v94, 0
    v_mov_b32 v95, 0
    v_mov_b32 v96, 0
    v_mov_b32 v97, 0
    v_mov_b32 v98, 0
    v_mov_b32 v99, 0
    v_mov_b32 v100, 0
    v_mov_b32 v101, 0
    v_mov_b32 v102, 0
    v_mov_b32 v103, 0
    s_sub_u32 s56, s57, 135168
slow2_a:
    buffer_load_dwordx4 v[12:15], v20, s[28:31], s56 offen
    buffer_load_dwordx4 v[40:43], v23, s[28:31], s56 offen
    buffer_load_dwordx4 v[44:47], v23, s[28:31], s56 offen offset:544
    s_waitcnt vmcnt(0)
    v_mfma_f32_32x32x16_bf16 v[56:71], v[12:15], v[4:7], v[72:87]
    s_add_u32 s56, s56, 2112
    s_nop 11
    v_exp_f32 v56, v56
    v_exp_f32 v57, v57
    v_exp_f32 v58, v58
    v_exp_f32 v59, v59
    v_exp_f32 v60, v60
    v_exp_f32 v61, v61
    v_exp_f32 v62, v62
    v_exp_f32 v63, v63
    v_exp_f32 v64, v64
    v_exp_f32 v65, v65
    v_exp_f32 v66, v66
    v_exp_f32 v67, v67
    v_exp_f32 v68, v68
    v_exp_f32 v69, v69
    v_exp_f32 v70, v70
    v_exp_f32 v71, v71
    s_nop 1
    v_smfmac_f32_32x32x32_bf16 v[88:103], v[40:43], v[56:63], v27
    v_smfmac_f32_32x32x32_bf16 v[88:103], v[44:47], v[64:71], v27
    s_nop 15
    s_cmp_lg_u32 s56, s57
    s_cbranch_scc1 slow2_a
    v_rcp_f32 v98, v96
    s_branch norm_a
kb_battn:
    ds_read_b128 v[12:15], v20 offset:0
    ds_read_b128 v[40:43], v23 offset:0
    ds_read_b128 v[44:47], v23 offset:544
    ds_read_b128 v[16:19], v20 offset:4224
    ds_read_b128 v[48:51], v23 offset:4224
    ds_read_b128 v[52:55], v23 offset:4768
    s_waitcnt lgkmcnt(5)
    v_mfma_f32_32x32x16_bf16 v[56:71], v[12:15], v[8:11], 0
    s_nop 11
    s_setprio 3
    v_exp_f32 v56, v56
    v_exp_f32 v57, v57
    s_waitcnt lgkmcnt(2)
    v_exp_f32 v58, v58
    v_exp_f32 v59, v59
    v_exp_f32 v60, v60
    v_mfma_f32_32x32x16_bf16 v[72:87], v[12:15], v[4:7], 0
    ds_read_b128 v[12:15], v20 offset:8448
    v_exp_f32 v61, v61
    v_exp_f32 v62, v62
    v_exp_f32 v63, v63
    v_exp_f32 v64, v64
    v_exp_f32 v65, v65
    v_smfmac_f32_32x32x32_bf16 v[104:119], v[40:43], v[56:63], v27
    v_exp_f32 v66, v66
    v_exp_f32 v67, v67
    v_exp_f32 v68, v68
    v_exp_f32 v69, v69
    v_exp_f32 v70, v70
    v_exp_f32 v71, v71
    v_exp_f32 v72, v72
    v_exp_f32 v73, v73
    v_smfmac_f32_32x32x32_bf16 v[104:119], v[44:47], v[64:71], v27
    v_exp_f32 v74, v74
    v_exp_f32 v75, v75
    v_exp_f32 v76, v76
    v_mfma_f32_32x32x16_bf16 v[56:71], v[16:19], v[8:11], 0
    v_exp_f32 v77, v77
    v_exp_f32 v78, v78
    v_exp_f32 v79, v79
    v_exp_f32 v80, v80
    v_exp_f32 v81, v81
    v_smfmac_f32_32x32x32_bf16 v[88:103], v[40:43], v[72:79], v27
    ds_read_b128 v[40:43], v23 offset:8448
    v_exp_f32 v82, v82
    v_exp_f32 v83, v83
    v_exp_f32 v84, v84
    v_exp_f32 v85, v85
    v_exp_f32 v86, v86
    v_exp_f32 v87, v87
    v_exp_f32 v56, v56
    v_exp_f32 v57, v57
    s_waitcnt lgkmcnt(1)
    v_smfmac_f32_32x32x32_bf16 v[88:103], v[44:47], v[80:87], v27
    ds_read_b128 v[44:47], v23 offset:8992
    v_exp_f32 v58, v58
    v_exp_f32 v59, v59
    v_exp_f32 v60, v60
    v_mfma_f32_32x32x16_bf16 v[72:87], v[16:19], v[4:7], 0
    ds_read_b128 v[16:19], v20 offset:12672
pad_4:
    s_cbranch_execz kb_warm
    v_exp_f32 v61, v61
    v_exp_f32 v62, v62
    v_exp_f32 v63, v63
    v_exp_f32 v64, v64
    v_exp_f32 v65, v65
    v_smfmac_f32_32x32x32_bf16 v[104:119], v[48:51], v[56:63], v27
    v_exp_f32 v66, v66
    v_exp_f32 v67, v67
    v_exp_f32 v68, v68
    v_exp_f32 v69, v69
    v_exp_f32 v70, v70
    v_exp_f32 v71, v71
    v_exp_f32 v72, v72
    v_exp_f32 v73, v73
    v_smfmac_f32_32x32x32_bf16 v[104:119], v[52:55], v[64:71], v27
    v_exp_f32 v74, v74
    v_exp_f32 v75, v75
    v_exp_f32 v76, v76
    v_mfma_f32_32x32x16_bf16 v[56:71], v[12:15], v[8:11], 0
    v_exp_f32 v77, v77
    v_exp_f32 v78, v78
    v_exp_f32 v79, v79
    v_exp_f32 v80, v80
    v_exp_f32 v81, v81
    v_smfmac_f32_32x32x32_bf16 v[88:103], v[48:51], v[72:79], v27
    ds_read_b128 v[48:51], v23 offset:12672
    v_exp_f32 v82, v82
    v_exp_f32 v83, v83
    v_exp_f32 v84, v84
    v_exp_f32 v85, v85
    v_exp_f32 v86, v86
    v_exp_f32 v87, v87
    s_setprio 3
    s_lshl_b32 s58, s54, 7
    s_add_u32 s58, s58, 2365440
    v_and_b32 v127, 15, v1
    v_lshlrev_b32 v127, 2, v127
    buffer_load_dword v126, v127, s[28:31], s58 offen sc1
    s_waitcnt vmcnt(0)
    s_mov_b32 s61, 32768
poll_rlb:
    v_cmp_le_u32 vcc, 1, v126
    s_cmp_eq_u64 vcc, -1
    s_cbranch_scc0 again_rlb
done_rlb:
    s_add_u32 s58, s58, 43008
    buffer_load_dword v126, v127, s[28:31], s58 offen sc1
    s_add_u32 s56, s59, 0
    buffer_load_dwordx4 v[128:131], v2, s[28:31], s56 offen offset:0 sc1
    buffer_load_dwordx4 v[132:135], v2, s[28:31], s56 offen offset:1024 sc1
    s_add_u32 s56, s101, 0
    buffer_load_dwordx4 v[136:139], v2, s[28:31], s56 offen offset:0 sc1
    buffer_load_dwordx4 v[140:143], v2, s[28:31], s56 offen offset:1024 sc1
    s_add_u32 s56, s59, 14336
    buffer_load_dwordx4 v[144:147], v2, s[28:31], s56 offen offset:0 sc1
    buffer_load_dwordx4 v[148:151], v2, s[28:31], s56 offen offset:1024 sc1
    s_add_u32 s56, s101, 14336
    buffer_load_dwordx4 v[152:155], v2, s[28:31], s56 offen offset:0 sc1
    buffer_load_dwordx4 v[156:159], v2, s[28:31], s56 offen offset:1024 sc1
    s_add_u32 s56, s59, 2048
    buffer_load_dwordx4 v[160:163], v2, s[28:31], s56 offen offset:0 sc1
    buffer_load_dwordx4 v[164:167], v2, s[28:31], s56 offen offset:1024 sc1
    s_add_u32 s56, s101, 2048
    buffer_load_dwordx4 v[168:171], v2, s[28:31], s56 offen offset:0 sc1
    buffer_load_dwordx4 v[172:175], v2, s[28:31], s56 offen offset:1024 sc1
    s_add_u32 s56, s59, 16384
    buffer_load_dwordx4 v[176:179], v2, s[28:31], s56 offen offset:0 sc1
    buffer_load_dwordx4 v[180:183], v2, s[28:31], s56 offen offset:1024 sc1
    s_add_u32 s56, s101, 16384
    buffer_load_dwordx4 v[184:187], v2, s[28:31], s56 offen offset:0 sc1
    buffer_load_dwordx4 v[188:191], v2, s[28:31], s56 offen offset:1024 sc1
    s_add_u32 s56, s59, 4096
    buffer_load_dwordx4 v[192:195], v2, s[28:31], s56 offen offset:0 sc1
    buffer_load_dwordx4 v[196:199], v2, s[28:31], s56 offen offset:1024 sc1
    s_add_u32 s56, s101, 4096
    buffer_load_dwordx4 v[200:203], v2, s[28:31], s56 offen offset:0 sc1
    buffer_load_dwordx4 v[204:207], v2, s[28:31], s56 offen offset:1024 sc1
    s_add_u32 s56, s59, 18432
    buffer_load_dwordx4 v[208:211], v2, s[28:31], s56 offen offset:0 sc1
    buffer_load_dwordx4 v[212:215], v2, s[28:31], s56 offen offset:1024 sc1
    s_add_u32 s56, s101, 18432
    buffer_load_dwordx4 v[216:219], v2, s[28:31], s56 offen offset:0 sc1
    buffer_load_dwordx4 v[220:223], v2, s[28:31], s56 offen offset:1024 sc1
    s_add_u32 s56, s59, 6144
    buffer_load_dwordx4 v[224:227], v2, s[28:31], s56 offen offset:0 sc1
    buffer_load_dwordx4 v[228:231], v2, s[28:31], s56 offen offset:1024 sc1
    s_add_u32 s56, s101, 6144
    buffer_load_dwordx4 v[232:235], v2, s[28:31], s56 offen offset:0 sc1
    buffer_load_dwordx4 v[236:239], v2, s[28:31], s56 offen offset:1024 sc1
    s_add_u32 s56, s59, 20480
    buffer_load_dwordx4 v[240:243], v2, s[28:31], s56 offen offset:0 sc1
    buffer_load_dwordx4 v[244:247], v2, s[28:31], s56 offen offset:1024 sc1
    s_add_u32 s56, s101, 20480
    buffer_load_dwordx4 v[248:251], v2, s[28:31], s56 offen offset:0 sc1
    buffer_load_dwordx4 v[252:255], v2, s[28:31], s56 offen offset:1024 sc1
    s_mul_i32 s63, s55, 229376
    s_lshl_b32 s58, s53, 13
    s_add_u32 s63, s63, s58
    s_add_u32 s63, s63, 5242880
    s_and_b32 s57, s54, 1
    s_lshl_b32 s57, s57, 12
    s_add_u32 s57, s57, s63
    v_lshlrev_b32 v123, 7, v1
    s_mov_b32 exec_hi, 0
    s_add_u32 s56, s57, 0
    buffer_load_dword v125, v123, s[28:31], s56 offen sc1
    s_mov_b32 exec_hi, -1
    s_getreg_b32 s56, hwreg(HW_REG_XCC_ID, 0, 4)
    s_add_u32 s56, s56, 1
    s_waitcnt vmcnt(32)
    v_cmp_eq_u32 vcc, s56, v126
    s_cmp_eq_u64 vcc, -1
    s_cselect_b32 s98, 1, 0
    s_add_u32 s57, s98, 1
    s_lshl_b32 s56, s53, 2
    s_add_u32 s56, s56, 159792
    v_mov_b32 v122, s56
    v_mov_b32 v123, s57
    ds_write_b32 v122, v123
    s_setprio 1
    v_exp_f32 v56, v56
    v_exp_f32 v57, v57
    s_waitcnt lgkmcnt(1)
    v_smfmac_f32_32x32x32_bf16 v[88:103], v[52:55], v[80:87], v27
    ds_read_b128 v[52:55], v23 offset:13216
    v_exp_f32 v58, v58
    v_exp_f32 v59, v59
    v_exp_f32 v60, v60
    v_mfma_f32_32x32x16_bf16 v[72:87], v[12:15], v[4:7], 0
    ds_read_b128 v[12:15], v20 offset:16896
    v_exp_f32 v61, v61
    v_exp_f32 v62, v62
    v_exp_f32 v63, v63
    v_exp_f32 v64, v64
    v_exp_f32 v65, v65
    v_smfmac_f32_32x32x32_bf16 v[104:119], v[40:43], v[56:63], v27
    v_exp_f32 v66, v66
    v_exp_f32 v67, v67
    v_exp_f32 v68, v68
    v_exp_f32 v69, v69
    v_exp_f32 v70, v70
    v_exp_f32 v71, v71
    v_exp_f32 v72, v72
    v_exp_f32 v73, v73
    v_smfmac_f32_32x32x32_bf16 v[104:119], v[44:47], v[64:71], v27
    v_exp_f32 v74, v74
    v_exp_f32 v75, v75
    v_exp_f32 v76, v76
    v_mfma_f32_32x32x16_bf16 v[56:71], v[16:19], v[8:11], 0
    v_exp_f32 v77, v77
    v_exp_f32 v78, v78
    v_exp_f32 v79, v79
    v_exp_f32 v80, v80
    v_exp_f32 v81, v81
    v_smfmac_f32_32x32x32_bf16 v[88:103], v[40:43], v[72:79], v27
    ds_read_b128 v[40:43], v23 offset:16896
    v_exp_f32 v82, v82
    v_exp_f32 v83, v83
    v_exp_f32 v84, v84
    v_exp_f32 v85, v85
    v_exp_f32 v86, v86
    v_exp_f32 v87, v87
    v_exp_f32 v56, v56
    v_exp_f32 v57, v57
    s_waitcnt lgkmcnt(1)
    v_smfmac_f32_32x32x32_bf16 v[88:103], v[44:47], v[80:87], v27
    ds_read_b128 v[44:47], v23 offset:17440
    v_exp_f32 v58, v58
    v_exp_f32 v59, v59
    v_exp_f32 v60, v60
    v_mfma_f32_32x32x16_bf16 v[72:87], v[16:19], v[4:7], 0
    ds_read_b128 v[16:19], v20 offset:21120
    v_exp_f32 v61, v61
    v_exp_f32 v62, v62
    v_exp_f32 v63, v63
    v_exp_f32 v64, v64
    v_exp_f32 v65, v65
    v_smfmac_f32_32x32x32_bf16 v[104:119], v[48:51], v[56:63], v27
    v_exp_f32 v66, v66
    v_exp_f32 v67, v67
    v_exp_f32 v68, v68
    v_exp_f32 v69, v69
    v_exp_f32 v70, v70
    v_exp_f32 v71, v71
    v_exp_f32 v72, v72
    v_exp_f32 v73, v73
    v_smfmac_f32_32x32x32_bf16 v[104:119], v[52:55], v[64:71], v27
    v_exp_f32 v74, v74
    v_exp_f32 v75, v75
    v_exp_f32 v76, v76
    v_mfma_f32_32x32x16_bf16 v[56:71], v[12:15], v[8:11], 0
    v_exp_f32 v77, v77
    v_exp_f32 v78, v78
    v_exp_f32 v79, v79
    v_exp_f32 v80, v80
    v_exp_f32 v81, v81
    v_smfmac_f32_32x32x32_bf16 v[88:103], v[48:51], v[72:79], v27
    ds_read_b128 v[48:51], v23 offset:21120
    v_exp_f32 v82, v82
    v_exp_f32 v83, v83
    v_exp_f32 v84, v84
    v_exp_f32 v85, v85
    v_exp_f32 v86, v86
    v_exp_f32 v87, v87
    v_exp_f32 v56, v56
    v_exp_f32 v57, v57
    s_waitcnt lgkmcnt(1)
    v_smfmac_f32_32x32x32_bf16 v[88:103], v[52:55], v[80:87], v27
    ds_read_b128 v[52:55], v23 offset:21664
    v_exp_f32 v58, v58
    v_exp_f32 v59, v59
    v_exp_f32 v60, v60
    v_mfma_f32_32x32x16_bf16 v[72:87], v[12:15], v[4:7], 0
    ds_read_b128 v[12:15], v20 offset:25344
    v_exp_f32 v61, v61
    v_exp_f32 v62, v62
    v_exp_f32 v63, v63
    v_exp_f32 v64, v64
    v_exp_f32 v65, v65
    v_smfmac_f32_32x32x32_bf16 v[104:119], v[40:43], v[56:63], v27
    v_exp_f32 v66, v66
    v_exp_f32 v67, v67
    v_exp_f32 v68, v68
    v_exp_f32 v69, v69
    v_exp_f32 v70, v70
    v_exp_f32 v71, v71
    v_exp_f32 v72, v72
    v_exp_f32 v73, v73
    v_smfmac_f32_32x32x32_bf16 v[104:119], v[44:47], v[64:71], v27
    v_exp_f32 v74, v74
    v_exp_f32 v75, v75
    v_exp_f32 v76, v76
    v_mfma_f32_32x32x16_bf16 v[56:71], v[16:19], v[8:11], 0
    v_exp_f32 v77, v77
    v_exp_f32 v78, v78
    v_exp_f32 v79, v79
    v_exp_f32 v80, v80
    v_exp_f32 v81, v81
    v_smfmac_f32_32x32x32_bf16 v[88:103], v[40:43], v[72:79], v27
    ds_read_b128 v[40:43], v23 offset:25344
    v_exp_f32 v82, v82
    v_exp_f32 v83, v83
    v_exp_f32 v84, v84
    v_exp_f32 v85, v85
    v_exp_f32 v86, v86
    v_exp_f32 v87, v87
    v_exp_f32 v56, v56
    v_exp_f32 v57, v57
    s_waitcnt lgkmcnt(1)
    v_smfmac_f32_32x32x32_bf16 v[88:103], v[44:47], v[80:87], v27
    ds_read_b128 v[44:47], v23 offset:25888
    v_exp_f32 v58, v58
    v_exp_f32 v59, v59
    v_exp_f32 v60, v60
    v_mfma_f32_32x32x16_bf16 v[72:87], v[16:19], v[4:7], 0
    ds_read_b128 v[16:19], v20 offset:29568
    v_exp_f32 v61, v61
    v_exp_f32 v62, v62
    v_exp_f32 v63, v63
    v_exp_f32 v64, v64
    v_exp_f32 v65, v65
    v_smfmac_f32_32x32x32_bf16 v[104:119], v[48:51], v[56:63], v27
    v_exp_f32 v66, v66
    v_exp_f32 v67, v67
    v_exp_f32 v68, v68
    v_exp_f32 v69, v69
    v_exp_f32 v70, v70
    v_exp_f32 v71, v71
    v_exp_f32 v72, v72
    v_exp_f32 v73, v73
    v_smfmac_f32_32x32x32_bf16 v[104:119], v[52:55], v[64:71], v27
    v_exp_f32 v74, v74
    v_exp_f32 v75, v75
    v_exp_f32 v76, v76
    v_mfma_f32_32x32x16_bf16 v[56:71], v[12:15], v[8:11], 0
    v_exp_f32 v77, v77
    v_exp_f32 v78, v78
    v_exp_f32 v79, v79
    v_exp_f32 v80, v80
    v_exp_f32 v81, v81
    v_smfmac_f32_32x32x32_bf16 v[88:103], v[48:51], v[72:79], v27
    ds_read_b128 v[48:51], v23 offset:29568
    v_exp_f32 v82, v82
    v_exp_f32 v83, v83
    v_exp_f32 v84, v84
    v_exp_f32 v85, v85
    v_exp_f32 v86, v86
    v_exp_f32 v87, v87
    v_exp_f32 v56, v56
    v_exp_f32 v57, v57
    s_waitcnt lgkmcnt(1)
    v_smfmac_f32_32x32x32_bf16 v[88:103], v[52:55], v[80:87], v27
    ds_read_b128 v[52:55], v23 offset:30112
    v_exp_f32 v58, v58
    v_exp_f32 v59, v59
    v_exp_f32 v60, v60
    v_mfma_f32_32x32x16_bf16 v[72:87], v[12:15], v[4:7], 0
    ds_read_b128 v[12:15], v20 offset:33792
    v_exp_f32 v61, v61
    v_exp_f32 v62, v62
    v_exp_f32 v63, v63
    v_exp_f32 v64, v64
    v_exp_f32 v65, v65
    v_smfmac_f32_32x32x32_bf16 v[104:119], v[40:43], v[56:63], v27
    v_exp_f32 v66, v66
    v_exp_f32 v67, v67
    v_exp_f32 v68, v68
    v_exp_f32 v69, v69
    v_exp_f32 v70, v70
    v_exp_f32 v71, v71
    v_exp_f32 v72, v72
    v_exp_f32 v73, v73
    v_smfmac_f32_32x32x32_bf16 v[104:119], v[44:47], v[64:71], v27
    v_exp_f32 v74, v74
    v_exp_f32 v75, v75
    v_exp_f32 v76, v76
    v_mfma_f32_32x32x16_bf16 v[56:71], v[16:19], v[8:11], 0
    v_exp_f32 v77, v77
    v_exp_f32 v78, v78
    v_exp_f32 v79, v79
    v_exp_f32 v80, v80
    v_exp_f32 v81, v81
    v_smfmac_f32_32x32x32_bf16 v[88:103], v[40:43], v[72:79], v27
    ds_read_b128 v[40:43], v23 offset:33792
    v_exp_f32 v82, v82
    v_exp_f32 v83, v83
    v_exp_f32 v84, v84
    v_exp_f32 v85, v85
    v_exp_f32 v86, v86
    v_exp_f32 v87, v87
    v_exp_f32 v56, v56
    v_exp_f32 v57, v57
    s_waitcnt lgkmcnt(1)
    v_smfmac_f32_32x32x32_bf16 v[88:103], v[44:47], v[80:87], v27
    ds_read_b128 v[44:47], v23 offset:34336
    v_exp_f32 v58, v58
    v_exp_f32 v59, v59
    v_exp_f32 v60, v60
    v_mfma_f32_32x32x16_bf16 v[72:87], v[16:19], v[4:7], 0
    ds_read_b128 v[16:19], v20 offset:38016
    v_exp_f32 v61, v61
    v_exp_f32 v62, v62
    v_exp_f32 v63, v63
    v_exp_f32 v64, v64
    v_exp_f32 v65, v65
    v_smfmac_f32_32x32x32_bf16 v[104:119], v[48:51], v[56:63], v27
    v_exp_f32 v66, v66
    v_exp_f32 v67, v67
    v_exp_f32 v68, v68
    v_exp_f32 v69, v69
    v_exp_f32 v70, v70
    v_exp_f32 v71, v71
    v_mov_b32 v3, 1
    ds_write_b32 v0, v3
    v_exp_f32 v72, v72
    v_exp_f32 v73, v73
    v_smfmac_f32_32x32x32_bf16 v[104:119], v[52:55], v[64:71], v27
    v_exp_f32 v74, v74
    v_exp_f32 v75, v75
    v_exp_f32 v76, v76
    v_mfma_f32_32x32x16_bf16 v[56:71], v[12:15], v[8:11], 0
    v_exp_f32 v77, v77
    v_exp_f32 v78, v78
    v_exp_f32 v79, v79
    v_exp_f32 v80, v80
    v_exp_f32 v81, v81
    v_smfmac_f32_32x32x32_bf16 v[88:103], v[48:51], v[72:79], v27
    ds_read_b128 v[48:51], v23 offset:38016
    v_exp_f32 v82, v82
    v_exp_f32 v83, v83
    v_exp_f32 v84, v84
    v_exp_f32 v85, v85
    v_exp_f32 v86, v86
    v_exp_f32 v87, v87
    v_exp_f32 v56, v56
    v_exp_f32 v57, v57
    s_waitcnt lgkmcnt(1)
    v_smfmac_f32_32x32x32_bf16 v[88:103], v[52:55], v[80:87], v27
    ds_read_b128 v[52:55], v23 offset:38560
    v_exp_f32 v58, v58
    v_exp_f32 v59, v59
    v_exp_f32 v60, v60
    v_mfma_f32_32x32x16_bf16 v[72:87], v[12:15], v[4:7], 0
    ds_read_b128 v[12:15], v20 offset:42240
    v_exp_f32 v61, v61
    v_exp_f32 v62, v62
    v_exp_f32 v63, v63
    v_exp_f32 v64, v64
    v_exp_f32 v65, v65
    v_smfmac_f32_32x32x32_bf16 v[104:119], v[40:43], v[56:63], v27
    v_exp_f32 v66, v66
    v_exp_f32 v67, v67
    v_exp_f32 v68, v68
    v_exp_f32 v69, v69
    v_exp_f32 v70, v70
    v_exp_f32 v71, v71
    v_exp_f32 v72, v72
    v_exp_f32 v73, v73
    v_smfmac_f32_32x32x32_bf16 v[104:119], v[44:47], v[64:71], v27
    v_exp_f32 v74, v74
    v_exp_f32 v75, v75
    v_exp_f32 v76, v76
    v_mfma_f32_32x32x16_bf16 v[56:71], v[16:19], v[8:11], 0
    v_exp_f32 v77, v77
    v_exp_f32 v78, v78
    v_exp_f32 v79, v79
    v_exp_f32 v80, v80
    v_exp_f32 v81, v81
    v_smfmac_f32_32x32x32_bf16 v[88:103], v[40:43], v[72:79], v27
    ds_read_b128 v[40:43], v23 offset:42240
    v_exp_f32 v82, v82
    v_exp_f32 v83, v83
    v_exp_f32 v84, v84
    v_exp_f32 v85, v85
    v_exp_f32 v86, v86
    v_exp_f32 v87, v87
    v_exp_f32 v56, v56
    v_exp_f32 v57, v57
    s_waitcnt lgkmcnt(1)
    v_smfmac_f32_32x32x32_bf16 v[88:103], v[44:47], v[80:87], v27
    ds_read_b128 v[44:47], v23 offset:42784
    v_exp_f32 v58, v58
    v_exp_f32 v59, v59
    v_exp_f32 v60, v60
    v_mfma_f32_32x32x16_bf16 v[72:87], v[16:19], v[4:7], 0
    ds_read_b128 v[16:19], v20 offset:46464
    v_exp_f32 v61, v61
    v_exp_f32 v62, v62
    v_exp_f32 v63, v63
    v_exp_f32 v64, v64
    v_exp_f32 v65, v65
    v_smfmac_f32_32x32x32_bf16 v[104:119], v[48:51], v[56:63], v27
    v_exp_f32 v66, v66
    v_exp_f32 v67, v67
    v_exp_f32 v68, v68
    v_exp_f32 v69, v69
    v_exp_f32 v70, v70
    v_exp_f32 v71, v71
    v_exp_f32 v72, v72
    v_exp_f32 v73, v73
    v_smfmac_f32_32x32x32_bf16 v[104:119], v[52:55], v[64:71], v27
    v_exp_f32 v74, v74
    v_exp_f32 v75, v75
    v_exp_f32 v76, v76
    v_mfma_f32_32x32x16_bf16 v[56:71], v[12:15], v[8:11], 0
    v_exp_f32 v77, v77
    v_exp_f32 v78, v78
    v_exp_f32 v79, v79
    v_exp_f32 v80, v80
    v_exp_f32 v81, v81
    v_smfmac_f32_32x32x32_bf16 v[88:103], v[48:51], v[72:79], v27
    ds_read_b128 v[48:51], v23 offset:46464
    v_exp_f32 v82, v82
    v_exp_f32 v83, v83
    v_exp_f32 v84, v84
    v_exp_f32 v85, v85
    v_exp_f32 v86, v86
    v_exp_f32 v87, v87
    v_exp_f32 v56, v56
    v_exp_f32 v57, v57
    s_waitcnt lgkmcnt(1)
    v_smfmac_f32_32x32x32_bf16 v[88:103], v[52:55], v[80:87], v27
    ds_read_b128 v[52:55], v23 offset:47008
    v_exp_f32 v58, v58
    v_exp_f32 v59, v59
    v_exp_f32 v60, v60
    v_mfma_f32_32x32x16_bf16 v[72:87], v[12:15], v[4:7], 0
    ds_read_b128 v[12:15], v20 offset:50688
    v_exp_f32 v61, v61
    v_exp_f32 v62, v62
    v_exp_f32 v63, v63
    v_exp_f32 v64, v64
    v_exp_f32 v65, v65
    v_smfmac_f32_32x32x32_bf16 v[104:119], v[40:43], v[56:63], v27
    v_exp_f32 v66, v66
    v_exp_f32 v67, v67
    v_exp_f32 v68, v68
    v_exp_f32 v69, v69
    v_exp_f32 v70, v70
    v_exp_f32 v71, v71
    v_exp_f32 v72, v72
    v_exp_f32 v73, v73
    v_smfmac_f32_32x32x32_bf16 v[104:119], v[44:47], v[64:71], v27
    v_exp_f32 v74, v74
    v_exp_f32 v75, v75
    v_exp_f32 v76, v76
    v_mfma_f32_32x32x16_bf16 v[56:71], v[16:19], v[8:11], 0
    v_exp_f32 v77, v77
    v_exp_f32 v78, v78
    v_exp_f32 v79, v79
    v_exp_f32 v80, v80
    v_exp_f32 v81, v81
    v_smfmac_f32_32x32x32_bf16 v[88:103], v[40:43], v[72:79], v27
    ds_read_b128 v[40:43], v23 offset:50688
    v_exp_f32 v82, v82
    v_exp_f32 v83, v83
    v_exp_f32 v84, v84
    v_exp_f32 v85, v85
    v_exp_f32 v86, v86
    v_exp_f32 v87, v87
    v_exp_f32 v56, v56
    v_exp_f32 v57, v57
    s_waitcnt lgkmcnt(1)
    v_smfmac_f32_32x32x32_bf16 v[88:103], v[44:47], v[80:87], v27
    ds_read_b128 v[44:47], v23 offset:51232
    v_exp_f32 v58, v58
    v_exp_f32 v59, v59
    v_exp_f32 v60, v60
    v_mfma_f32_32x32x16_bf16 v[72:87], v[16:19], v[4:7], 0
    ds_read_b128 v[16:19], v20 offset:54912
    v_exp_f32 v61, v61
    v_exp_f32 v62, v62
    v_exp_f32 v63, v63
    v_exp_f32 v64, v64
    v_exp_f32 v65, v65
    v_smfmac_f32_32x32x32_bf16 v[104:119], v[48:51], v[56:63], v27
    v_exp_f32 v66, v66
    v_exp_f32 v67, v67
    v_exp_f32 v68, v68
    v_exp_f32 v69, v69
    v_exp_f32 v70, v70
    v_exp_f32 v71, v71
    v_exp_f32 v72, v72
    v_exp_f32 v73, v73
    v_smfmac_f32_32x32x32_bf16 v[104:119], v[52:55], v[64:71], v27
    v_exp_f32 v74, v74
    v_exp_f32 v75, v75
    v_exp_f32 v76, v76
    v_mfma_f32_32x32x16_bf16 v[56:71], v[12:15], v[8:11], 0
    v_exp_f32 v77, v77
    v_exp_f32 v78, v78
    v_exp_f32 v79, v79
    v_exp_f32 v80, v80
    v_exp_f32 v81, v81
    v_smfmac_f32_32x32x32_bf16 v[88:103], v[48:51], v[72:79], v27
    ds_read_b128 v[48:51], v23 offset:54912
    v_exp_f32 v82, v82
    v_exp_f32 v83, v83
    v_exp_f32 v84, v84
    v_exp_f32 v85, v85
    v_exp_f32 v86, v86
    v_exp_f32 v87, v87
    v_exp_f32 v56, v56
    v_exp_f32 v57, v57
    s_waitcnt lgkmcnt(1)
    v_smfmac_f32_32x32x32_bf16 v[88:103], v[52:55], v[80:87], v27
    ds_read_b128 v[52:55], v23 offset:55456
    v_exp_f32 v58, v58
    v_exp_f32 v59, v59
    v_exp_f32 v60, v60
    v_mfma_f32_32x32x16_bf16 v[72:87], v[12:15], v[4:7], 0
    ds_read_b128 v[12:15], v20 offset:59136
    v_exp_f32 v61, v61
    v_exp_f32 v62, v62
    v_exp_f32 v63, v63
    v_exp_f32 v64, v64
    v_exp_f32 v65, v65
    v_smfmac_f32_32x32x32_bf16 v[104:119], v[40:43], v[56:63], v27
    v_exp_f32 v66, v66
    v_exp_f32 v67, v67
    v_exp_f32 v68, v68
    v_exp_f32 v69, v69
    v_exp_f32 v70, v70
    v_exp_f32 v71, v71
    v_exp_f32 v72, v72
    v_exp_f32 v73, v73
    v_smfmac_f32_32x32x32_bf16 v[104:119], v[44:47], v[64:71], v27
    v_exp_f32 v74, v74
    v_exp_f32 v75, v75
    v_exp_f32 v76, v76
    v_mfma_f32_32x32x16_bf16 v[56:71], v[16:19], v[8:11], 0
    v_exp_f32 v77, v77
    v_exp_f32 v78, v78
    v_exp_f32 v79, v79
    v_exp_f32 v80, v80
    v_exp_f32 v81, v81
    v_smfmac_f32_32x32x32_bf16 v[88:103], v[40:43], v[72:79], v27
    ds_read_b128 v[40:43], v23 offset:59136
    v_exp_f32 v82, v82
    v_exp_f32 v83, v83
    v_exp_f32 v84, v84
    v_exp_f32 v85, v85
    v_exp_f32 v86, v86
    v_exp_f32 v87, v87
    v_exp_f32 v56, v56
    v_exp_f32 v57, v57
    s_waitcnt lgkmcnt(1)
    v_smfmac_f32_32x32x32_bf16 v[88:103], v[44:47], v[80:87], v27
    ds_read_b128 v[44:47], v23 offset:59680
    v_exp_f32 v58, v58
    v_exp_f32 v59, v59
    v_exp_f32 v60, v60
    v_mfma_f32_32x32x16_bf16 v[72:87], v[16:19], v[4:7], 0
    ds_read_b128 v[16:19], v21 offset:0
    v_exp_f32 v61, v61
    v_exp_f32 v62, v62
    v_exp_f32 v63, v63
    v_exp_f32 v64, v64
    v_exp_f32 v65, v65
    v_smfmac_f32_32x32x32_bf16 v[104:119], v[48:51], v[56:63], v27
    v_exp_f32 v66, v66
    v_exp_f32 v67, v67
    v_exp_f32 v68, v68
    v_exp_f32 v69, v69
    v_exp_f32 v70, v70
    v_exp_f32 v71, v71
    v_exp_f32 v72, v72
    v_exp_f32 v73, v73
    v_smfmac_f32_32x32x32_bf16 v[104:119], v[52:55], v[64:71], v27
    v_exp_f32 v74, v74
    v_exp_f32 v75, v75
    v_exp_f32 v76, v76
    v_mfma_f32_32x32x16_bf16 v[56:71], v[12:15], v[8:11], 0
    v_exp_f32 v77, v77
    v_exp_f32 v78, v78
    v_exp_f32 v79, v79
    v_exp_f32 v80, v80
    v_exp_f32 v81, v81
    v_smfmac_f32_32x32x32_bf16 v[88:103], v[48:51], v[72:79], v27
    ds_read_b128 v[48:51], v24 offset:0
    v_exp_f32 v82, v82
    v_exp_f32 v83, v83
    v_exp_f32 v84, v84
    v_exp_f32 v85, v85
    v_exp_f32 v86, v86
    v_exp_f32 v87, v87
    v_exp_f32 v56, v56
    v_exp_f32 v57, v57
    s_waitcnt lgkmcnt(1)
    v_smfmac_f32_32x32x32_bf16 v[88:103], v[52:55], v[80:87], v27
    ds_read_b128 v[52:55], v24 offset:544
    v_exp_f32 v58, v58
    v_exp_f32 v59, v59
    v_exp_f32 v60, v60
    v_mfma_f32_32x32x16_bf16 v[72:87], v[12:15], v[4:7], 0
    ds_read_b128 v[12:15], v21 offset:4224
    v_exp_f32 v61, v61
    v_exp_f32 v62, v62
    v_exp_f32 v63, v63
    v_exp_f32 v64, v64
    v_exp_f32 v65, v65
    v_smfmac_f32_32x32x32_bf16 v[104:119], v[40:43], v[56:63], v27
    v_exp_f32 v66, v66
    v_exp_f32 v67, v67
    v_exp_f32 v68, v68
    v_exp_f32 v69, v69
    v_exp_f32 v70, v70
    v_exp_f32 v71, v71
    v_exp_f32 v72, v72
    v_exp_f32 v73, v73
    v_smfmac_f32_32x32x32_bf16 v[104:119], v[44:47], v[64:71], v27
    v_exp_f32 v74, v74
    v_exp_f32 v75, v75
    v_exp_f32 v76, v76
    v_mfma_f32_32x32x16_bf16 v[56:71], v[16:19], v[8:11], 0
    v_exp_f32 v77, v77
    v_exp_f32 v78, v78
    v_exp_f32 v79, v79
    v_exp_f32 v80, v80
    v_exp_f32 v81, v81
    v_smfmac_f32_32x32x32_bf16 v[88:103], v[40:43], v[72:79], v27
    ds_read_b128 v[40:43], v24 offset:4224
    v_exp_f32 v82, v82
    v_exp_f32 v83, v83
    v_exp_f32 v84, v84
    v_exp_f32 v85, v85
    v_exp_f32 v86, v86
    v_exp_f32 v87, v87
    v_exp_f32 v56, v56
    v_exp_f32 v57, v57
    s_waitcnt lgkmcnt(1)
    v_smfmac_f32_32x32x32_bf16 v[88:103], v[44:47], v[80:87], v27
    ds_read_b128 v[44:47], v24 offset:4768
    v_exp_f32 v58, v58
    v_exp_f32 v59, v59
    v_exp_f32 v60, v60
    v_mfma_f32_32x32x16_bf16 v[72:87], v[16:19], v[4:7], 0
    ds_read_b128 v[16:19], v21 offset:8448
    v_exp_f32 v61, v61
    v_exp_f32 v62, v62
    v_exp_f32 v63, v63
    v_exp_f32 v64, v64
    v_exp_f32 v65, v65
    v_smfmac_f32_32x32x32_bf16 v[104:119], v[48:51], v[56:63], v27
    v_exp_f32 v66, v66
    v_exp_f32 v67, v67
    v_exp_f32 v68, v68
    v_exp_f32 v69, v69
    v_exp_f32 v70, v70
    v_exp_f32 v71, v71
    v_mov_b32 v3, 2
    ds_write_b32 v0, v3
    v_exp_f32 v72, v72
    v_exp_f32 v73, v73
    v_smfmac_f32_32x32x32_bf16 v[104:119], v[52:55], v[64:71], v27
    v_exp_f32 v74, v74
    v_exp_f32 v75, v75
    v_exp_f32 v76, v76
    v_mfma_f32_32x32x16_bf16 v[56:71], v[12:15], v[8:11], 0
    v_exp_f32 v77, v77
    v_exp_f32 v78, v78
    v_exp_f32 v79, v79
    v_exp_f32 v80, v80
    v_exp_f32 v81, v81
    v_smfmac_f32_32x32x32_bf16 v[88:103], v[48:51], v[72:79], v27
    ds_read_b128 v[48:51], v24 offset:8448
    v_exp_f32 v82, v82
    v_exp_f32 v83, v83
    v_exp_f32 v84, v84
    v_exp_f32 v85, v85
    v_exp_f32 v86, v86
    v_exp_f32 v87, v87
    v_exp_f32 v56, v56
    v_exp_f32 v57, v57
    s_waitcnt lgkmcnt(1)
    v_smfmac_f32_32x32x32_bf16 v[88:103], v[52:55], v[80:87], v27
    ds_read_b128 v[52:55], v24 offset:8992
    v_exp_f32 v58, v58
    v_exp_f32 v59, v59
    v_exp_f32 v60, v60
    v_mfma_f32_32x32x16_bf16 v[72:87], v[12:15], v[4:7], 0
    ds_read_b128 v[12:15], v21 offset:12672
    v_exp_f32 v61, v61
    v_exp_f32 v62, v62
    v_exp_f32 v63, v63
    v_exp_f32 v64, v64
    v_exp_f32 v65, v65
    v_smfmac_f32_32x32x32_bf16 v[104:119], v[40:43], v[56:63], v27
    v_exp_f32 v66, v66
    v_exp_f32 v67, v67
    v_exp_f32 v68, v68
    v_exp_f32 v69, v69
    v_exp_f32 v70, v70
    v_exp_f32 v71, v71
    v_exp_f32 v72, v72
    v_exp_f32 v73, v73
    v_smfmac_f32_32x32x32_bf16 v[104:119], v[44:47], v[64:71], v27
    v_exp_f32 v74, v74
    v_exp_f32 v75, v75
    v_exp_f32 v76, v76
    v_mfma_f32_32x32x16_bf16 v[56:71], v[16:19], v[8:11], 0
    v_exp_f32 v77, v77
    v_exp_f32 v78, v78
    v_exp_f32 v79, v79
    v_exp_f32 v80, v80
    v_exp_f32 v81, v81
    v_smfmac_f32_32x32x32_bf16 v[88:103], v[40:43], v[72:79], v27
    ds_read_b128 v[40:43], v24 offset:12672
    v_exp_f32 v82, v82
    v_exp_f32 v83, v83
    v_exp_f32 v84, v84
    v_exp_f32 v85, v85
    v_exp_f32 v86, v86
    v_exp_f32 v87, v87
    v_exp_f32 v56, v56
    v_exp_f32 v57, v57
    s_waitcnt lgkmcnt(1)
    v_smfmac_f32_32x32x32_bf16 v[88:103], v[44:47], v[80:87], v27
    ds_read_b128 v[44:47], v24 offset:13216
    v_exp_f32 v58, v58
    v_exp_f32 v59, v59
    v_exp_f32 v60, v60
    v_mfma_f32_32x32x16_bf16 v[72:87], v[16:19], v[4:7], 0
    ds_read_b128 v[16:19], v21 offset:16896
    v_exp_f32 v61, v61
    v_exp_f32 v62, v62
    v_exp_f32 v63, v63
    v_exp_f32 v64, v64
    v_exp_f32 v65, v65
    v_smfmac_f32_32x32x32_bf16 v[104:119], v[48:51], v[56:63], v27
    v_exp_f32 v66, v66
    v_exp_f32 v67, v67
    v_exp_f32 v68, v68
    v_exp_f32 v69, v69
    v_exp_f32 v70, v70
    v_exp_f32 v71, v71
    v_exp_f32 v72, v72
    v_exp_f32 v73, v73
    v_smfmac_f32_32x32x32_bf16 v[104:119], v[52:55], v[64:71], v27
    v_exp_f32 v74, v74
    v_exp_f32 v75, v75
    v_exp_f32 v76, v76
    v_mfma_f32_32x32x16_bf16 v[56:71], v[12:15], v[8:11], 0
    v_exp_f32 v77, v77
    v_exp_f32 v78, v78
    v_exp_f32 v79, v79
    v_exp_f32 v80, v80
    v_exp_f32 v81, v81
    v_smfmac_f32_32x32x32_bf16 v[88:103], v[48:51], v[72:79], v27
    ds_read_b128 v[48:51], v24 offset:16896
    v_exp_f32 v82, v82
    v_exp_f32 v83, v83
    v_exp_f32 v84, v84
    v_exp_f32 v85, v85
    v_exp_f32 v86, v86
    v_exp_f32 v87, v87
    v_exp_f32 v56, v56
    v_exp_f32 v57, v57
    s_waitcnt lgkmcnt(1)
    v_smfmac_f32_32x32x32_bf16 v[88:103], v[52:55], v[80:87], v27
    ds_read_b128 v[52:55], v24 offset:17440
    v_exp_f32 v58, v58
    v_exp_f32 v59, v59
    v_exp_f32 v60, v60
    v_mfma_f32_32x32x16_bf16 v[72:87], v[12:15], v[4:7], 0
    ds_read_b128 v[12:15], v21 offset:21120
    v_exp_f32 v61, v61
    v_exp_f32 v62, v62
    v_exp_f32 v63, v63
    v_exp_f32 v64, v64
    v_exp_f32 v65, v65
    v_smfmac_f32_32x32x32_bf16 v[104:119], v[40:43], v[56:63], v27
    v_exp_f32 v66, v66
pad_5:
    s_cbranch_execz kb_warm
    v_exp_f32 v67, v67
    v_exp_f32 v68, v68
    v_exp_f32 v69, v69
    v_exp_f32 v70, v70
    v_exp_f32 v71, v71
    v_exp_f32 v72, v72
    v_exp_f32 v73, v73
    v_smfmac_f32_32x32x32_bf16 v[104:119], v[44:47], v[64:71], v27
    v_exp_f32 v74, v74
    v_exp_f32 v75, v75
    v_exp_f32 v76, v76
    v_mfma_f32_32x32x16_bf16 v[56:71], v[16:19], v[8:11], 0
    v_exp_f32 v77, v77
    v_exp_f32 v78, v78
    v_exp_f32 v79, v79
    v_exp_f32 v80, v80
    v_exp_f32 v81, v81
    v_smfmac_f32_32x32x32_bf16 v[88:103], v[40:43], v[72:79], v27
    ds_read_b128 v[40:43], v24 offset:21120
    v_exp_f32 v82, v82
    v_exp_f32 v83, v83
    v_exp_f32 v84, v84
    v_exp_f32 v85, v85
    v_exp_f32 v86, v86
    v_exp_f32 v87, v87
    v_exp_f32 v56, v56
    v_exp_f32 v57, v57
    s_waitcnt lgkmcnt(1)
    v_smfmac_f32_32x32x32_bf16 v[88:103], v[44:47], v[80:87], v27
    ds_read_b128 v[44:47], v24 offset:21664
    v_exp_f32 v58, v58
    v_exp_f32 v59, v59
    v_exp_f32 v60, v60
    v_mfma_f32_32x32x16_bf16 v[72:87], v[16:19], v[4:7], 0
    ds_read_b128 v[16:19], v21 offset:25344
    v_exp_f32 v61, v61
    v_exp_f32 v62, v62
    v_exp_f32 v63, v63
    v_exp_f32 v64, v64
    v_exp_f32 v65, v65
    v_smfmac_f32_32x32x32_bf16 v[104:119], v[48:51], v[56:63], v27
    v_exp_f32 v66, v66
    v_exp_f32 v67, v67
    v_exp_f32 v68, v68
    v_exp_f32 v69, v69
    v_exp_f32 v70, v70
    v_exp_f32 v71, v71
    v_exp_f32 v72, v72
    v_exp_f32 v73, v73
    v_smfmac_f32_32x32x32_bf16 v[104:119], v[52:55], v[64:71], v27
    v_exp_f32 v74, v74
    v_exp_f32 v75, v75
    v_exp_f32 v76, v76
    v_mfma_f32_32x32x16_bf16 v[56:71], v[12:15], v[8:11], 0
    v_exp_f32 v77, v77
    v_exp_f32 v78, v78
    v_exp_f32 v79, v79
    v_exp_f32 v80, v80
    v_exp_f32 v81, v81
    v_smfmac_f32_32x32x32_bf16 v[88:103], v[48:51], v[72:79], v27
    ds_read_b128 v[48:51], v24 offset:25344
    v_exp_f32 v82, v82
    v_exp_f32 v83, v83
    v_exp_f32 v84, v84
    v_exp_f32 v85, v85
    v_exp_f32 v86, v86
    v_exp_f32 v87, v87
    v_exp_f32 v56, v56
    v_exp_f32 v57, v57
    s_waitcnt lgkmcnt(1)
    v_smfmac_f32_32x32x32_bf16 v[88:103], v[52:55], v[80:87], v27
    ds_read_b128 v[52:55], v24 offset:25888
    v_exp_f32 v58, v58
    v_exp_f32 v59, v59
    v_exp_f32 v60, v60
    v_mfma_f32_32x32x16_bf16 v[72:87], v[12:15], v[4:7], 0
    ds_read_b128 v[12:15], v21 offset:29568
    v_exp_f32 v61, v61
    v_exp_f32 v62, v62
    v_exp_f32 v63, v63
    v_exp_f32 v64, v64
    v_exp_f32 v65, v65
    v_smfmac_f32_32x32x32_bf16 v[104:119], v[40:43], v[56:63], v27
    v_exp_f32 v66, v66
    v_exp_f32 v67, v67
    v_exp_f32 v68, v68
    v_exp_f32 v69, v69
    v_exp_f32 v70, v70
    v_exp_f32 v71, v71
    v_exp_f32 v72, v72
    v_exp_f32 v73, v73
    v_smfmac_f32_32x32x32_bf16 v[104:119], v[44:47], v[64:71], v27
    v_exp_f32 v74, v74
    v_exp_f32 v75, v75
    v_exp_f32 v76, v76
    v_mfma_f32_32x32x16_bf16 v[56:71], v[16:19], v[8:11], 0
    v_exp_f32 v77, v77
    v_exp_f32 v78, v78
    v_exp_f32 v79, v79
    v_exp_f32 v80, v80
    v_exp_f32 v81, v81
    v_smfmac_f32_32x32x32_bf16 v[88:103], v[40:43], v[72:79], v27
    ds_read_b128 v[40:43], v24 offset:29568
    v_exp_f32 v82, v82
    v_exp_f32 v83, v83
    v_exp_f32 v84, v84
    v_exp_f32 v85, v85
    v_exp_f32 v86, v86
    v_exp_f32 v87, v87
    v_exp_f32 v56, v56
    v_exp_f32 v57, v57
    s_waitcnt lgkmcnt(1)
    v_smfmac_f32_32x32x32_bf16 v[88:103], v[44:47], v[80:87], v27
    ds_read_b128 v[44:47], v24 offset:30112
    v_exp_f32 v58, v58
    v_exp_f32 v59, v59
    v_exp_f32 v60, v60
    v_mfma_f32_32x32x16_bf16 v[72:87], v[16:19], v[4:7], 0
    ds_read_b128 v[16:19], v21 offset:33792
    v_exp_f32 v61, v61
    v_exp_f32 v62, v62
    v_exp_f32 v63, v63
    v_exp_f32 v64, v64
    v_exp_f32 v65, v65
    v_smfmac_f32_32x32x32_bf16 v[104:119], v[48:51], v[56:63], v27
    v_exp_f32 v66, v66
    v_exp_f32 v67, v67
    v_exp_f32 v68, v68
    v_exp_f32 v69, v69
    v_exp_f32 v70, v70
    v_exp_f32 v71, v71
    v_exp_f32 v72, v72
    v_exp_f32 v73, v73
    v_smfmac_f32_32x32x32_bf16 v[104:119], v[52:55], v[64:71], v27
    v_exp_f32 v74, v74
    v_exp_f32 v75, v75
    v_exp_f32 v76, v76
    v_mfma_f32_32x32x16_bf16 v[56:71], v[12:15], v[8:11], 0
    v_exp_f32 v77, v77
    v_exp_f32 v78, v78
    v_exp_f32 v79, v79
    v_exp_f32 v80, v80
    v_exp_f32 v81, v81
    v_smfmac_f32_32x32x32_bf16 v[88:103], v[48:51], v[72:79], v27
    ds_read_b128 v[48:51], v24 offset:33792
    v_exp_f32 v82, v82
    v_exp_f32 v83, v83
    v_exp_f32 v84, v84
    v_exp_f32 v85, v85
    v_exp_f32 v86, v86
    v_exp_f32 v87, v87
    v_exp_f32 v56, v56
    v_exp_f32 v57, v57
    s_waitcnt lgkmcnt(1)
    v_smfmac_f32_32x32x32_bf16 v[88:103], v[52:55], v[80:87], v27
    ds_read_b128 v[52:55], v24 offset:34336
    v_exp_f32 v58, v58
    v_exp_f32 v59, v59
    v_exp_f32 v60, v60
    v_mfma_f32_32x32x16_bf16 v[72:87], v[12:15], v[4:7], 0
    ds_read_b128 v[12:15], v21 offset:38016
    v_exp_f32 v61, v61
    v_exp_f32 v62, v62
    v_exp_f32 v63, v63
    v_exp_f32 v64, v64
    v_exp_f32 v65, v65
    v_smfmac_f32_32x32x32_bf16 v[104:119], v[40:43], v[56:63], v27
    v_exp_f32 v66, v66
    v_exp_f32 v67, v67
    v_exp_f32 v68, v68
    v_exp_f32 v69, v69
    v_exp_f32 v70, v70
    v_exp_f32 v71, v71
    v_exp_f32 v72, v72
    v_exp_f32 v73, v73
    v_smfmac_f32_32x32x32_bf16 v[104:119], v[44:47], v[64:71], v27
    v_exp_f32 v74, v74
    v_exp_f32 v75, v75
    v_exp_f32 v76, v76
    v_mfma_f32_32x32x16_bf16 v[56:71], v[16:19], v[8:11], 0
    v_exp_f32 v77, v77
    v_exp_f32 v78, v78
    v_exp_f32 v79, v79
    v_exp_f32 v80, v80
    v_exp_f32 v81, v81
    v_smfmac_f32_32x32x32_bf16 v[88:103], v[40:43], v[72:79], v27
    ds_read_b128 v[40:43], v24 offset:38016
    v_exp_f32 v82, v82
    v_exp_f32 v83, v83
    v_exp_f32 v84, v84
    v_exp_f32 v85, v85
    v_exp_f32 v86, v86
    v_exp_f32 v87, v87
    v_exp_f32 v56, v56
    v_exp_f32 v57, v57
    s_waitcnt lgkmcnt(1)
    v_smfmac_f32_32x32x32_bf16 v[88:103], v[44:47], v[80:87], v27
    ds_read_b128 v[44:47], v24 offset:38560
    v_exp_f32 v58, v58
    v_exp_f32 v59, v59
    v_exp_f32 v60, v60
    v_mfma_f32_32x32x16_bf16 v[72:87], v[16:19], v[4:7], 0
    ds_read_b128 v[16:19], v21 offset:42240
    v_exp_f32 v61, v61
    v_exp_f32 v62, v62
    v_exp_f32 v63, v63
    v_exp_f32 v64, v64
    v_exp_f32 v65, v65
    v_smfmac_f32_32x32x32_bf16 v[104:119], v[48:51], v[56:63], v27
    v_exp_f32 v66, v66
    v_exp_f32 v67, v67
    v_exp_f32 v68, v68
    v_exp_f32 v69, v69
    v_exp_f32 v70, v70
    v_exp_f32 v71, v71
    v_mov_b32 v3, 3
    ds_write_b32 v0, v3
    v_exp_f32 v72, v72
    v_exp_f32 v73, v73
    v_smfmac_f32_32x32x32_bf16 v[104:119], v[52:55], v[64:71], v27
    v_exp_f32 v74, v74
    v_exp_f32 v75, v75
    v_exp_f32 v76, v76
    v_mfma_f32_32x32x16_bf16 v[56:71], v[12:15], v[8:11], 0
    v_exp_f32 v77, v77
    v_exp_f32 v78, v78
    v_exp_f32 v79, v79
    v_exp_f32 v80, v80
    v_exp_f32 v81, v81
    v_smfmac_f32_32x32x32_bf16 v[88:103], v[48:51], v[72:79], v27
    ds_read_b128 v[48:51], v24 offset:42240
    v_exp_f32 v82, v82
    v_exp_f32 v83, v83
    v_exp_f32 v84, v84
    v_exp_f32 v85, v85
    v_exp_f32 v86, v86
    v_exp_f32 v87, v87
    v_exp_f32 v56, v56
    v_exp_f32 v57, v57
    s_waitcnt lgkmcnt(1)
    v_smfmac_f32_32x32x32_bf16 v[88:103], v[52:55], v[80:87], v27
    ds_read_b128 v[52:55], v24 offset:42784
    v_exp_f32 v58, v58
    v_exp_f32 v59, v59
    v_exp_f32 v60, v60
    v_mfma_f32_32x32x16_bf16 v[72:87], v[12:15], v[4:7], 0
    ds_read_b128 v[12:15], v21 offset:46464
    v_exp_f32 v61, v61
    v_exp_f32 v62, v62
    v_exp_f32 v63, v63
    v_exp_f32 v64, v64
    v_exp_f32 v65, v65
    v_smfmac_f32_32x32x32_bf16 v[104:119], v[40:43], v[56:63], v27
    v_exp_f32 v66, v66
    v_exp_f32 v67, v67
    v_exp_f32 v68, v68
    v_exp_f32 v69, v69
    v_exp_f32 v70, v70
    v_exp_f32 v71, v71
    v_exp_f32 v72, v72
    v_exp_f32 v73, v73
    v_smfmac_f32_32x32x32_bf16 v[104:119], v[44:47], v[64:71], v27
    v_exp_f32 v74, v74
    v_exp_f32 v75, v75
    v_exp_f32 v76, v76
    v_mfma_f32_32x32x16_bf16 v[56:71], v[16:19], v[8:11], 0
    v_exp_f32 v77, v77
    v_exp_f32 v78, v78
    v_exp_f32 v79, v79
    v_exp_f32 v80, v80
    v_exp_f32 v81, v81
    v_smfmac_f32_32x32x32_bf16 v[88:103], v[40:43], v[72:79], v27
    ds_read_b128 v[40:43], v24 offset:46464
    v_exp_f32 v82, v82
    v_exp_f32 v83, v83
    v_exp_f32 v84, v84
    v_exp_f32 v85, v85
    v_exp_f32 v86, v86
    v_exp_f32 v87, v87
    v_exp_f32 v56, v56
    v_exp_f32 v57, v57
    s_waitcnt lgkmcnt(1)
    v_smfmac_f32_32x32x32_bf16 v[88:103], v[44:47], v[80:87], v27
    ds_read_b128 v[44:47], v24 offset:47008
    v_exp_f32 v58, v58
    v_exp_f32 v59, v59
    v_exp_f32 v60, v60
    v_mfma_f32_32x32x16_bf16 v[72:87], v[16:19], v[4:7], 0
    ds_read_b128 v[16:19], v21 offset:50688
    v_exp_f32 v61, v61
    v_exp_f32 v62, v62
    v_exp_f32 v63, v63
    v_exp_f32 v64, v64
    v_exp_f32 v65, v65
    v_smfmac_f32_32x32x32_bf16 v[104:119], v[48:51], v[56:63], v27
    v_exp_f32 v66, v66
    v_exp_f32 v67, v67
    v_exp_f32 v68, v68
    v_exp_f32 v69, v69
    v_exp_f32 v70, v70
    v_exp_f32 v71, v71
    v_exp_f32 v72, v72
    v_exp_f32 v73, v73
    v_smfmac_f32_32x32x32_bf16 v[104:119], v[52:55], v[64:71], v27
    v_exp_f32 v74, v74
    v_exp_f32 v75, v75
    v_exp_f32 v76, v76
    v_mfma_f32_32x32x16_bf16 v[56:71], v[12:15], v[8:11], 0
    v_exp_f32 v77, v77
    v_exp_f32 v78, v78
    v_exp_f32 v79, v79
    v_exp_f32 v80, v80
    v_exp_f32 v81, v81
    v_smfmac_f32_32x32x32_bf16 v[88:103], v[48:51], v[72:79], v27
    ds_read_b128 v[48:51], v24 offset:50688
    v_exp_f32 v82, v82
    v_exp_f32 v83, v83
    v_exp_f32 v84, v84
    v_exp_f32 v85, v85
    v_exp_f32 v86, v86
    v_exp_f32 v87, v87
    v_exp_f32 v56, v56
    v_exp_f32 v57, v57
    s_waitcnt lgkmcnt(1)
    v_smfmac_f32_32x32x32_bf16 v[88:103], v[52:55], v[80:87], v27
    ds_read_b128 v[52:55], v24 offset:51232
    v_exp_f32 v58, v58
    v_exp_f32 v59, v59
    v_exp_f32 v60, v60
    v_mfma_f32_32x32x16_bf16 v[72:87], v[12:15], v[4:7], 0
    ds_read_b128 v[12:15], v21 offset:54912
    v_exp_f32 v61, v61
    v_exp_f32 v62, v62
    v_exp_f32 v63, v63
    v_exp_f32 v64, v64
    v_exp_f32 v65, v65
    v_smfmac_f32_32x32x32_bf16 v[104:119], v[40:43], v[56:63], v27
    v_exp_f32 v66, v66
    v_exp_f32 v67, v67
    v_exp_f32 v68, v68
    v_exp_f32 v69, v69
    v_exp_f32 v70, v70
    v_exp_f32 v71, v71
    v_exp_f32 v72, v72
    v_exp_f32 v73, v73
    v_smfmac_f32_32x32x32_bf16 v[104:119], v[44:47], v[64:71], v27
    v_exp_f32 v74, v74
    v_exp_f32 v75, v75
    v_exp_f32 v76, v76
    v_mfma_f32_32x32x16_bf16 v[56:71], v[16:19], v[8:11], 0
    v_exp_f32 v77, v77
    v_exp_f32 v78, v78
    v_exp_f32 v79, v79
    v_exp_f32 v80, v80
    v_exp_f32 v81, v81
    v_smfmac_f32_32x32x32_bf16 v[88:103], v[40:43], v[72:79], v27
    ds_read_b128 v[40:43], v24 offset:54912
    v_exp_f32 v82, v82
    v_exp_f32 v83, v83
    v_exp_f32 v84, v84
    v_exp_f32 v85, v85
    v_exp_f32 v86, v86
    v_exp_f32 v87, v87
    v_exp_f32 v56, v56
    v_exp_f32 v57, v57
    s_waitcnt lgkmcnt(1)
    v_smfmac_f32_32x32x32_bf16 v[88:103], v[44:47], v[80:87], v27
    ds_read_b128 v[44:47], v24 offset:55456
    v_exp_f32 v58, v58
    v_exp_f32 v59, v59
    v_exp_f32 v60, v60
    v_mfma_f32_32x32x16_bf16 v[72:87], v[16:19], v[4:7], 0
    ds_read_b128 v[16:19], v21 offset:59136
    v_exp_f32 v61, v61
    v_exp_f32 v62, v62
    v_exp_f32 v63, v63
    v_exp_f32 v64, v64
    v_exp_f32 v65, v65
    v_smfmac_f32_32x32x32_bf16 v[104:119], v[48:51], v[56:63], v27
    v_exp_f32 v66, v66
    v_exp_f32 v67, v67
    v_exp_f32 v68, v68
    v_exp_f32 v69, v69
    v_exp_f32 v70, v70
    v_exp_f32 v71, v71
    v_exp_f32 v72, v72
    v_exp_f32 v73, v73
    v_smfmac_f32_32x32x32_bf16 v[104:119], v[52:55], v[64:71], v27
    v_exp_f32 v74, v74
    v_exp_f32 v75, v75
    v_exp_f32 v76, v76
    v_mfma_f32_32x32x16_bf16 v[56:71], v[12:15], v[8:11], 0
    v_exp_f32 v77, v77
    v_exp_f32 v78, v78
    v_exp_f32 v79, v79
    v_exp_f32 v80, v80
    v_exp_f32 v81, v81
    v_smfmac_f32_32x32x32_bf16 v[88:103], v[48:51], v[72:79], v27
    ds_read_b128 v[48:51], v24 offset:59136
    v_exp_f32 v82, v82
    v_exp_f32 v83, v83
    v_exp_f32 v84, v84
    v_exp_f32 v85, v85
    v_exp_f32 v86, v86
    v_exp_f32 v87, v87
    v_exp_f32 v56, v56
    v_exp_f32 v57, v57
    s_waitcnt lgkmcnt(1)
    v_smfmac_f32_32x32x32_bf16 v[88:103], v[52:55], v[80:87], v27
    ds_read_b128 v[52:55], v24 offset:59680
    v_exp_f32 v58, v58
    v_exp_f32 v59, v59
    v_exp_f32 v60, v60
    v_mfma_f32_32x32x16_bf16 v[72:87], v[12:15], v[4:7], 0
    ds_read_b128 v[12:15], v22 offset:0
    v_exp_f32 v61, v61
    v_exp_f32 v62, v62
    v_exp_f32 v63, v63
    v_exp_f32 v64, v64
    v_exp_f32 v65, v65
    v_smfmac_f32_32x32x32_bf16 v[104:119], v[40:43], v[56:63], v27
    v_exp_f32 v66, v66
    v_exp_f32 v67, v67
    v_exp_f32 v68, v68
    v_exp_f32 v69, v69
    v_exp_f32 v70, v70
    v_exp_f32 v71, v71
    v_exp_f32 v72, v72
    v_exp_f32 v73, v73
    v_smfmac_f32_32x32x32_bf16 v[104:119], v[44:47], v[64:71], v27
    v_exp_f32 v74, v74
    v_exp_f32 v75, v75
    v_exp_f32 v76, v76
    v_mfma_f32_32x32x16_bf16 v[56:71], v[16:19], v[8:11], 0
    v_exp_f32 v77, v77
    v_exp_f32 v78, v78
    v_exp_f32 v79, v79
    v_exp_f32 v80, v80
    v_exp_f32 v81, v81
    v_smfmac_f32_32x32x32_bf16 v[88:103], v[40:43], v[72:79], v27
    ds_read_b128 v[40:43], v25 offset:0
    v_exp_f32 v82, v82
    v_exp_f32 v83, v83
    v_exp_f32 v84, v84
    v_exp_f32 v85, v85
    v_exp_f32 v86, v86
    v_exp_f32 v87, v87
    v_exp_f32 v56, v56
    v_exp_f32 v57, v57
    s_waitcnt lgkmcnt(1)
    v_smfmac_f32_32x32x32_bf16 v[88:103], v[44:47], v[80:87], v27
    ds_read_b128 v[44:47], v25 offset:544
    v_exp_f32 v58, v58
    v_exp_f32 v59, v59
    v_exp_f32 v60, v60
    v_mfma_f32_32x32x16_bf16 v[72:87], v[16:19], v[4:7], 0
    ds_read_b128 v[16:19], v22 offset:4224
    v_exp_f32 v61, v61
    v_exp_f32 v62, v62
    v_exp_f32 v63, v63
    v_exp_f32 v64, v64
    v_exp_f32 v65, v65
    v_smfmac_f32_32x32x32_bf16 v[104:119], v[48:51], v[56:63], v27
    v_exp_f32 v66, v66
    v_exp_f32 v67, v67
    v_exp_f32 v68, v68
    v_exp_f32 v69, v69
    v_exp_f32 v70, v70
    v_exp_f32 v71, v71
    v_exp_f32 v72, v72
    v_exp_f32 v73, v73
    v_smfmac_f32_32x32x32_bf16 v[104:119], v[52:55], v[64:71], v27
    v_exp_f32 v74, v74
    v_exp_f32 v75, v75
    v_exp_f32 v76, v76
    v_mfma_f32_32x32x16_bf16 v[56:71], v[12:15], v[8:11], 0
    v_exp_f32 v77, v77
    v_exp_f32 v78, v78
    v_exp_f32 v79, v79
    v_exp_f32 v80, v80
    v_exp_f32 v81, v81
    v_smfmac_f32_32x32x32_bf16 v[88:103], v[48:51], v[72:79], v27
    ds_read_b128 v[48:51], v25 offset:4224
    v_exp_f32 v82, v82
    v_exp_f32 v83, v83
    v_exp_f32 v84, v84
    v_exp_f32 v85, v85
    v_exp_f32 v86, v86
    v_exp_f32 v87, v87
    v_exp_f32 v56, v56
    v_exp_f32 v57, v57
    s_waitcnt lgkmcnt(1)
    v_smfmac_f32_32x32x32_bf16 v[88:103], v[52:55], v[80:87], v27
    ds_read_b128 v[52:55], v25 offset:4768
    v_exp_f32 v58, v58
    v_exp_f32 v59, v59
    v_exp_f32 v60, v60
    v_mfma_f32_32x32x16_bf16 v[72:87], v[16:19], v[8:11], 0
    v_exp_f32 v61, v61
    v_exp_f32 v62, v62
    v_exp_f32 v63, v63
    v_exp_f32 v64, v64
    v_exp_f32 v65, v65
    v_smfmac_f32_32x32x32_bf16 v[104:119], v[40:43], v[56:63], v27
    v_exp_f32 v66, v66
    v_exp_f32 v67, v67
    v_exp_f32 v68, v68
    v_exp_f32 v69, v69
    v_exp_f32 v70, v70
    v_exp_f32 v71, v71
    v_exp_f32 v72, v72
    v_exp_f32 v73, v73
    s_waitcnt lgkmcnt(0)
    v_smfmac_f32_32x32x32_bf16 v[104:119], v[44:47], v[64:71], v27
    v_exp_f32 v74, v74
    v_exp_f32 v75, v75
    v_exp_f32 v76, v76
    v_mfma_f32_32x32x16_bf16 v[56:71], v[12:15], v[4:7], 0
    v_exp_f32 v77, v77
    v_exp_f32 v78, v78
    v_exp_f32 v79, v79
    v_exp_f32 v80, v80
    v_exp_f32 v81, v81
    v_smfmac_f32_32x32x32_bf16 v[104:119], v[48:51], v[72:79], v27
    v_exp_f32 v82, v82
    v_exp_f32 v83, v83
    v_exp_f32 v84, v84
    v_exp_f32 v85, v85
    v_exp_f32 v86, v86
    v_exp_f32 v87, v87
    v_exp_f32 v56, v56
    v_exp_f32 v57, v57
    v_smfmac_f32_32x32x32_bf16 v[104:119], v[52:55], v[80:87], v27
    v_exp_f32 v58, v58
    v_exp_f32 v59, v59
    v_exp_f32 v60, v60
    v_mfma_f32_32x32x16_bf16 v[72:87], v[16:19], v[4:7], 0
    v_exp_f32 v61, v61
    v_exp_f32 v62, v62
    v_exp_f32 v63, v63
    v_exp_f32 v64, v64
    v_exp_f32 v65, v65
    v_exp_f32 v66, v66
    v_exp_f32 v67, v67
    v_exp_f32 v68, v68
    v_smfmac_f32_32x32x32_bf16 v[88:103], v[40:43], v[56:63], v27
    ds_write_b32 v30, v112
    ds_write_b128 v28, v[104:107]
    ds_write_b128 v28, v[108:111] offset:1024
    ds_write_b32 v120, v27
    v_exp_f32 v69, v69
    v_exp_f32 v70, v70
    v_exp_f32 v71, v71
    v_exp_f32 v72, v72
    v_exp_f32 v73, v73
    v_smfmac_f32_32x32x32_bf16 v[88:103], v[44:47], v[64:71], v27
    v_exp_f32 v74, v74
    v_exp_f32 v75, v75
    v_exp_f32 v76, v76
    v_exp_f32 v77, v77
    v_exp_f32 v78, v78
    v_exp_f32 v79, v79
    v_exp_f32 v80, v80
    v_exp_f32 v81, v81
    v_smfmac_f32_32x32x32_bf16 v[88:103], v[48:51], v[72:79], v27
    ds_read_b32 v114, v121
    ds_read_b32 v112, v31
    ds_read_b128 v[104:107], v29
    ds_read_b128 v[108:111], v29 offset:1024
    v_exp_f32 v82, v82
    v_exp_f32 v83, v83
    v_exp_f32 v84, v84
    v_exp_f32 v85, v85
    v_exp_f32 v86, v86
    v_exp_f32 v87, v87
    s_mov_b32 s56, 0x1f800000
    s_mov_b32 s57, 0x5f800000
    v_smfmac_f32_32x32x32_bf16 v[88:103], v[52:55], v[80:87], v27
    s_mov_b32 s61, 262144
    v_mov_b32 v17, 1
    v_mov_b32 v18, 0x40000000
    s_mov_b32 exec_hi, 0
    v_lshlrev_b32 v18, 4, v1
    s_mov_b32 exec_hi, -1
    s_nop 2
xw_b:
    s_waitcnt lgkmcnt(0) vmcnt(63)
    v_cmp_ne_u32 vcc, 0, v114
    s_cmp_eq_u64 vcc, -1
    s_cbranch_scc0 xr_b
xd_b:
    v_add_f32 v96, v96, v112
    v_pk_add_f32 v[88:89], v[88:89], v[104:105]
    v_pk_add_f32 v[90:91], v[90:91], v[106:107]
    v_cmp_lt_f32 vcc, s56, v96
    v_cmp_gt_f32 s[96:97], s57, v96
    v_rcp_f32 v98, v96
    v_pk_add_f32 v[92:93], v[92:93], v[108:109]
    v_pk_add_f32 v[94:95], v[94:95], v[110:111]
    s_and_b64 vcc, vcc, s[96:97]
    s_cmp_eq_u64 vcc, -1
    s_cbranch_scc0 slow_b
norm_b:
    v_mov_b32 v99, v98
    v_pk_mul_f32 v[88:89], v[88:89], v[98:99]
    v_pk_mul_f32 v[90:91], v[90:91], v[98:99]
    v_pk_mul_f32 v[92:93], v[92:93], v[98:99]
    v_pk_mul_f32 v[94:95], v[94:95], v[98:99]
    v_cvt_pk_bf16_f32 v12, v88, v89
    v_cvt_pk_bf16_f32 v13, v90, v91
    v_cvt_pk_bf16_f32 v14, v92, v93
    v_cvt_pk_bf16_f32 v15, v94, v95
    s_cmp_eq_u32 s98, 1
    s_cbranch_scc0 far_ob
    buffer_store_dwordx4 v[12:15], v2, s[28:31], s60 offen
    v_pk_mul_f32 v[100:101], v[88:89], v[32:33]
    v_pk_fma_f32 v[100:101], v[90:91], v[34:35], v[100:101]
    v_pk_fma_f32 v[100:101], v[92:93], v[36:37], v[100:101]
    v_pk_fma_f32 v[100:101], v[94:95], v[38:39], v[100:101]
    v_add_f32 v102, v100, v101
    v_add_f32 v100, v100, v101
    s_nop 1
    v_permlane32_swap_b32 v100, v102
    v_add_f32 v100, v100, v102
    buffer_store_dword v100, v18, s[28:31], s46 offen
back_ob:
    s_barrier
    s_mul_i32 s63, s55, 229376
    s_lshl_b32 s58, s53, 13
    s_add_u32 s63, s63, s58
    s_add_u32 s63, s63, 5242880
    s_waitcnt vmcnt(0)
    s_cmp_eq_u32 s98, 1
    s_cbranch_scc0 far_fb
    buffer_store_dword v17, v26, s[28:31], s47 offen
back_fb:
    s_lshl_b32 s57, s53, 10
    s_sub_u32 s61, s63, s58
    s_add_u32 s61, s61, s57
    s_barrier
    s_add_u32 m0, s58, 98304
    s_add_u32 s56, s63, 98304
    buffer_load_dwordx4 v2, s[28:31], s56 offen offset:0 sc1 lds
    buffer_load_dwordx4 v2, s[28:31], s56 offen offset:1024 sc1 lds
    buffer_load_dwordx4 v2, s[28:31], s56 offen offset:2048 sc1 lds
    buffer_load_dwordx4 v2, s[28:31], s56 offen offset:3072 sc1 lds
    s_add_u32 m0, s58, 102400
    s_add_u32 s56, s63, 102400
    buffer_load_dwordx4 v2, s[28:31], s56 offen offset:0 sc1 lds
    buffer_load_dwordx4 v2, s[28:31], s56 offen offset:1024 sc1 lds
    buffer_load_dwordx4 v2, s[28:31], s56 offen offset:2048 sc1 lds
    buffer_load_dwordx4 v2, s[28:31], s56 offen offset:3072 sc1 lds
    s_add_u32 m0, s57, 131072
    s_add_u32 s56, s61, 131072
    buffer_load_dwordx4 v2, s[28:31], s56 offen sc1 lds
    s_add_u32 m0, s57, 135168
    s_add_u32 s56, s61, 135168
    buffer_load_dwordx4 v2, s[28:31], s56 offen sc1 lds
    s_add_u32 m0, s57, 139264
    s_add_u32 s56, s61, 139264
    buffer_load_dwordx4 v2, s[28:31], s56 offen sc1 lds
    s_add_u32 m0, s57, 159744
    s_add_u32 s56, s61, 159744
    buffer_load_dwordx4 v2, s[28:31], s56 offen sc1 lds
    s_barrier
    s_add_u32 m0, s57, 143360
    s_add_u32 s56, s61, 143360
    buffer_load_dwordx4 v2, s[28:31], s56 offen sc1 lds
    s_add_u32 m0, s57, 147456
    s_add_u32 s56, s61, 147456
    buffer_load_dwordx4 v2, s[28:31], s56 offen sc1 lds
    s_add_u32 m0, s57, 151552
    s_add_u32 s56, s61, 151552
    buffer_load_dwordx4 v2, s[28:31], s56 offen sc1 lds
    s_add_u32 m0, s57, 155648
    s_add_u32 s56, s61, 155648
    buffer_load_dwordx4 v2, s[28:31], s56 offen sc1 lds
    s_lshr_b32 s56, s53, 1
    s_mul_i32 s57, s56, 114688
    v_add_u32 v6, s57, v2
    s_sub_u32 s57, 114688, s57
    v_add_u32 v7, s57, v2
    s_lshr_b32 s57, s55, 3
    s_lshl_b32 s61, s54, 1
    s_add_u32 s61, s61, s57
    s_lshl_b32 s61, s61, 1
    s_lshl_b32 s47, s61, 8
    s_add_u32 s47, s47, 2392064
    s_mul_i32 s60, s61, 114688
    s_mul_i32 s57, s53, 28672
    s_add_u32 s60, s60, s57
    s_add_u32 s60, s60, 13631488
    s_add_u32 s61, s61, s56
    s_lshl_b32 s99, s61, 15
    s_and_b32 s56, s55, 7
    s_lshl_b32 s56, s56, 1
    s_and_b32 s57, s53, 1
    s_add_u32 s56, s56, s57
    s_lshl_b32 s26, s56, 6
    s_add_u32 s26, s26, s99
    s_lshl_b32 s56, s56, 11
    s_add_u32 s99, s99, s56
    s_add_u32 s99, s99, 0
    s_lshl_b32 s61, s61, 8
    s_add_u32 s61, s61, 2375808
    s_lshl_b32 s56, s53, 2
    s_lshl_b32 s62, 0xf000f, s56
    v_and_b32 v3, 15, v1
    v_lshlrev_b32 v3, 2, v3
    s_sub_u32 s100, s61, 0x80
    s_mov_b32 s61, 32768
poll_hb:
    buffer_load_dword v0, v3, s[28:31], s100 offen sc1
    s_waitcnt vmcnt(0)
    v_cmp_le_u32 vcc, 1, v0
    s_sub_u32 s61, s61, 1
    s_cselect_b64 vcc, -1, vcc
    s_cmp_eq_u64 vcc, -1
    s_cbranch_scc1 done_hb
    s_sleep 6
    s_branch poll_hb
done_hb:
    buffer_load_dwordx4 v[8:11], v2, s[28:31], s99 offen sc1
    buffer_load_dwordx4 v[12:15], v2, s[28:31], s99 offen offset:1024 sc1
    buffer_load_dword v4, v3, s[28:31], s100 offen offset:128 sc1
    buffer_load_dword v5, v3, s[28:31], s100 offen offset:192 sc1
    v_bfe_u32 v0, v1, 4, 1
    v_lshl_add_u32 v3, v0, 8, v3
    v_mov_b32 v0, 0
    s_add_u32 s57, s58, 0x10000
    s_mov_b32 s36, s22
    s_mov_b32 s37, s23
    s_mov_b32 s38, 0x200000
    s_mov_b32 s39, 0x00020000
    s_waitcnt vmcnt(0)
    v_lshlrev_b32 v16, 16, v8
    v_and_b32 v17, 0xffff0000, v8
    v_lshlrev_b32 v18, 16, v9
    v_and_b32 v19, 0xffff0000, v9
    v_lshlrev_b32 v20, 16, v10
    v_and_b32 v21, 0xffff0000, v10
    v_lshlrev_b32 v22, 16, v11
    v_and_b32 v23, 0xffff0000, v11
    v_lshlrev_b32 v24, 16, v12
    v_and_b32 v25, 0xffff0000, v12
    v_lshlrev_b32 v26, 16, v13
    v_and_b32 v27, 0xffff0000, v13
    v_lshlrev_b32 v28, 16, v14
    v_and_b32 v29, 0xffff0000, v14
    v_lshlrev_b32 v30, 16, v15
    v_and_b32 v31, 0xffff0000, v15
    v_add_f32 v16, v16, v4
    v_add_f32 v17, v17, v4
    v_add_f32 v18, v18, v4
    v_add_f32 v19, v19, v4
    v_add_f32 v20, v20, v4
    v_add_f32 v21, v21, v4
    v_add_f32 v22, v22, v4
    v_add_f32 v23, v23, v4
    v_add_f32 v24, v24, v5
    v_add_f32 v25, v25, v5
    v_add_f32 v26, v26, v5
    v_add_f32 v27, v27, v5
    v_add_f32 v28, v28, v5
    v_add_f32 v29, v29, v5
    v_add_f32 v30, v30, v5
    v_add_f32 v31, v31, v5
    v_add_u32 v8, s57, v2
    v_add_u32 v9, 0x10000, v8
    s_lshl_b32 s56, s53, 14
    v_add_u32 v14, s56, v2
    v_and_b32 v15, 3, v1
    v_lshrrev_b32 v1, 2, v1
    v_lshlrev_b32 v1, 10, v1
    v_lshl_add_u32 v1, v15, 4, v1
    s_add_u32 s27, s26, 16384
    s_lshl_b32 s45, s54, 2
    s_add_u32 s45, s45, s53
    s_lshl_b32 s45, s45, 15
    s_lshr_b32 s56, s55, 3
    s_lshl_b32 s56, s56, 11
    s_add_u32 s45, s45, s56
    s_lshr_b32 s56, s53, 1
    s_lshl_b32 s56, s56, 10
    s_add_u32 s45, s45, s56
    s_add_u32 s45, s45, 9437184
    s_xor_b32 s46, s45, 0x400
    s_barrier
    s_add_u32 m0, s58, 0
    s_add_u32 s56, s63, 163840
    buffer_load_dwordx4 v2, s[28:31], s56 offen offset:0 sc1 lds
    buffer_load_dwordx4 v2, s[28:31], s56 offen offset:1024 sc1 lds
    buffer_load_dwordx4 v2, s[28:31], s56 offen offset:2048 sc1 lds
    buffer_load_dwordx4 v2, s[28:31], s56 offen offset:3072 sc1 lds
    s_add_u32 m0, s58, 4096
    s_add_u32 s56, s63, 167936
    buffer_load_dwordx4 v2, s[28:31], s56 offen offset:0 sc1 lds
    buffer_load_dwordx4 v2, s[28:31], s56 offen offset:1024 sc1 lds
    buffer_load_dwordx4 v2, s[28:31], s56 offen offset:2048 sc1 lds
    buffer_load_dwordx4 v2, s[28:31], s56 offen offset:3072 sc1 lds
pad_6:
    s_cbranch_execz kb_warm
    s_add_u32 m0, s58, 32768
    s_add_u32 s56, s63, 196608
    buffer_load_dwordx4 v2, s[28:31], s56 offen offset:0 sc1 lds
    buffer_load_dwordx4 v2, s[28:31], s56 offen offset:1024 sc1 lds
    buffer_load_dwordx4 v2, s[28:31], s56 offen offset:2048 sc1 lds
    buffer_load_dwordx4 v2, s[28:31], s56 offen offset:3072 sc1 lds
    s_add_u32 m0, s58, 36864
    s_add_u32 s56, s63, 200704
    buffer_load_dwordx4 v2, s[28:31], s56 offen offset:0 sc1 lds
    buffer_load_dwordx4 v2, s[28:31], s56 offen offset:1024 sc1 lds
    buffer_load_dwordx4 v2, s[28:31], s56 offen offset:2048 sc1 lds
    buffer_load_dwordx4 v2, s[28:31], s56 offen offset:3072 sc1 lds
    s_waitcnt vmcnt(0)
    s_barrier
    s_add_u32 m0, s57, 0
    s_add_u32 s56, s59, 8192
    buffer_load_dwordx4 v2, s[28:31], s56 offen offset:0 sc1 lds
    buffer_load_dwordx4 v2, s[28:31], s56 offen offset:1024 sc1 lds
    s_add_u32 m0, s57, 2048
    s_add_u32 s56, s101, 8192
    buffer_load_dwordx4 v2, s[28:31], s56 offen offset:0 sc1 lds
    buffer_load_dwordx4 v2, s[28:31], s56 offen offset:1024 sc1 lds
    s_add_u32 m0, s57, 4096
    s_add_u32 s56, s59, 22528
    buffer_load_dwordx4 v2, s[28:31], s56 offen offset:0 sc1 lds
    buffer_load_dwordx4 v2, s[28:31], s56 offen offset:1024 sc1 lds
    s_add_u32 m0, s57, 6144
    s_add_u32 s56, s101, 22528
    buffer_load_dwordx4 v2, s[28:31], s56 offen offset:0 sc1 lds
    buffer_load_dwordx4 v2, s[28:31], s56 offen offset:1024 sc1 lds
    s_barrier
    s_add_u32 m0, s57, 32768
    s_add_u32 s56, s59, 10240
    buffer_load_dwordx4 v2, s[28:31], s56 offen offset:0 sc1 lds
    buffer_load_dwordx4 v2, s[28:31], s56 offen offset:1024 sc1 lds
    s_add_u32 m0, s57, 34816
    s_add_u32 s56, s101, 10240
    buffer_load_dwordx4 v2, s[28:31], s56 offen offset:0 sc1 lds
    buffer_load_dwordx4 v2, s[28:31], s56 offen offset:1024 sc1 lds
    s_add_u32 m0, s57, 36864
    s_add_u32 s56, s59, 24576
    buffer_load_dwordx4 v2, s[28:31], s56 offen offset:0 sc1 lds
    buffer_load_dwordx4 v2, s[28:31], s56 offen offset:1024 sc1 lds
    s_add_u32 m0, s57, 38912
    s_add_u32 s56, s101, 24576
    buffer_load_dwordx4 v2, s[28:31], s56 offen offset:0 sc1 lds
    buffer_load_dwordx4 v2, s[28:31], s56 offen offset:1024 sc1 lds
    s_barrier
    buffer_load_dword v0, v3, s[28:31], s47 offen sc1
    s_add_u32 m0, s57, 65536
    s_add_u32 s56, s59, 12288
    buffer_load_dwordx4 v2, s[28:31], s56 offen offset:0 sc1 lds
    buffer_load_dwordx4 v2, s[28:31], s56 offen offset:1024 sc1 lds
    s_add_u32 m0, s57, 67584
    s_add_u32 s56, s101, 12288
    buffer_load_dwordx4 v2, s[28:31], s56 offen offset:0 sc1 lds
    buffer_load_dwordx4 v2, s[28:31], s56 offen offset:1024 sc1 lds
    s_add_u32 m0, s57, 69632
    s_add_u32 s56, s59, 26624
    buffer_load_dwordx4 v2, s[28:31], s56 offen offset:0 sc1 lds
    buffer_load_dwordx4 v2, s[28:31], s56 offen offset:1024 sc1 lds
    s_add_u32 m0, s57, 71680
    s_add_u32 s56, s101, 26624
    buffer_load_dwordx4 v2, s[28:31], s56 offen offset:0 sc1 lds
    buffer_load_dwordx4 v2, s[28:31], s56 offen offset:1024 sc1 lds
    s_waitcnt vmcnt(8) lgkmcnt(0)
    s_mov_b32 s61, 32768
poll_act0:
    v_cmp_le_u32 vcc, 2, v0
    s_and_b32 s56, vcc_lo, s62
    s_cmp_eq_u32 s56, s62
    s_cbranch_scc0 again_act0
done_act0:
    s_add_u32 s56, s60, 0
    buffer_load_dwordx4 v[80:83], v7, s[28:31], s56 offen offset:0 sc1
    buffer_load_dwordx4 v[84:87], v7, s[28:31], s56 offen offset:1024 sc1
    s_add_u32 s56, s60, 0
    buffer_load_dwordx4 v[88:91], v6, s[28:31], s56 offen offset:0 sc1
    buffer_load_dwordx4 v[92:95], v6, s[28:31], s56 offen offset:1024 sc1
    s_add_u32 s56, s60, 14336
    buffer_load_dwordx4 v[96:99], v7, s[28:31], s56 offen offset:0 sc1
    buffer_load_dwordx4 v[100:103], v7, s[28:31], s56 offen offset:1024 sc1
    s_add_u32 s56, s60, 14336
    buffer_load_dwordx4 v[104:107], v6, s[28:31], s56 offen offset:0 sc1
    buffer_load_dwordx4 v[108:111], v6, s[28:31], s56 offen offset:1024 sc1
    s_add_u32 s56, s60, 2048
    buffer_load_dwordx4 v[112:115], v7, s[28:31], s56 offen offset:0 sc1
    buffer_load_dwordx4 v[116:119], v7, s[28:31], s56 offen offset:1024 sc1
    s_add_u32 s56, s60, 2048
    buffer_load_dwordx4 v[120:123], v6, s[28:31], s56 offen offset:0 sc1
    buffer_load_dwordx4 v[124:127], v6, s[28:31], s56 offen offset:1024 sc1
    buffer_load_dword v15, v3, s[28:31], s47 offen sc1
    s_setprio 1
    s_waitcnt vmcnt(11)
    v_swap_b32 v82, v84
    v_swap_b32 v83, v85
    s_nop 1
    v_mfma_f32_16x16x32_bf16 v[64:67], v[136:139], v[80:83], 0
    v_mfma_f32_16x16x32_bf16 v[68:71], v[140:143], v[80:83], 0
    v_mfma_f32_16x16x32_bf16 v[72:75], v[136:139], v[84:87], 0
    v_mfma_f32_16x16x32_bf16 v[76:79], v[140:143], v[84:87], 0
    v_mfma_f32_16x16x32_bf16 v[48:51], v[128:131], v[80:83], 0
    s_waitcnt vmcnt(9)
    v_swap_b32 v90, v92
    v_mfma_f32_16x16x32_bf16 v[52:55], v[132:135], v[80:83], 0
    v_swap_b32 v91, v93
    v_mfma_f32_16x16x32_bf16 v[56:59], v[128:131], v[84:87], 0
    v_mfma_f32_16x16x32_bf16 v[60:63], v[132:135], v[84:87], 0
    v_mfma_f32_16x16x32_bf16 v[32:35], v[136:139], v[88:91], 0
    s_add_u32 s56, s60, 16384
    buffer_load_dwordx4 v[80:83], v7, s[28:31], s56 offen offset:0 sc1
    v_mfma_f32_16x16x32_bf16 v[36:39], v[140:143], v[88:91], 0
    buffer_load_dwordx4 v[84:87], v7, s[28:31], s56 offen offset:1024 sc1
    v_mfma_f32_16x16x32_bf16 v[40:43], v[136:139], v[92:95], 0
    v_mfma_f32_16x16x32_bf16 v[44:47], v[140:143], v[92:95], 0
    v_mfma_f32_16x16x32_bf16 v[16:19], v[128:131], v[88:91], v[16:19]
    s_waitcnt vmcnt(9)
    v_swap_b32 v98, v100
    v_mfma_f32_16x16x32_bf16 v[20:23], v[132:135], v[88:91], v[20:23]
    v_swap_b32 v99, v101
    v_mfma_f32_16x16x32_bf16 v[24:27], v[128:131], v[92:95], v[24:27]
    v_mfma_f32_16x16x32_bf16 v[28:31], v[132:135], v[92:95], v[28:31]
    v_mfma_f32_16x16x32_bf16 v[64:67], v[152:155], v[96:99], v[64:67]
    s_add_u32 s56, s60, 16384
    buffer_load_dwordx4 v[88:91], v6, s[28:31], s56 offen offset:0 sc1
    v_mfma_f32_16x16x32_bf16 v[68:71], v[156:159], v[96:99], v[68:71]
    buffer_load_dwordx4 v[92:95], v6, s[28:31], s56 offen offset:1024 sc1
    v_mfma_f32_16x16x32_bf16 v[72:75], v[152:155], v[100:103], v[72:75]
    v_mfma_f32_16x16x32_bf16 v[76:79], v[156:159], v[100:103], v[76:79]
    v_mfma_f32_16x16x32_bf16 v[48:51], v[144:147], v[96:99], v[48:51]
    s_waitcnt vmcnt(9)
    v_swap_b32 v106, v108
    v_mfma_f32_16x16x32_bf16 v[52:55], v[148:151], v[96:99], v[52:55]
    v_swap_b32 v107, v109
    v_mfma_f32_16x16x32_bf16 v[56:59], v[144:147], v[100:103], v[56:59]
    v_mfma_f32_16x16x32_bf16 v[60:63], v[148:151], v[100:103], v[60:63]
    s_waitcnt vmcnt(4)
    v_max_u32 v0, v0, v15
    s_mov_b32 s61, 32768
poll_act3:
    v_cmp_le_u32 vcc, 3, v0
    s_and_b32 s56, vcc_lo, s62
    s_cmp_eq_u32 s56, s62
    s_cbranch_scc0 again_act3
done_act3:
    v_mfma_f32_16x16x32_bf16 v[32:35], v[152:155], v[104:107], v[32:35]
    buffer_load_dword v10, v3, s[28:31], s47 offen sc1
    v_mfma_f32_16x16x32_bf16 v[36:39], v[156:159], v[104:107], v[36:39]
    s_add_u32 s56, s60, 4096
    buffer_load_dwordx4 v[128:131], v7, s[28:31], s56 offen offset:0 sc1
    v_mfma_f32_16x16x32_bf16 v[40:43], v[152:155], v[108:111], v[40:43]
    buffer_load_dwordx4 v[132:135], v7, s[28:31], s56 offen offset:1024 sc1
    v_mfma_f32_16x16x32_bf16 v[44:47], v[156:159], v[108:111], v[44:47]
    v_mfma_f32_16x16x32_bf16 v[16:19], v[144:147], v[104:107], v[16:19]
    s_waitcnt vmcnt(10)
    v_swap_b32 v114, v116
    v_mfma_f32_16x16x32_bf16 v[20:23], v[148:151], v[104:107], v[20:23]
    v_swap_b32 v115, v117
    v_mfma_f32_16x16x32_bf16 v[24:27], v[144:147], v[108:111], v[24:27]
    v_mfma_f32_16x16x32_bf16 v[28:31], v[148:151], v[108:111], v[28:31]
    v_mfma_f32_16x16x32_bf16 v[64:67], v[168:171], v[112:115], v[64:67]
    s_add_u32 s56, s60, 4096
    buffer_load_dwordx4 v[136:139], v6, s[28:31], s56 offen offset:0 sc1
    v_mfma_f32_16x16x32_bf16 v[68:71], v[172:175], v[112:115], v[68:71]
    buffer_load_dwordx4 v[140:143], v6, s[28:31], s56 offen offset:1024 sc1
    v_mfma_f32_16x16x32_bf16 v[72:75], v[168:171], v[116:119], v[72:75]
    v_mfma_f32_16x16x32_bf16 v[76:79], v[172:175], v[116:119], v[76:79]
    v_mfma_f32_16x16x32_bf16 v[48:51], v[160:163], v[112:115], v[48:51]
    s_waitcnt vmcnt(10)
    v_swap_b32 v122, v124
    v_mfma_f32_16x16x32_bf16 v[52:55], v[164:167], v[112:115], v[52:55]
    v_swap_b32 v123, v125
    v_mfma_f32_16x16x32_bf16 v[56:59], v[160:163], v[116:119], v[56:59]
    v_mfma_f32_16x16x32_bf16 v[60:63], v[164:167], v[116:119], v[60:63]
    v_mfma_f32_16x16x32_bf16 v[32:35], v[168:171], v[120:123], v[32:35]
    s_add_u32 s56, s60, 18432
    buffer_load_dwordx4 v[96:99], v7, s[28:31], s56 offen offset:0 sc1
    v_mfma_f32_16x16x32_bf16 v[36:39], v[172:175], v[120:123], v[36:39]
    buffer_load_dwordx4 v[100:103], v7, s[28:31], s56 offen offset:1024 sc1
    v_mfma_f32_16x16x32_bf16 v[40:43], v[168:171], v[124:127], v[40:43]
    v_mfma_f32_16x16x32_bf16 v[44:47], v[172:175], v[124:127], v[44:47]
    v_mfma_f32_16x16x32_bf16 v[16:19], v[160:163], v[120:123], v[16:19]
    s_waitcnt vmcnt(9)
    v_swap_b32 v82, v84
    v_mfma_f32_16x16x32_bf16 v[20:23], v[164:167], v[120:123], v[20:23]
    v_swap_b32 v83, v85
    v_mfma_f32_16x16x32_bf16 v[24:27], v[160:163], v[124:127], v[24:27]
    v_mfma_f32_16x16x32_bf16 v[28:31], v[164:167], v[124:127], v[28:31]
    v_mfma_f32_16x16x32_bf16 v[64:67], v[184:187], v[80:83], v[64:67]
    buffer_load_dword v11, v3, s[28:31], s47 offen sc1
    v_mfma_f32_16x16x32_bf16 v[68:71], v[188:191], v[80:83], v[68:71]
    s_add_u32 s56, s60, 18432
    buffer_load_dwordx4 v[104:107], v6, s[28:31], s56 offen offset:0 sc1
    v_mfma_f32_16x16x32_bf16 v[72:75], v[184:187], v[84:87], v[72:75]
    buffer_load_dwordx4 v[108:111], v6, s[28:31], s56 offen offset:1024 sc1
    v_mfma_f32_16x16x32_bf16 v[76:79], v[188:191], v[84:87], v[76:79]
    v_mfma_f32_16x16x32_bf16 v[48:51], v[176:179], v[80:83], v[48:51]
    s_waitcnt vmcnt(10)
    v_swap_b32 v90, v92
    v_mfma_f32_16x16x32_bf16 v[52:55], v[180:183], v[80:83], v[52:55]
    v_swap_b32 v91, v93
    v_mfma_f32_16x16x32_bf16 v[56:59], v[176:179], v[84:87], v[56:59]
    v_mfma_f32_16x16x32_bf16 v[60:63], v[180:183], v[84:87], v[60:63]
    s_waitcnt vmcnt(9)
    v_max_u32 v0, v0, v10
    s_mov_b32 s61, 32768
poll_act4:
    v_cmp_le_u32 vcc, 4, v0
    s_and_b32 s56, vcc_lo, s62
    s_cmp_eq_u32 s56, s62
    s_cbranch_scc0 again_act4
done_act4:
    v_mfma_f32_16x16x32_bf16 v[32:35], v[184:187], v[88:91], v[32:35]
    s_add_u32 s56, s60, 6144
    buffer_load_dwordx4 v[144:147], v7, s[28:31], s56 offen offset:0 sc1
    v_mfma_f32_16x16x32_bf16 v[36:39], v[188:191], v[88:91], v[36:39]
    buffer_load_dwordx4 v[148:151], v7, s[28:31], s56 offen offset:1024 sc1
    v_mfma_f32_16x16x32_bf16 v[40:43], v[184:187], v[92:95], v[40:43]
    v_mfma_f32_16x16x32_bf16 v[44:47], v[188:191], v[92:95], v[44:47]
    v_mfma_f32_16x16x32_bf16 v[16:19], v[176:179], v[88:91], v[16:19]
    s_waitcnt vmcnt(9)
    v_swap_b32 v130, v132
    v_mfma_f32_16x16x32_bf16 v[20:23], v[180:183], v[88:91], v[20:23]
    v_swap_b32 v131, v133
    v_mfma_f32_16x16x32_bf16 v[24:27], v[176:179], v[92:95], v[24:27]
    v_mfma_f32_16x16x32_bf16 v[28:31], v[180:183], v[92:95], v[28:31]
    v_mfma_f32_16x16x32_bf16 v[64:67], v[200:203], v[128:131], v[64:67]
    s_add_u32 s56, s60, 6144
    buffer_load_dwordx4 v[152:155], v6, s[28:31], s56 offen offset:0 sc1
    v_mfma_f32_16x16x32_bf16 v[68:71], v[204:207], v[128:131], v[68:71]
    buffer_load_dwordx4 v[156:159], v6, s[28:31], s56 offen offset:1024 sc1
    v_mfma_f32_16x16x32_bf16 v[72:75], v[200:203], v[132:135], v[72:75]
    v_mfma_f32_16x16x32_bf16 v[76:79], v[204:207], v[132:135], v[76:79]
    v_mfma_f32_16x16x32_bf16 v[48:51], v[192:195], v[128:131], v[48:51]
    s_waitcnt vmcnt(9)
    v_swap_b32 v138, v140
    v_mfma_f32_16x16x32_bf16 v[52:55], v[196:199], v[128:131], v[52:55]
    v_swap_b32 v139, v141
    v_mfma_f32_16x16x32_bf16 v[56:59], v[192:195], v[132:135], v[56:59]
    v_mfma_f32_16x16x32_bf16 v[60:63], v[196:199], v[132:135], v[60:63]
    v_mfma_f32_16x16x32_bf16 v[32:35], v[200:203], v[136:139], v[32:35]
    s_add_u32 s56, s60, 20480
    buffer_load_dwordx4 v[112:115], v7, s[28:31], s56 offen offset:0 sc1
    v_mfma_f32_16x16x32_bf16 v[36:39], v[204:207], v[136:139], v[36:39]
    buffer_load_dwordx4 v[116:119], v7, s[28:31], s56 offen offset:1024 sc1
    v_mfma_f32_16x16x32_bf16 v[40:43], v[200:203], v[140:143], v[40:43]
    v_mfma_f32_16x16x32_bf16 v[44:47], v[204:207], v[140:143], v[44:47]
    v_mfma_f32_16x16x32_bf16 v[16:19], v[192:195], v[136:139], v[16:19]
    s_waitcnt vmcnt(9)
    v_swap_b32 v98, v100
    v_mfma_f32_16x16x32_bf16 v[20:23], v[196:199], v[136:139], v[20:23]
    v_swap_b32 v99, v101
    v_mfma_f32_16x16x32_bf16 v[24:27], v[192:195], v[140:143], v[24:27]
    v_mfma_f32_16x16x32_bf16 v[28:31], v[196:199], v[140:143], v[28:31]
    v_mfma_f32_16x16x32_bf16 v[64:67], v[216:219], v[96:99], v[64:67]
    buffer_load_dword v12, v3, s[28:31], s47 offen sc1
    v_mfma_f32_16x16x32_bf16 v[68:71], v[220:223], v[96:99], v[68:71]
    s_add_u32 s56, s60, 20480
    buffer_load_dwordx4 v[120:123], v6, s[28:31], s56 offen offset:0 sc1
    v_mfma_f32_16x16x32_bf16 v[72:75], v[216:219], v[100:103], v[72:75]
    buffer_load_dwordx4 v[124:127], v6, s[28:31], s56 offen offset:1024 sc1
    v_mfma_f32_16x16x32_bf16 v[76:79], v[220:223], v[100:103], v[76:79]
    v_mfma_f32_16x16x32_bf16 v[48:51], v[208:211], v[96:99], v[48:51]
    s_waitcnt vmcnt(9)
    v_swap_b32 v106, v108
    v_mfma_f32_16x16x32_bf16 v[52:55], v[212:215], v[96:99], v[52:55]
    v_swap_b32 v107, v109
    v_mfma_f32_16x16x32_bf16 v[56:59], v[208:211], v[100:103], v[56:59]
    v_mfma_f32_16x16x32_bf16 v[60:63], v[212:215], v[100:103], v[60:63]
    s_waitcnt vmcnt(11)
    v_max_u32 v0, v0, v11
    s_mov_b32 s61, 32768
poll_act5:
    v_cmp_le_u32 vcc, 5, v0
    s_and_b32 s56, vcc_lo, s62
    s_cmp_eq_u32 s56, s62
    s_cbranch_scc0 again_act5
done_act5:
    v_mfma_f32_16x16x32_bf16 v[32:35], v[216:219], v[104:107], v[32:35]
    s_add_u32 s56, s60, 8192
    buffer_load_dwordx4 v[160:163], v7, s[28:31], s56 offen offset:0 sc1
    v_mfma_f32_16x16x32_bf16 v[36:39], v[220:223], v[104:107], v[36:39]
    buffer_load_dwordx4 v[164:167], v7, s[28:31], s56 offen offset:1024 sc1
    v_mfma_f32_16x16x32_bf16 v[40:43], v[216:219], v[108:111], v[40:43]
    v_mfma_f32_16x16x32_bf16 v[44:47], v[220:223], v[108:111], v[44:47]
    v_mfma_f32_16x16x32_bf16 v[16:19], v[208:211], v[104:107], v[16:19]
    s_waitcnt vmcnt(9)
    v_swap_b32 v146, v148
    v_mfma_f32_16x16x32_bf16 v[20:23], v[212:215], v[104:107], v[20:23]
    v_swap_b32 v147, v149
    v_mfma_f32_16x16x32_bf16 v[24:27], v[208:211], v[108:111], v[24:27]
    v_mfma_f32_16x16x32_bf16 v[28:31], v[212:215], v[108:111], v[28:31]
    v_mfma_f32_16x16x32_bf16 v[64:67], v[232:235], v[144:147], v[64:67]
    s_add_u32 s56, s60, 8192
    buffer_load_dwordx4 v[168:171], v6, s[28:31], s56 offen offset:0 sc1
    v_mfma_f32_16x16x32_bf16 v[68:71], v[236:239], v[144:147], v[68:71]
    buffer_load_dwordx4 v[172:175], v6, s[28:31], s56 offen offset:1024 sc1
    v_mfma_f32_16x16x32_bf16 v[72:75], v[232:235], v[148:151], v[72:75]
    v_mfma_f32_16x16x32_bf16 v[76:79], v[236:239], v[148:151], v[76:79]
    v_mfma_f32_16x16x32_bf16 v[48:51], v[224:227], v[144:147], v[48:51]
    s_waitcnt vmcnt(9)
    v_swap_b32 v154, v156
    v_mfma_f32_16x16x32_bf16 v[52:55], v[228:231], v[144:147], v[52:55]
    v_swap_b32 v155, v157
    v_xor_b32 v4, 0x4000, v14
    v_mfma_f32_16x16x32_bf16 v[56:59], v[224:227], v[148:151], v[56:59]
    v_xor_b32 v5, 0x8000, v14
    v_mfma_f32_16x16x32_bf16 v[60:63], v[228:231], v[148:151], v[60:63]
    v_xor_b32 v15, 0xc000, v14
    v_mfma_f32_16x16x32_bf16 v[32:35], v[232:235], v[152:155], v[32:35]
    ds_read_b128 v[80:83], v8 offset:0
    v_mfma_f32_16x16x32_bf16 v[36:39], v[236:239], v[152:155], v[36:39]
    ds_read_b128 v[84:87], v8 offset:1024
    v_mfma_f32_16x16x32_bf16 v[40:43], v[232:235], v[156:159], v[40:43]
    s_add_u32 s56, s60, 22528
    buffer_load_dwordx4 v[88:91], v7, s[28:31], s56 offen offset:0 sc1
    v_mfma_f32_16x16x32_bf16 v[44:47], v[236:239], v[156:159], v[44:47]
    buffer_load_dwordx4 v[92:95], v7, s[28:31], s56 offen offset:1024 sc1
    v_mfma_f32_16x16x32_bf16 v[16:19], v[224:227], v[152:155], v[16:19]
    s_waitcnt vmcnt(9)
    v_swap_b32 v114, v116
    v_mfma_f32_16x16x32_bf16 v[20:23], v[228:231], v[152:155], v[20:23]
    v_swap_b32 v115, v117
    v_mfma_f32_16x16x32_bf16 v[24:27], v[224:227], v[156:159], v[24:27]
    v_mfma_f32_16x16x32_bf16 v[28:31], v[228:231], v[156:159], v[28:31]
    v_mfma_f32_16x16x32_bf16 v[64:67], v[248:251], v[112:115], v[64:67]
    buffer_load_dword v13, v3, s[28:31], s47 offen sc1
    ds_read_b128 v[176:179], v8 offset:2048
    v_mfma_f32_16x16x32_bf16 v[68:71], v[252:255], v[112:115], v[68:71]
    ds_read_b128 v[180:183], v8 offset:3072
    v_mfma_f32_16x16x32_bf16 v[72:75], v[248:251], v[116:119], v[72:75]
    s_add_u32 s56, s60, 22528
    buffer_load_dwordx4 v[184:187], v6, s[28:31], s56 offen offset:0 sc1
    v_mfma_f32_16x16x32_bf16 v[76:79], v[252:255], v[116:119], v[76:79]
    buffer_load_dwordx4 v[188:191], v6, s[28:31], s56 offen offset:1024 sc1
    v_mfma_f32_16x16x32_bf16 v[48:51], v[240:243], v[112:115], v[48:51]
    s_waitcnt vmcnt(9)
    v_swap_b32 v122, v124
    v_mfma_f32_16x16x32_bf16 v[52:55], v[244:247], v[112:115], v[52:55]
    v_swap_b32 v123, v125
    v_mfma_f32_16x16x32_bf16 v[56:59], v[240:243], v[116:119], v[56:59]
    v_mfma_f32_16x16x32_bf16 v[60:63], v[244:247], v[116:119], v[60:63]
    s_waitcnt vmcnt(11)
    v_max_u32 v0, v0, v12
    s_mov_b32 s61, 32768
poll_act6:
    v_cmp_le_u32 vcc, 6, v0
    s_and_b32 s56, vcc_lo, s62
    s_cmp_eq_u32 s56, s62
    s_cbranch_scc0 again_act6
done_act6:
    v_mfma_f32_16x16x32_bf16 v[32:35], v[248:251], v[120:123], v[32:35]
    ds_read_b128 v[128:131], v8 offset:4096
    v_mfma_f32_16x16x32_bf16 v[36:39], v[252:255], v[120:123], v[36:39]
    ds_read_b128 v[132:135], v8 offset:5120
    v_mfma_f32_16x16x32_bf16 v[40:43], v[248:251], v[124:127], v[40:43]
    s_add_u32 s56, s60, 10240
    buffer_load_dwordx4 v[136:139], v7, s[28:31], s56 offen offset:0 sc1
    v_mfma_f32_16x16x32_bf16 v[44:47], v[252:255], v[124:127], v[44:47]
    buffer_load_dwordx4 v[140:143], v7, s[28:31], s56 offen offset:1024 sc1
    v_mfma_f32_16x16x32_bf16 v[16:19], v[240:243], v[120:123], v[16:19]
    s_waitcnt vmcnt(9) lgkmcnt(2)
    v_swap_b32 v162, v164
    v_mfma_f32_16x16x32_bf16 v[20:23], v[244:247], v[120:123], v[20:23]
    v_swap_b32 v163, v165
    v_mfma_f32_16x16x32_bf16 v[24:27], v[240:243], v[124:127], v[24:27]
    v_mfma_f32_16x16x32_bf16 v[28:31], v[244:247], v[124:127], v[28:31]
    v_mfma_f32_16x16x32_bf16 v[64:67], v[176:179], v[160:163], v[64:67]
    ds_read_b128 v[192:195], v8 offset:6144
    v_mfma_f32_16x16x32_bf16 v[68:71], v[180:183], v[160:163], v[68:71]
    ds_read_b128 v[196:199], v8 offset:7168
    v_mfma_f32_16x16x32_bf16 v[72:75], v[176:179], v[164:167], v[72:75]
    s_add_u32 s56, s60, 10240
    buffer_load_dwordx4 v[200:203], v6, s[28:31], s56 offen offset:0 sc1
    v_mfma_f32_16x16x32_bf16 v[76:79], v[180:183], v[164:167], v[76:79]
    buffer_load_dwordx4 v[204:207], v6, s[28:31], s56 offen offset:1024 sc1
    v_mfma_f32_16x16x32_bf16 v[48:51], v[80:83], v[160:163], v[48:51]
    s_waitcnt vmcnt(9)
    v_swap_b32 v170, v172
    v_mfma_f32_16x16x32_bf16 v[52:55], v[84:87], v[160:163], v[52:55]
    v_swap_b32 v171, v173
    v_mfma_f32_16x16x32_bf16 v[56:59], v[80:83], v[164:167], v[56:59]
    v_mfma_f32_16x16x32_bf16 v[60:63], v[84:87], v[164:167], v[60:63]
    v_mfma_f32_16x16x32_bf16 v[32:35], v[176:179], v[168:171], v[32:35]
    ds_read_b128 v[96:99], v8 offset:32768
    v_mfma_f32_16x16x32_bf16 v[36:39], v[180:183], v[168:171], v[36:39]
    ds_read_b128 v[100:103], v8 offset:33792
    v_mfma_f32_16x16x32_bf16 v[40:43], v[176:179], v[172:175], v[40:43]
    s_add_u32 s56, s60, 24576
    buffer_load_dwordx4 v[104:107], v7, s[28:31], s56 offen offset:0 sc1
    v_mfma_f32_16x16x32_bf16 v[44:47], v[180:183], v[172:175], v[44:47]
    buffer_load_dwordx4 v[108:111], v7, s[28:31], s56 offen offset:1024 sc1
    v_mfma_f32_16x16x32_bf16 v[16:19], v[80:83], v[168:171], v[16:19]
    s_waitcnt vmcnt(9) lgkmcnt(2)
    v_swap_b32 v90, v92
    v_mfma_f32_16x16x32_bf16 v[20:23], v[84:87], v[168:171], v[20:23]
    v_swap_b32 v91, v93
    v_mfma_f32_16x16x32_bf16 v[24:27], v[80:83], v[172:175], v[24:27]
    v_mfma_f32_16x16x32_bf16 v[28:31], v[84:87], v[172:175], v[28:31]
    s_waitcnt vmcnt(8)
    v_max_u32 v0, v0, v13
    s_mov_b32 s61, 32768
poll_act7:
    v_cmp_le_u32 vcc, 7, v0
    s_and_b32 s56, vcc_lo, s62
    s_cmp_eq_u32 s56, s62
    s_cbranch_scc0 again_act7
done_act7:
    v_mfma_f32_16x16x32_bf16 v[64:67], v[192:195], v[88:91], v[64:67]
    ds_read_b128 v[208:211], v8 offset:34816
    v_mfma_f32_16x16x32_bf16 v[68:71], v[196:199], v[88:91], v[68:71]
    ds_read_b128 v[212:215], v8 offset:35840
    v_mfma_f32_16x16x32_bf16 v[72:75], v[192:195], v[92:95], v[72:75]
    s_add_u32 s56, s60, 12288
    buffer_load_dwordx4 v[216:219], v7, s[28:31], s56 offen offset:0 sc1
    v_mfma_f32_16x16x32_bf16 v[76:79], v[196:199], v[92:95], v[76:79]
    buffer_load_dwordx4 v[220:223], v7, s[28:31], s56 offen offset:1024 sc1
    v_mfma_f32_16x16x32_bf16 v[48:51], v[128:131], v[88:91], v[48:51]
    s_waitcnt vmcnt(8)
    v_swap_b32 v186, v188
    v_mfma_f32_16x16x32_bf16 v[52:55], v[132:135], v[88:91], v[52:55]
    v_swap_b32 v187, v189
    v_mfma_f32_16x16x32_bf16 v[56:59], v[128:131], v[92:95], v[56:59]
    v_mfma_f32_16x16x32_bf16 v[60:63], v[132:135], v[92:95], v[60:63]
    v_mfma_f32_16x16x32_bf16 v[32:35], v[192:195], v[184:187], v[32:35]
    ds_read_b128 v[144:147], v8 offset:36864
    v_mfma_f32_16x16x32_bf16 v[36:39], v[196:199], v[184:187], v[36:39]
    ds_read_b128 v[148:151], v8 offset:37888
    v_mfma_f32_16x16x32_bf16 v[40:43], v[192:195], v[188:191], v[40:43]
    s_add_u32 s56, s60, 26624
    buffer_load_dwordx4 v[152:155], v7, s[28:31], s56 offen offset:0 sc1
    v_mfma_f32_16x16x32_bf16 v[44:47], v[196:199], v[188:191], v[44:47]
    buffer_load_dwordx4 v[156:159], v7, s[28:31], s56 offen offset:1024 sc1
    v_mfma_f32_16x16x32_bf16 v[16:19], v[128:131], v[184:187], v[16:19]
    s_waitcnt vmcnt(8) lgkmcnt(2)
    v_swap_b32 v138, v140
    v_mfma_f32_16x16x32_bf16 v[20:23], v[132:135], v[184:187], v[20:23]
    v_swap_b32 v139, v141
    v_mfma_f32_16x16x32_bf16 v[24:27], v[128:131], v[188:191], v[24:27]
    v_mfma_f32_16x16x32_bf16 v[28:31], v[132:135], v[188:191], v[28:31]
    v_mfma_f32_16x16x32_bf16 v[64:67], v[208:211], v[136:139], v[64:67]
    ds_read_b128 v[224:227], v8 offset:38912
    ds_read_b128 v[228:231], v8 offset:39936
    v_mfma_f32_16x16x32_bf16 v[68:71], v[212:215], v[136:139], v[68:71]
    ds_read_b128 v[232:235], v9 offset:0
    ds_read_b128 v[236:239], v9 offset:1024
    v_mfma_f32_16x16x32_bf16 v[72:75], v[208:211], v[140:143], v[72:75]
    s_add_u32 s56, s60, 24576
    buffer_load_dwordx4 v[112:115], v6, s[28:31], s56 offen offset:0 sc1
    v_mfma_f32_16x16x32_bf16 v[76:79], v[212:215], v[140:143], v[76:79]
    buffer_load_dwordx4 v[116:119], v6, s[28:31], s56 offen offset:1024 sc1
    v_mfma_f32_16x16x32_bf16 v[48:51], v[96:99], v[136:139], v[48:51]
    s_waitcnt vmcnt(8)
    v_swap_b32 v202, v204
    v_mfma_f32_16x16x32_bf16 v[52:55], v[100:103], v[136:139], v[52:55]
    v_swap_b32 v203, v205
    v_mfma_f32_16x16x32_bf16 v[56:59], v[96:99], v[140:143], v[56:59]
    v_mfma_f32_16x16x32_bf16 v[60:63], v[100:103], v[140:143], v[60:63]
    v_mfma_f32_16x16x32_bf16 v[32:35], v[208:211], v[200:203], v[32:35]
    ds_read_b128 v[120:123], v9 offset:2048
    ds_read_b128 v[124:127], v9 offset:3072
    v_mfma_f32_16x16x32_bf16 v[36:39], v[212:215], v[200:203], v[36:39]
    ds_read_b128 v[240:243], v9 offset:4096
    ds_read_b128 v[244:247], v9 offset:5120
    v_mfma_f32_16x16x32_bf16 v[40:43], v[208:211], v[204:207], v[40:43]
    s_add_u32 s56, s60, 12288
    buffer_load_dwordx4 v[248:251], v6, s[28:31], s56 offen offset:0 sc1
    v_mfma_f32_16x16x32_bf16 v[44:47], v[212:215], v[204:207], v[44:47]
    buffer_load_dwordx4 v[252:255], v6, s[28:31], s56 offen offset:1024 sc1
    v_mfma_f32_16x16x32_bf16 v[16:19], v[96:99], v[200:203], v[16:19]
    s_waitcnt vmcnt(8) lgkmcnt(6)
    v_swap_b32 v106, v108
    v_mfma_f32_16x16x32_bf16 v[20:23], v[100:103], v[200:203], v[20:23]
    v_swap_b32 v107, v109
    v_mfma_f32_16x16x32_bf16 v[24:27], v[96:99], v[204:207], v[24:27]
    v_mfma_f32_16x16x32_bf16 v[28:31], v[100:103], v[204:207], v[28:31]
    v_mfma_f32_16x16x32_bf16 v[64:67], v[224:227], v[104:107], v[64:67]
    ds_read_b128 v[160:163], v9 offset:6144
    v_mfma_f32_16x16x32_bf16 v[68:71], v[228:231], v[104:107], v[68:71]
    ds_read_b128 v[164:167], v9 offset:7168
    v_mfma_f32_16x16x32_bf16 v[72:75], v[224:227], v[108:111], v[72:75]
    s_add_u32 s56, s60, 26624
    buffer_load_dwordx4 v[168:171], v6, s[28:31], s56 offen offset:0 sc1
    v_mfma_f32_16x16x32_bf16 v[76:79], v[228:231], v[108:111], v[76:79]
    buffer_load_dwordx4 v[172:175], v6, s[28:31], s56 offen offset:1024 sc1
    v_mfma_f32_16x16x32_bf16 v[48:51], v[144:147], v[104:107], v[48:51]
    s_waitcnt vmcnt(8) lgkmcnt(4)
    v_swap_b32 v218, v220
    v_mfma_f32_16x16x32_bf16 v[52:55], v[148:151], v[104:107], v[52:55]
    v_swap_b32 v219, v221
    v_mfma_f32_16x16x32_bf16 v[56:59], v[144:147], v[108:111], v[56:59]
    v_mfma_f32_16x16x32_bf16 v[60:63], v[148:151], v[108:111], v[60:63]
    v_mfma_f32_16x16x32_bf16 v[64:67], v[120:123], v[216:219], v[64:67]
    v_mfma_f32_16x16x32_bf16 v[68:71], v[124:127], v[216:219], v[68:71]
    v_mfma_f32_16x16x32_bf16 v[72:75], v[120:123], v[220:223], v[72:75]
    v_mfma_f32_16x16x32_bf16 v[76:79], v[124:127], v[220:223], v[76:79]
    v_mfma_f32_16x16x32_bf16 v[48:51], v[232:235], v[216:219], v[48:51]
    s_waitcnt vmcnt(6) lgkmcnt(0)
    v_swap_b32 v154, v156
    v_mfma_f32_16x16x32_bf16 v[52:55], v[236:239], v[216:219], v[52:55]
    v_swap_b32 v155, v157
    v_mfma_f32_16x16x32_bf16 v[56:59], v[232:235], v[220:223], v[56:59]
    v_mfma_f32_16x16x32_bf16 v[60:63], v[236:239], v[220:223], v[60:63]
    v_mfma_f32_16x16x32_bf16 v[64:67], v[160:163], v[152:155], v[64:67]
    v_mfma_f32_16x16x32_bf16 v[68:71], v[164:167], v[152:155], v[68:71]
    v_mfma_f32_16x16x32_bf16 v[72:75], v[160:163], v[156:159], v[72:75]
    v_mfma_f32_16x16x32_bf16 v[76:79], v[164:167], v[156:159], v[76:79]
    v_mfma_f32_16x16x32_bf16 v[48:51], v[240:243], v[152:155], v[48:51]
    s_waitcnt vmcnt(4)
    v_swap_b32 v114, v116
    v_mfma_f32_16x16x32_bf16 v[52:55], v[244:247], v[152:155], v[52:55]
    v_swap_b32 v115, v117
    v_mfma_f32_16x16x32_bf16 v[56:59], v[240:243], v[156:159], v[56:59]
    v_mfma_f32_16x16x32_bf16 v[60:63], v[244:247], v[156:159], v[60:63]
    s_barrier
    v_mfma_f32_16x16x32_bf16 v[32:35], v[224:227], v[112:115], v[32:35]
    ds_write_b128 v15, v[64:67] offset:8192
    v_mfma_f32_16x16x32_bf16 v[36:39], v[228:231], v[112:115], v[36:39]
    v_mfma_f32_16x16x32_bf16 v[40:43], v[224:227], v[116:119], v[40:43]
    v_mfma_f32_16x16x32_bf16 v[44:47], v[228:231], v[116:119], v[44:47]
    ds_write_b128 v15, v[68:71] offset:9216
    v_mfma_f32_16x16x32_bf16 v[16:19], v[144:147], v[112:115], v[16:19]
    s_waitcnt vmcnt(2)
    v_swap_b32 v250, v252
    v_mfma_f32_16x16x32_bf16 v[20:23], v[148:151], v[112:115], v[20:23]
    v_swap_b32 v251, v253
    v_mfma_f32_16x16x32_bf16 v[24:27], v[144:147], v[116:119], v[24:27]
    ds_write_b128 v15, v[72:75] offset:10240
    v_mfma_f32_16x16x32_bf16 v[28:31], v[148:151], v[116:119], v[28:31]
    v_mfma_f32_16x16x32_bf16 v[32:35], v[120:123], v[248:251], v[32:35]
    v_mfma_f32_16x16x32_bf16 v[36:39], v[124:127], v[248:251], v[36:39]
    ds_write_b128 v15, v[76:79] offset:11264
    v_mfma_f32_16x16x32_bf16 v[40:43], v[120:123], v[252:255], v[40:43]
    v_mfma_f32_16x16x32_bf16 v[44:47], v[124:127], v[252:255], v[44:47]
    v_mfma_f32_16x16x32_bf16 v[16:19], v[232:235], v[248:251], v[16:19]
    s_waitcnt vmcnt(0)
    v_swap_b32 v170, v172
    ds_write_b128 v5, v[48:51] offset:4096
    v_mfma_f32_16x16x32_bf16 v[20:23], v[236:239], v[248:251], v[20:23]
    v_swap_b32 v171, v173
    v_mfma_f32_16x16x32_bf16 v[24:27], v[232:235], v[252:255], v[24:27]
    v_mfma_f32_16x16x32_bf16 v[28:31], v[236:239], v[252:255], v[28:31]
    ds_write_b128 v5, v[52:55] offset:5120
    v_mfma_f32_16x16x32_bf16 v[32:35], v[160:163], v[168:171], v[32:35]
    v_mfma_f32_16x16x32_bf16 v[36:39], v[164:167], v[168:171], v[36:39]
    v_mfma_f32_16x16x32_bf16 v[40:43], v[160:163], v[172:175], v[40:43]
    ds_write_b128 v5, v[56:59] offset:6144
    v_mfma_f32_16x16x32_bf16 v[44:47], v[164:167], v[172:175], v[44:47]
    v_mfma_f32_16x16x32_bf16 v[16:19], v[240:243], v[168:171], v[16:19]
    v_mfma_f32_16x16x32_bf16 v[20:23], v[244:247], v[168:171], v[20:23]
    ds_write_b128 v5, v[60:63] offset:7168
    v_mfma_f32_16x16x32_bf16 v[24:27], v[240:243], v[172:175], v[24:27]
    v_mfma_f32_16x16x32_bf16 v[28:31], v[244:247], v[172:175], v[28:31]
    ds_write_b128 v4, v[32:35] offset:0
    ds_write_b128 v4, v[36:39] offset:1024
    ds_write_b128 v4, v[40:43] offset:2048
    ds_write_b128 v4, v[44:47] offset:3072
    v_bfe_u32 v10, v2, 4, 4
    v_lshlrev_b32 v10, 6, v10
    v_lshrrev_b32 v11, 8, v2
    v_lshl_add_u32 v10, v11, 4, v10
    s_lshl_b32 s56, s53, 14
    s_add_u32 s56, s56, 0x3000
    v_add_u32 v10, s56, v10
    v_add_u32 v11, s56, v2
    s_waitcnt lgkmcnt(0)
    s_barrier
    ds_read_b128 v[32:35], v14 offset:0
    ds_read_b128 v[48:51], v14 offset:4096
    ds_read_b128 v[64:67], v14 offset:8192
    ds_read_b128 v[36:39], v14 offset:1024
    ds_read_b128 v[52:55], v14 offset:5120
    ds_read_b128 v[68:71], v14 offset:9216
    ds_read_b128 v[40:43], v14 offset:2048
    ds_read_b128 v[56:59], v14 offset:6144
    ds_read_b128 v[72:75], v14 offset:10240
    ds_read_b128 v[44:47], v14 offset:3072
    ds_read_b128 v[60:63], v14 offset:7168
    ds_read_b128 v[76:79], v14 offset:11264
    s_waitcnt lgkmcnt(9)
    v_pk_add_f32 v[16:17], v[16:17], v[32:33]
    v_pk_add_f32 v[48:49], v[48:49], v[64:65]
    v_pk_add_f32 v[18:19], v[18:19], v[34:35]
    v_pk_add_f32 v[50:51], v[50:51], v[66:67]
    v_pk_add_f32 v[16:17], v[16:17], v[48:49]
    v_pk_add_f32 v[18:19], v[18:19], v[50:51]
    v_cvt_pk_bf16_f32 v80, v16, v17
    v_cvt_pk_bf16_f32 v81, v18, v19
    s_waitcnt lgkmcnt(6)
    v_pk_add_f32 v[20:21], v[20:21], v[36:37]
    v_pk_add_f32 v[52:53], v[52:53], v[68:69]
    v_pk_add_f32 v[22:23], v[22:23], v[38:39]
    v_pk_add_f32 v[54:55], v[54:55], v[70:71]
pad_7:
    s_cbranch_execz kb_warm
    v_pk_add_f32 v[20:21], v[20:21], v[52:53]
    v_pk_add_f32 v[22:23], v[22:23], v[54:55]
    v_cvt_pk_bf16_f32 v82, v20, v21
    v_cvt_pk_bf16_f32 v83, v22, v23
    ds_write_b128 v10, v[80:83] offset:0
    ds_read_b128 v[88:91], v11 offset:0
    s_waitcnt lgkmcnt(5)
    v_pk_add_f32 v[24:25], v[24:25], v[40:41]
    v_pk_add_f32 v[56:57], v[56:57], v[72:73]
    v_pk_add_f32 v[26:27], v[26:27], v[42:43]
    v_pk_add_f32 v[58:59], v[58:59], v[74:75]
    v_pk_add_f32 v[24:25], v[24:25], v[56:57]
    v_pk_add_f32 v[26:27], v[26:27], v[58:59]
    v_cvt_pk_bf16_f32 v84, v24, v25
    v_cvt_pk_bf16_f32 v85, v26, v27
    s_waitcnt lgkmcnt(2)
    v_pk_add_f32 v[28:29], v[28:29], v[44:45]
    v_pk_add_f32 v[60:61], v[60:61], v[76:77]
    v_pk_add_f32 v[30:31], v[30:31], v[46:47]
    v_pk_add_f32 v[62:63], v[62:63], v[78:79]
    v_pk_add_f32 v[28:29], v[28:29], v[60:61]
    v_pk_add_f32 v[30:31], v[30:31], v[62:63]
    v_cvt_pk_bf16_f32 v86, v28, v29
    v_cvt_pk_bf16_f32 v87, v30, v31
    ds_write_b128 v10, v[84:87] offset:1024
    ds_read_b128 v[92:95], v11 offset:1024
    s_waitcnt lgkmcnt(2)
    buffer_store_dwordx4 v[88:91], v1, s[36:39], s26 offen sc1
    s_waitcnt lgkmcnt(0)
    buffer_store_dwordx4 v[92:95], v1, s[36:39], s27 offen sc1
    s_endpgm
again_rlb:
    s_sub_u32 s61, s61, 1
    s_cbranch_scc1 done_rlb
    s_sleep 4
    buffer_load_dword v126, v127, s[28:31], s58 offen sc1
    s_waitcnt vmcnt(0)
    s_branch poll_rlb
xr_b:
    s_sub_u32 s61, s61, 1
    s_cbranch_scc1 xd_b
    ds_read_b32 v114, v121
    ds_read_b32 v112, v31
    ds_read_b128 v[104:107], v29
    ds_read_b128 v[108:111], v29 offset:1024
    s_branch xw_b
far_ob:
    buffer_store_dwordx4 v[12:15], v2, s[28:31], s60 offen sc1
    v_pk_mul_f32 v[100:101], v[88:89], v[32:33]
    v_pk_fma_f32 v[100:101], v[90:91], v[34:35], v[100:101]
    v_pk_fma_f32 v[100:101], v[92:93], v[36:37], v[100:101]
    v_pk_fma_f32 v[100:101], v[94:95], v[38:39], v[100:101]
    v_add_f32 v102, v100, v101
    v_add_f32 v100, v100, v101
    s_nop 1
    v_permlane32_swap_b32 v100, v102
    v_add_f32 v100, v100, v102
    buffer_store_dword v100, v18, s[28:31], s46 offen sc1
    s_branch back_ob
far_fb:
    buffer_store_dword v17, v26, s[28:31], s47 offen sc1
    s_branch back_fb
again_act0:
    s_sub_u32 s61, s61, 1
    s_cbranch_scc1 done_act0
    buffer_load_dword v0, v3, s[28:31], s47 offen sc1
    s_waitcnt vmcnt(0)
    s_branch poll_act0
again_act3:
    s_sub_u32 s61, s61, 1
    s_cbranch_scc1 done_act3
    buffer_load_dword v0, v3, s[28:31], s47 offen sc1
    s_waitcnt vmcnt(0)
    s_branch poll_act3
again_act4:
    s_sub_u32 s61, s61, 1
    s_cbranch_scc1 done_act4
    buffer_load_dword v0, v3, s[28:31], s47 offen sc1
    s_waitcnt vmcnt(0)
    s_branch poll_act4
again_act5:
    s_sub_u32 s61, s61, 1
    s_cbranch_scc1 done_act5
    buffer_load_dword v0, v3, s[28:31], s47 offen sc1
    s_waitcnt vmcnt(0)
    s_branch poll_act5
again_act6:
    s_sub_u32 s61, s61, 1
    s_cbranch_scc1 done_act6
    buffer_load_dword v0, v3, s[28:31], s47 offen sc1
    s_waitcnt vmcnt(0)
    s_branch poll_act6
again_act7:
    s_sub_u32 s61, s61, 1
    s_cbranch_scc1 done_act7
    buffer_load_dword v0, v3, s[28:31], s47 offen sc1
    s_waitcnt vmcnt(0)
    s_branch poll_act7
slow_b:
    v_mov_b32 v72, 0xff800000
    s_and_b32 s57, s53, 1
    s_mul_i32 s57, s57, 2112
    s_sub_u32 s56, 2097152, s57
    s_add_u32 s57, s56, 135168
slow1_b:
    buffer_load_dwordx4 v[12:15], v20, s[28:31], s56 offen
    s_waitcnt vmcnt(0)
    v_mfma_f32_32x32x16_bf16 v[56:71], v[12:15], v[4:7], 0
    s_add_u32 s56, s56, 2112
    s_nop 11
    v_max3_f32 v72, v72, v56, v57
    v_max3_f32 v72, v72, v58, v59
    v_max3_f32 v72, v72, v60, v61
    v_max3_f32 v72, v72, v62, v63
    v_max3_f32 v72, v72, v64, v65
    v_max3_f32 v72, v72, v66, v67
    v_max3_f32 v72, v72, v68, v69
    v_max3_f32 v72, v72, v70, v71
    s_cmp_lg_u32 s56, s57
    s_cbranch_scc1 slow1_b
    v_mov_b32 v73, v72
    s_nop 1
    v_permlane32_swap_b32 v72, v73
    v_max_f32 v72, v72, v73
    v_sub_f32 v72, 0, v72
    v_mov_b32 v73, v72
    v_mov_b32 v74, v72
    v_mov_b32 v75, v72
    v_mov_b32 v76, v72
    v_mov_b32 v77, v72
    v_mov_b32 v78, v72
    v_mov_b32 v79, v72
    v_mov_b32 v80, v72
    v_mov_b32 v81, v72
    v_mov_b32 v82, v72
    v_mov_b32 v83, v72
    v_mov_b32 v84, v72
    v_mov_b32 v85, v72
    v_mov_b32 v86, v72
    v_mov_b32 v87, v72
    v_mov_b32 v88, 0
    v_mov_b32 v89, 0
    v_mov_b32 v90, 0
    v_mov_b32 v91, 0
    v_mov_b32 v92, 0
    v_mov_b32 v93, 0
    v_mov_b32 v94, 0
    v_mov_b32 v95, 0
    v_mov_b32 v96, 0
    v_mov_b32 v97, 0
    v_mov_b32 v98, 0
    v_mov_b32 v99, 0
    v_mov_b32 v100, 0
    v_mov_b32 v101, 0
    v_mov_b32 v102, 0
    v_mov_b32 v103, 0
    s_sub_u32 s56, s57, 135168
slow2_b:
    buffer_load_dwordx4 v[12:15], v20, s[28:31], s56 offen
    buffer_load_dwordx4 v[40:43], v23, s[28:31], s56 offen
    buffer_load_dwordx4 v[44:47], v23, s[28:31], s56 offen offset:544
    s_waitcnt vmcnt(0)
    v_mfma_f32_32x32x16_bf16 v[56:71], v[12:15], v[4:7], v[72:87]
    s_add_u32 s56, s56, 2112
    s_nop 11
    v_exp_f32 v56, v56
    v_exp_f32 v57, v57
    v_exp_f32 v58, v58
    v_exp_f32 v59, v59
    v_exp_f32 v60, v60
    v_exp_f32 v61, v61
    v_exp_f32 v62, v62
    v_exp_f32 v63, v63
    v_exp_f32 v64, v64
    v_exp_f32 v65, v65
    v_exp_f32 v66, v66
    v_exp_f32 v67, v67
    v_exp_f32 v68, v68
    v_exp_f32 v69, v69
    v_exp_f32 v70, v70
    v_exp_f32 v71, v71
    s_nop 1
    v_smfmac_f32_32x32x32_bf16 v[88:103], v[40:43], v[56:63], v27
    v_smfmac_f32_32x32x32_bf16 v[88:103], v[44:47], v[64:71], v27
    s_nop 15
    s_cmp_lg_u32 s56, s57
    s_cbranch_scc1 slow2_b
    v_rcp_f32 v98, v96
    s_branch norm_b
kb_done:
kb_exit:
    s_endpgm
.section .rodata,"a"
.p2align 6
.amdhsa_kernel qkv_kernel
  .amdhsa_next_free_vgpr 128
  .amdhsa_next_free_sgpr 102
  .amdhsa_accum_offset 128
  .amdhsa_group_segment_fixed_size 0
  .amdhsa_kernarg_size 96
  .amdhsa_user_sgpr_count 2
  .amdhsa_user_sgpr_kernarg_segment_ptr 1
  .amdhsa_system_sgpr_workgroup_id_x 1
.end_amdhsa_kernel
.p2align 6
.amdhsa_kernel sequential_preLN__grouped_kv_mqa__glu_gated_glu__prompt_kernel
  .amdhsa_next_free_vgpr 256
  .amdhsa_next_free_sgpr 102
  .amdhsa_accum_offset 256
  .amdhsa_group_segment_fixed_size 0
  .amdhsa_kernarg_size 96
  .amdhsa_user_sgpr_count 2
  .amdhsa_user_sgpr_kernarg_segment_ptr 1
  .amdhsa_system_sgpr_workgroup_id_x 1
.end_amdhsa_kernel
```
